```python
import torch

def _softmax(x, axis=-1):
    return torch.softmax(x, dim=axis)

def _gelu(x):
    return torch.nn.functional.gelu(x, approximate='tanh')

def _silu(x):
    return torch.nn.functional.silu(x)

def _sigmoid(x):
    return torch.sigmoid(x)

def _layernorm(x, axis=-1, eps=1e-05):
    m = x.mean(dim=axis, keepdim=True)
    v = x.var(dim=axis, keepdim=True, unbiased=False)
    return (x - m) / torch.sqrt(v + eps)

def _scatter_add(tgt, idx, src, axis=0):
    return tgt.clone().index_add_(axis, idx, src)

def _segment_sum(src, seg, n):
    out = torch.zeros((n,) + src.shape[1:], dtype=src.dtype)
    return out.index_add_(0, seg, src)

def _pad(x, pw):
    flat = tuple((v for pair in reversed(pw) for v in pair))
    return torch.nn.functional.pad(x, flat)
kernel_name = 'standalone__video_video_swin__vision'

def setup_inputs():

    _w = lambda a: (lambda t: t.to(torch.bfloat16) if t.is_floating_point() else t)(torch.as_tensor(a))
    T = 4
    H = W = 384 // 8 * 8
    C, win = (96, 8)
    return {'x': _w((lambda *s: torch.randn(*s, dtype=torch.bfloat16) * 0.1)(1, T, H, W, C)), 'wqkv_t': _w((lambda *s: torch.randn(*s, dtype=torch.bfloat16) * 0.1)(C, 3 * C)), 'wo_t': _w((lambda *s: torch.randn(*s, dtype=torch.bfloat16) * 0.1)(C, C)), 'wqkv_s': _w((lambda *s: torch.randn(*s, dtype=torch.bfloat16) * 0.1)(C, 3 * C)), 'wo_s': _w((lambda *s: torch.randn(*s, dtype=torch.bfloat16) * 0.05)(C, C))}

def reference(x, wqkv_t, wo_t, wqkv_s, wo_s):
    B, T, H, W, C = x.shape
    win = 8
    scale = C ** (-0.5)
    h = _layernorm(x, axis=-1)
    ht = (lambda x, *d: x.permute(*d))(h, 0, 2, 3, 1, 4).reshape(B * H * W, T, C)
    qkv = ht @ wqkv_t
    q, k, v = (qkv[..., :C].clone(), qkv[..., C:2 * C].clone(), qkv[..., 2 * C:].clone())
    p = _softmax(torch.einsum('btc,bsc->bts', q, k) * scale, axis=-1)
    ot = torch.einsum('bts,bsc->btc', p, v) @ wo_t
    ot = (lambda x, *d: x.permute(*d))(ot.reshape(B, H, W, T, C), 0, 3, 1, 2, 4)
    x = x + ot
    h = _layernorm(x, axis=-1)
    nh, nw = (H // win, W // win)
    hs = h.reshape(B * T, nh, win, nw, win, C)
    hw = (lambda x, *d: x.permute(*d))(hs, 0, 1, 3, 2, 4, 5).reshape(B * T * nh * nw, win * win, C)
    qkv = hw @ wqkv_s
    q, k, v = (qkv[..., :C].clone(), qkv[..., C:2 * C].clone(), qkv[..., 2 * C:].clone())
    p = _softmax(torch.einsum('bqc,bkc->bqk', q, k) * scale, axis=-1)
    os = torch.einsum('bqk,bkc->bqc', p, v) @ wo_s
    os = (lambda x, *d: x.permute(*d))(os.reshape(B * T, nh, nw, win, win, C), 0, 1, 3, 2, 4, 5)
    os = os.reshape(B, T, H, W, C)
    return x + os
```

```asm
; @launch grid=(256,1,1) block=(256,1,1) lds=163840
.amdgcn_target "amdgcn-amd-amdhsa--gfx950"
.text
.globl standalone__video_video_swin__vision_kernel
.p2align 8
.type standalone__video_video_swin__vision_kernel,@function
standalone__video_video_swin__vision_kernel:
    s_load_dwordx8 s[4:11], s[0:1], 0
    s_load_dwordx4 s[12:15], s[0:1], 32
    s_getpc_b64 s[96:97]
L_pc:
    s_bfe_u32 s99, s2, 196611
    v_lshlrev_b32 v1, 5, v0
    s_mul_i32 s99, s99, 8192
    s_mov_b32 s98, L_codeend-L_pc-4
    v_add_u32 v1, s99, v1
    v_min_u32 v1, s98, v1
    v_and_b32 v1, -4, v1
    v_mov_b32 v3, s97
    v_add_co_u32 v2, vcc, s96, v1
    v_addc_co_u32 v3, vcc, 0, v3, vcc
    global_load_dword v60, v[2:3], off
    s_cmp_ge_u32 s2, 256
    s_cbranch_scc1 L_end
    v_lshrrev_b32 v1, 6, v0
    v_and_b32 v45, 63, v0
    v_readfirstlane_b32 s32, v1
    s_bfe_u32 s96, s2, 262147
    s_mov_b32 s26, 55296
    s_mov_b32 s27, 0x00020000
    s_mov_b32 s30, 18432
    s_mov_b32 s31, 0x00020000
    s_lshl_b32 s96, s96, 12
    v_and_b32 v70, 127, v0
    s_and_b32 s97, s96, 0x7fff
    s_lshr_b32 s33, s32, 1
    v_lshl_add_u32 v73, v70, 5, s97
    v_lshl_add_u32 v70, v70, 5, s96
    s_cmp_eq_u32 s33, 0
    s_waitcnt lgkmcnt(0)
    s_cselect_b32 s24, s6, s10
    s_cselect_b32 s25, s7, s11
    s_cselect_b32 s28, s8, s12
    s_cselect_b32 s29, s9, s13
    buffer_load_dword v71, v70, s[24:27], 0 offen
    buffer_load_dword v72, v73, s[28:31], 0 offen
    v_lshlrev_b32 v41, 4, v45
    v_and_b32 v44, 31, v45
    v_lshrrev_b32 v43, 5, v45
    s_and_b32 s34, s32, 1
    s_mul_i32 s43, s32, 18432
    s_add_u32 s43, s43, 88064
    s_cmp_eq_u32 s32, 0
    s_cselect_b32 s43, 49152, s43
    s_mul_i32 s44, s34, 384
    v_and_b32 v46, 0x13, v44
    v_and_b32 v47, 4, v44
    v_and_b32 v48, 8, v44
    v_lshl_or_b32 v46, v47, 1, v46
    v_lshrrev_b32 v48, 1, v48
    v_or_b32 v46, v46, v48
    v_mul_u32_u24 v47, 576, v46
    v_lshl_add_u32 v35, v43, 4, v47
    v_add_u32 v49, 0, v45
    v_mul_u32_u24 v47, 5462, v49
    v_lshrrev_b32 v47, 16, v47
    v_mul_u32_u24 v48, 12, v47
    v_sub_u32 v48, v49, v48
    v_lshrrev_b32 v50, 2, v47
    v_xor_b32 v48, v48, v50
    v_mul_u32_u24 v47, 576, v47
    v_add_u32 v47, 192, v47
    v_lshl_add_u32 v32, v48, 4, v47
    v_add_u32 v49, 64, v45
    v_mul_u32_u24 v47, 5462, v49
    v_lshrrev_b32 v47, 16, v47
    v_mul_u32_u24 v48, 12, v47
    v_sub_u32 v48, v49, v48
    v_lshrrev_b32 v50, 2, v47
    v_xor_b32 v48, v48, v50
    v_mul_u32_u24 v47, 576, v47
    v_add_u32 v47, -832, v47
    v_lshl_add_u32 v33, v48, 4, v47
    v_add_u32 v49, 128, v45
    v_mul_u32_u24 v47, 5462, v49
    v_lshrrev_b32 v47, 16, v47
    v_mul_u32_u24 v48, 12, v47
    v_sub_u32 v48, v49, v48
    v_lshrrev_b32 v50, 2, v47
    v_xor_b32 v48, v48, v50
    v_mul_u32_u24 v47, 576, v47
    v_add_u32 v47, -1856, v47
    v_lshl_add_u32 v34, v48, 4, v47
    s_cmp_eq_u32 s34, 0
    s_cselect_b64 vcc, -1, 0
    v_cndmask_b32 v32, v41, v32, vcc
    v_cndmask_b32 v33, v41, v33, vcc
    v_cndmask_b32 v34, v41, v34, vcc
    s_mov_b32 s16, s4
    s_mov_b32 s17, s5
    s_mov_b32 s45, 3072
    s_cmp_eq_u32 s34, 0
    s_cselect_b32 s28, s24, s28
    s_cselect_b32 s29, s25, s29
    s_cselect_b32 s30, s26, s30
    s_cselect_b32 s45, 9216, s45
    s_mov_b32 s42, 0
    s_cmp_eq_u32 s34, 0
    s_cbranch_scc0 L_wf
    s_add_u32 m0, s43, 0
    s_nop 0
    buffer_load_dwordx4 v32, s[28:31], s42 offen offset:0 lds
    buffer_load_dwordx4 v33, s[28:31], s42 offen offset:1024 lds
    buffer_load_dwordx4 v34, s[28:31], s42 offen offset:2048 lds
    s_add_u32 m0, s43, 3072
    s_add_u32 s42, s42, s45
    buffer_load_dwordx4 v32, s[28:31], s42 offen offset:0 lds
    buffer_load_dwordx4 v33, s[28:31], s42 offen offset:1024 lds
    buffer_load_dwordx4 v34, s[28:31], s42 offen offset:2048 lds
    s_mov_b32 s18, 113246208
    s_mov_b32 s19, 0x00020000
    s_mul_i32 s35, s32, 12288
    s_mov_b32 s36, s2
    s_mul_i32 s96, s32, 28311552
    s_mov_b32 s98, 147456
    s_mul_i32 s94, s36, 43691
    s_lshr_b32 s94, s94, 21
    s_mul_i32 s95, s94, 48
    s_sub_u32 s95, s36, s95
    s_mul_i32 s94, s94, 589824
    s_mul_i32 s95, s95, 1536
    s_add_u32 s38, s94, s95
    s_add_u32 s39, s38, 73728
    v_add_u32 v49, 0, v45
    v_mul_u32_u24 v47, 683, v49
    v_lshrrev_b32 v47, 16, v47
    v_mul_u32_u24 v48, 96, v47
    v_sub_u32 v48, v49, v48
    v_xor_b32 v48, v48, v47
    v_xor_b32 v48, s32, v48
    v_lshlrev_b32 v48, 4, v48
    v_mul_lo_u32 v47, v47, s98
    v_add3_u32 v0, v47, v48, s96
    v_xor_b32 v3, 32, v0
    v_add_u32 v3, 294912, v3
    v_add_u32 v49, 64, v45
    s_add_u32 m0, s43, 6144
    s_add_u32 s42, s42, s45
    buffer_load_dwordx4 v32, s[28:31], s42 offen offset:0 lds
    buffer_load_dwordx4 v33, s[28:31], s42 offen offset:1024 lds
    buffer_load_dwordx4 v34, s[28:31], s42 offen offset:2048 lds
    v_mul_u32_u24 v47, 683, v49
    v_lshrrev_b32 v47, 16, v47
    v_mul_u32_u24 v48, 96, v47
    v_sub_u32 v48, v49, v48
    v_xor_b32 v48, v48, v47
    v_xor_b32 v48, s32, v48
    v_lshlrev_b32 v48, 4, v48
    v_mul_lo_u32 v47, v47, s98
    v_add3_u32 v1, v47, v48, s96
    v_subrev_u32 v1, 1024, v1
    v_xor_b32 v4, 32, v1
    v_add_u32 v4, 294912, v4
    v_add_u32 v49, 128, v45
    v_mul_u32_u24 v47, 683, v49
    v_lshrrev_b32 v47, 16, v47
    v_mul_u32_u24 v48, 96, v47
    v_sub_u32 v48, v49, v48
    v_xor_b32 v48, v48, v47
    v_xor_b32 v48, s32, v48
    v_lshlrev_b32 v48, 4, v48
    v_mul_lo_u32 v47, v47, s98
    v_add3_u32 v2, v47, v48, s96
    v_subrev_u32 v2, 2048, v2
    v_xor_b32 v5, 32, v2
    v_add_u32 v5, 294912, v5
    s_mov_b32 s65, 49152
    s_mov_b32 s66, 49152
    s_add_u32 m0, s43, 9216
    s_add_u32 s42, s42, s45
    buffer_load_dwordx4 v32, s[28:31], s42 offen offset:0 lds
    buffer_load_dwordx4 v33, s[28:31], s42 offen offset:1024 lds
    buffer_load_dwordx4 v34, s[28:31], s42 offen offset:2048 lds
    s_mov_b32 s20, s14
    s_mov_b32 s21, s15
    s_mov_b32 s22, 113246208
    s_mov_b32 s23, 0x00020000
    s_mov_b32 s62, 0xffff0000
    s_mov_b32 s63, 0x3c2aaaab
    s_mov_b32 s64, 0x3dbcbe62
    s_mov_b32 s67, 0x42c00000
    s_mov_b32 s74, 0x42c00000
    s_mov_b32 s75, 0x42c00000
    s_mov_b32 s70, 0x44a9a027
    s_mov_b32 s71, 0x44a9a027
    s_mov_b32 s72, 0xc1622adf
    v_bfe_u32 v47, v46, 2, 2
    v_xor_b32 v47, v47, v43
    v_mul_u32_u24 v48, 192, v46
    v_lshl_add_u32 v48, v47, 4, v48
    v_add_u32 v36, s43, v48
    v_xor_b32 v37, 32, v36
    v_bfe_u32 v47, v45, 2, 2
    v_lshl_add_u32 v47, v43, 3, v47
    v_mul_u32_u24 v47, 192, v47
    v_and_b32 v48, 16, v45
    v_lshl_add_u32 v47, v48, 1, v47
    v_and_b32 v48, 1, v45
    v_lshl_add_u32 v47, v48, 4, v47
    v_and_b32 v48, 2, v45
    s_add_u32 m0, s43, 12288
    s_add_u32 s42, s42, s45
    buffer_load_dwordx4 v32, s[28:31], s42 offen offset:0 lds
    buffer_load_dwordx4 v33, s[28:31], s42 offen offset:1024 lds
    buffer_load_dwordx4 v34, s[28:31], s42 offen offset:2048 lds
    v_lshl_add_u32 v47, v48, 2, v47
    v_add_u32 v38, s43, v47
    s_cmp_eq_u32 s33, 0
    s_mov_b32 s96, 124928
    s_mov_b32 s97, 143360
    s_cselect_b32 s94, 49152, s96
    s_cselect_b32 s95, 88064, s96
    s_cselect_b32 s93, 106496, s97
    s_cmp_eq_u32 s34, 0
    s_cselect_b32 s94, s94, s93
    s_cselect_b32 s95, s95, s93
    v_add_u32 v39, s94, v41
    v_add_u32 v40, s95, v41
    v_add_u32 v11, 98304, v41
    v_add_u32 v42, 49152, v41
    v_and_b32 v50, 3, v44
    v_lshrrev_b32 v49, 2, v44
    v_mul_u32_u24 v48, 192, v49
    v_mul_u32_u24 v47, 12288, v50
    s_mul_i32 s96, s32, 1536
    v_add3_u32 v48, v48, v47, s96
    v_xor_b32 v47, v43, v50
    v_xor_b32 v47, s32, v47
    v_lshl_add_u32 v6, v47, 4, v48
    v_xor_b32 v7, 32, v6
    v_mul_u32_u24 v48, 192, v49
    v_mul_u32_u24 v51, 1536, v50
    s_add_u32 m0, s43, 15360
    s_add_u32 s42, s42, s45
    buffer_load_dwordx4 v32, s[28:31], s42 offen offset:0 lds
    buffer_load_dwordx4 v33, s[28:31], s42 offen offset:1024 lds
    buffer_load_dwordx4 v34, s[28:31], s42 offen offset:2048 lds
    v_add_u32 v48, v48, v51
    v_lshl_add_u32 v48, v47, 4, v48
    s_mul_i32 s96, s32, 12288
    v_add_u32 v8, s96, v48
    v_xor_b32 v9, 32, v8
    s_mul_i32 s96, s32, 9216
    s_add_u32 s96, s96, 124928
    v_add_u32 v10, s96, v48
    v_xor_b32 v21, 32, v10
    v_add_u32 v18, s96, v41
    v_sub_u32 v48, v49, v43
    v_cmp_eq_u32 s[48:49], 0, v48
    v_cmp_eq_u32 s[50:51], 2, v48
    v_cmp_eq_u32 s[52:53], 4, v48
    v_cmp_eq_u32 s[54:55], 6, v48
    v_cmp_eq_u32 s[56:57], 1, v50
    v_cmp_eq_u32 s[58:59], 2, v50
    v_cmp_eq_u32 s[60:61], 3, v50
    v_bfe_u32 v47, v45, 2, 2
    v_lshlrev_b32 v47, 5, v47
    v_lshl_add_u32 v47, v43, 4, v47
    v_lshl_add_u32 v12, v50, 2, v47
    v_lshrrev_b32 v47, 3, v45
    v_and_b32 v48, 7, v45
    s_mul_i32 s96, s32, 28311552
    v_mul_u32_u24 v47, 73728, v47
    v_lshlrev_b32 v48, 6, v48
    s_add_u32 s42, s44, 0
    buffer_load_dwordx4 a[72:75], v35, s[24:27], s42 offen offset:0
    buffer_load_dwordx4 a[76:79], v35, s[24:27], s42 offen offset:32
    buffer_load_dwordx4 a[80:83], v35, s[24:27], s42 offen offset:64
    buffer_load_dwordx4 a[84:87], v35, s[24:27], s42 offen offset:96
    buffer_load_dwordx4 a[88:91], v35, s[24:27], s42 offen offset:128
    buffer_load_dwordx4 a[92:95], v35, s[24:27], s42 offen offset:160
    v_add3_u32 v31, v47, v48, s96
    v_and_b32 v47, 1, v45
    v_lshlrev_b32 v47, 4, v47
    v_mov_b32 v48, 0x3f80
    v_lshlrev_b32 v48, v47, v48
    v_cmp_gt_u32 vcc, 2, v50
    v_bfe_u32 v47, v45, 2, 1
    v_bfe_u32 v51, v45, 4, 1
    v_cndmask_b32 v22, 0, v48, vcc
    v_sub_u32 v23, v48, v22
    v_cmp_eq_u32 vcc, v47, v51
    v_mov_b32 v48, 0x3f803f80
    v_bfe_u32 v47, v45, 3, 1
    v_cndmask_b32 v48, 0, v48, vcc
    v_cmp_eq_u32 vcc, 0, v47
    s_nop 1
    v_cndmask_b32 v47, 0, v48, vcc
    v_sub_u32 v48, v48, v47
    v_accvgpr_write_b32 a48, v47
    v_accvgpr_write_b32 a52, v48
    v_accvgpr_write_b32 a49, v47
    v_accvgpr_write_b32 a53, v48
    v_accvgpr_write_b32 a50, v47
    v_accvgpr_write_b32 a54, v48
    v_accvgpr_write_b32 a51, v47
    v_accvgpr_write_b32 a55, v48
    s_barrier
    s_add_u32 s42, s44, 18432
    buffer_load_dwordx4 a[96:99], v35, s[24:27], s42 offen offset:0
    buffer_load_dwordx4 a[100:103], v35, s[24:27], s42 offen offset:32
    buffer_load_dwordx4 a[104:107], v35, s[24:27], s42 offen offset:64
    buffer_load_dwordx4 a[108:111], v35, s[24:27], s42 offen offset:96
    buffer_load_dwordx4 a[112:115], v35, s[24:27], s42 offen offset:128
    buffer_load_dwordx4 a[116:119], v35, s[24:27], s42 offen offset:160
    s_add_u32 s42, s44, 36864
    buffer_load_dwordx4 a[120:123], v35, s[24:27], s42 offen offset:0
    buffer_load_dwordx4 a[124:127], v35, s[24:27], s42 offen offset:32
    buffer_load_dwordx4 a[128:131], v35, s[24:27], s42 offen offset:64
    buffer_load_dwordx4 a[132:135], v35, s[24:27], s42 offen offset:96
    buffer_load_dwordx4 a[136:139], v35, s[24:27], s42 offen offset:128
    buffer_load_dwordx4 a[140:143], v35, s[24:27], s42 offen offset:160
    s_waitcnt vmcnt(12)
.p2align 5
    ds_read_b128 a[144:147], v36 offset:0
    ds_read_b128 a[168:171], v36 offset:6144
    ds_read_b128 a[192:195], v36 offset:12288
    ds_read_b128 a[148:151], v37 offset:0
    ds_read_b128 a[172:175], v37 offset:6144
    ds_read_b128 a[196:199], v37 offset:12288
    ds_read_b128 a[152:155], v36 offset:64
    ds_read_b128 a[176:179], v36 offset:6208
    ds_read_b128 a[200:203], v36 offset:12352
    ds_read_b128 a[156:159], v37 offset:64
    s_waitcnt lgkmcnt(9)
    v_mfma_f32_32x32x16_bf16 v[80:95], a[72:75], a[144:147], 0
    ds_read_b128 a[180:183], v37 offset:6208
    s_waitcnt lgkmcnt(9)
    ds_read_b128 a[204:207], v37 offset:12352
    v_mfma_f32_32x32x16_bf16 v[96:111], a[72:75], a[168:171], 0
    ds_read_b128 a[160:163], v36 offset:128
    s_waitcnt lgkmcnt(10)
    ds_read_b128 a[184:187], v36 offset:6272
    v_mfma_f32_32x32x16_bf16 v[112:127], a[72:75], a[192:195], 0
    ds_read_b128 a[208:211], v36 offset:12416
    s_waitcnt lgkmcnt(11)
    ds_read_b128 a[164:167], v37 offset:128
    v_mfma_f32_32x32x16_bf16 v[80:95], a[76:79], a[148:151], v[80:95]
    ds_read_b128 a[188:191], v37 offset:6272
    s_waitcnt lgkmcnt(12)
    ds_read_b128 a[212:215], v37 offset:12416
    s_waitcnt lgkmcnt(12)
    v_mfma_f32_32x32x16_bf16 v[96:111], a[76:79], a[172:175], v[96:111]
    s_waitcnt lgkmcnt(11)
    v_mfma_f32_32x32x16_bf16 v[112:127], a[76:79], a[196:199], v[112:127]
    s_waitcnt lgkmcnt(10)
    v_mfma_f32_32x32x16_bf16 v[80:95], a[80:83], a[152:155], v[80:95]
    s_waitcnt lgkmcnt(9)
    v_mfma_f32_32x32x16_bf16 v[96:111], a[80:83], a[176:179], v[96:111]
    s_waitcnt lgkmcnt(8)
    v_mfma_f32_32x32x16_bf16 v[112:127], a[80:83], a[200:203], v[112:127]
    s_waitcnt lgkmcnt(7)
    v_mfma_f32_32x32x16_bf16 v[80:95], a[84:87], a[156:159], v[80:95]
    s_waitcnt lgkmcnt(6)
    v_mfma_f32_32x32x16_bf16 v[96:111], a[84:87], a[180:183], v[96:111]
    s_waitcnt lgkmcnt(5)
    v_mfma_f32_32x32x16_bf16 v[112:127], a[84:87], a[204:207], v[112:127]
    s_waitcnt lgkmcnt(4)
    v_mfma_f32_32x32x16_bf16 v[80:95], a[88:91], a[160:163], v[80:95]
    s_waitcnt lgkmcnt(3)
    v_mfma_f32_32x32x16_bf16 v[96:111], a[88:91], a[184:187], v[96:111]
    s_waitcnt lgkmcnt(2)
    v_mfma_f32_32x32x16_bf16 v[112:127], a[88:91], a[208:211], v[112:127]
    s_waitcnt lgkmcnt(1)
    v_mfma_f32_32x32x16_bf16 v[80:95], a[92:95], a[164:167], v[80:95]
    s_waitcnt lgkmcnt(0)
    v_mfma_f32_32x32x16_bf16 v[96:111], a[92:95], a[188:191], v[96:111]
    v_mfma_f32_32x32x16_bf16 v[112:127], a[92:95], a[212:215], v[112:127]
    s_nop 3
    v_pk_add_f32 v[224:225], v[80:81], v[96:97]
    s_nop 6
    v_pk_add_f32 v[224:225], v[224:225], v[112:113]
    v_pk_add_f32 v[226:227], v[82:83], v[98:99]
    v_pk_add_f32 v[226:227], v[226:227], v[114:115]
    v_pk_add_f32 v[228:229], v[84:85], v[100:101]
    v_pk_add_f32 v[228:229], v[228:229], v[116:117]
    v_pk_add_f32 v[230:231], v[86:87], v[102:103]
    v_pk_add_f32 v[230:231], v[230:231], v[118:119]
    v_pk_add_f32 v[232:233], v[88:89], v[104:105]
    v_pk_add_f32 v[232:233], v[232:233], v[120:121]
    v_pk_add_f32 v[234:235], v[90:91], v[106:107]
    v_pk_add_f32 v[234:235], v[234:235], v[122:123]
    v_pk_add_f32 v[236:237], v[92:93], v[108:109]
    v_pk_add_f32 v[236:237], v[236:237], v[124:125]
    v_pk_add_f32 v[238:239], v[94:95], v[110:111]
    v_pk_add_f32 v[238:239], v[238:239], v[126:127]
    v_add_f32_dpp v224, v224, v224 row_ror:8 row_mask:0xf bank_mask:0x3
    v_add_f32_dpp v225, v225, v225 row_ror:8 row_mask:0xf bank_mask:0x3
    v_add_f32_dpp v226, v226, v226 row_ror:8 row_mask:0xf bank_mask:0x3
    v_add_f32_dpp v224, v232, v232 row_ror:8 row_mask:0xf bank_mask:0xc
    v_add_f32_dpp v225, v233, v233 row_ror:8 row_mask:0xf bank_mask:0xc
    v_add_f32_dpp v226, v234, v234 row_ror:8 row_mask:0xf bank_mask:0xc
    v_add_f32_dpp v227, v227, v227 row_ror:8 row_mask:0xf bank_mask:0x3
    v_add_f32_dpp v228, v228, v228 row_ror:8 row_mask:0xf bank_mask:0x3
    v_add_f32_dpp v229, v229, v229 row_ror:8 row_mask:0xf bank_mask:0x3
    v_add_f32_dpp v227, v235, v235 row_ror:8 row_mask:0xf bank_mask:0xc
    v_add_f32_dpp v228, v236, v236 row_ror:8 row_mask:0xf bank_mask:0xc
    v_add_f32_dpp v229, v237, v237 row_ror:8 row_mask:0xf bank_mask:0xc
    v_add_f32_dpp v230, v230, v230 row_ror:8 row_mask:0xf bank_mask:0x3
    v_add_f32_dpp v231, v231, v231 row_ror:8 row_mask:0xf bank_mask:0x3
    v_add_f32_dpp v224, v224, v224 row_half_mirror row_mask:0xf bank_mask:0x5
    v_add_f32_dpp v230, v238, v238 row_ror:8 row_mask:0xf bank_mask:0xc
    v_add_f32_dpp v231, v239, v239 row_ror:8 row_mask:0xf bank_mask:0xc
    v_add_f32_dpp v224, v228, v228 row_half_mirror row_mask:0xf bank_mask:0xa
    v_add_f32_dpp v225, v225, v225 row_half_mirror row_mask:0xf bank_mask:0x5
    v_add_f32_dpp v226, v226, v226 row_half_mirror row_mask:0xf bank_mask:0x5
    v_add_f32_dpp v227, v227, v227 row_half_mirror row_mask:0xf bank_mask:0x5
    v_add_f32_dpp v225, v229, v229 row_half_mirror row_mask:0xf bank_mask:0xa
    v_add_f32_dpp v226, v230, v230 row_half_mirror row_mask:0xf bank_mask:0xa
    v_add_f32_dpp v227, v231, v231 row_half_mirror row_mask:0xf bank_mask:0xa
    v_add_f32_dpp v224, v224, v224 quad_perm:[1,0,3,2] row_mask:0xf bank_mask:0xf
    v_add_f32_dpp v225, v225, v225 quad_perm:[1,0,3,2] row_mask:0xf bank_mask:0xf
    v_add_f32_dpp v226, v226, v226 quad_perm:[1,0,3,2] row_mask:0xf bank_mask:0xf
    v_add_f32_dpp v227, v227, v227 quad_perm:[1,0,3,2] row_mask:0xf bank_mask:0xf
    v_add_f32_dpp v224, v224, v224 quad_perm:[2,3,0,1] row_mask:0xf bank_mask:0xf
    v_add_f32_dpp v225, v225, v225 quad_perm:[2,3,0,1] row_mask:0xf bank_mask:0xf
    v_add_f32_dpp v226, v226, v226 quad_perm:[2,3,0,1] row_mask:0xf bank_mask:0xf
    v_add_f32_dpp v227, v227, v227 quad_perm:[2,3,0,1] row_mask:0xf bank_mask:0xf
    v_mov_b32 v228, v224
    v_mov_b32 v229, v225
    v_mov_b32 v230, v226
    v_permlane16_swap_b32 v224, v228
    v_add_f32 v224, v224, v228
    v_mul_f32 v224, s63, v224
    v_permlane16_swap_b32 v225, v229
    v_add_f32 v225, v225, v229
    v_mul_f32 v225, s63, v225
    v_permlane16_swap_b32 v226, v230
    v_add_f32 v226, v226, v230
    v_mul_f32 v226, s63, v226
    v_mov_b32 v231, v227
    v_subrev_f32_dpp v80, v224, v80 row_newbcast:0 row_mask:0xf bank_mask:0xf
    v_subrev_f32_dpp v81, v225, v81 row_newbcast:0 row_mask:0xf bank_mask:0xf
    v_permlane16_swap_b32 v227, v231
    v_add_f32 v227, v227, v231
    v_mul_f32 v227, s63, v227
    v_subrev_f32_dpp v82, v226, v82 row_newbcast:0 row_mask:0xf bank_mask:0xf
    v_subrev_f32_dpp v84, v224, v84 row_newbcast:4 row_mask:0xf bank_mask:0xf
    v_subrev_f32_dpp v83, v227, v83 row_newbcast:0 row_mask:0xf bank_mask:0xf
    v_pk_add_f32 v[240:241], v[80:81], v[82:83]
    v_subrev_f32_dpp v85, v225, v85 row_newbcast:4 row_mask:0xf bank_mask:0xf
    v_pk_add_f32 v[240:241], v[240:241], v[84:85]
    v_subrev_f32_dpp v86, v226, v86 row_newbcast:4 row_mask:0xf bank_mask:0xf
    v_subrev_f32_dpp v87, v227, v87 row_newbcast:4 row_mask:0xf bank_mask:0xf
    v_pk_add_f32 v[240:241], v[240:241], v[86:87]
    v_subrev_f32_dpp v88, v224, v88 row_newbcast:8 row_mask:0xf bank_mask:0xf
    v_subrev_f32_dpp v89, v225, v89 row_newbcast:8 row_mask:0xf bank_mask:0xf
    v_pk_add_f32 v[240:241], v[240:241], v[88:89]
    v_subrev_f32_dpp v90, v226, v90 row_newbcast:8 row_mask:0xf bank_mask:0xf
    v_subrev_f32_dpp v91, v227, v91 row_newbcast:8 row_mask:0xf bank_mask:0xf
    v_pk_add_f32 v[240:241], v[240:241], v[90:91]
    v_subrev_f32_dpp v92, v224, v92 row_newbcast:12 row_mask:0xf bank_mask:0xf
    v_subrev_f32_dpp v93, v225, v93 row_newbcast:12 row_mask:0xf bank_mask:0xf
    v_pk_add_f32 v[240:241], v[240:241], v[92:93]
    v_subrev_f32_dpp v94, v226, v94 row_newbcast:12 row_mask:0xf bank_mask:0xf
    v_subrev_f32_dpp v95, v227, v95 row_newbcast:12 row_mask:0xf bank_mask:0xf
    v_pk_add_f32 v[240:241], v[240:241], v[94:95]
    v_subrev_f32_dpp v96, v224, v96 row_newbcast:0 row_mask:0xf bank_mask:0xf
    v_subrev_f32_dpp v97, v225, v97 row_newbcast:0 row_mask:0xf bank_mask:0xf
    v_subrev_f32_dpp v98, v226, v98 row_newbcast:0 row_mask:0xf bank_mask:0xf
    v_subrev_f32_dpp v99, v227, v99 row_newbcast:0 row_mask:0xf bank_mask:0xf
    v_pk_add_f32 v[242:243], v[96:97], v[98:99]
    v_subrev_f32_dpp v100, v224, v100 row_newbcast:4 row_mask:0xf bank_mask:0xf
    v_subrev_f32_dpp v101, v225, v101 row_newbcast:4 row_mask:0xf bank_mask:0xf
    v_pk_add_f32 v[242:243], v[242:243], v[100:101]
    v_subrev_f32_dpp v102, v226, v102 row_newbcast:4 row_mask:0xf bank_mask:0xf
    v_subrev_f32_dpp v103, v227, v103 row_newbcast:4 row_mask:0xf bank_mask:0xf
    v_pk_add_f32 v[242:243], v[242:243], v[102:103]
    v_subrev_f32_dpp v104, v224, v104 row_newbcast:8 row_mask:0xf bank_mask:0xf
    v_subrev_f32_dpp v105, v225, v105 row_newbcast:8 row_mask:0xf bank_mask:0xf
    v_pk_add_f32 v[242:243], v[242:243], v[104:105]
    v_subrev_f32_dpp v106, v226, v106 row_newbcast:8 row_mask:0xf bank_mask:0xf
    v_subrev_f32_dpp v107, v227, v107 row_newbcast:8 row_mask:0xf bank_mask:0xf
    v_pk_add_f32 v[242:243], v[242:243], v[106:107]
    v_subrev_f32_dpp v108, v224, v108 row_newbcast:12 row_mask:0xf bank_mask:0xf
    v_subrev_f32_dpp v109, v225, v109 row_newbcast:12 row_mask:0xf bank_mask:0xf
    v_pk_add_f32 v[242:243], v[242:243], v[108:109]
    v_subrev_f32_dpp v110, v226, v110 row_newbcast:12 row_mask:0xf bank_mask:0xf
    v_subrev_f32_dpp v111, v227, v111 row_newbcast:12 row_mask:0xf bank_mask:0xf
    v_pk_add_f32 v[242:243], v[242:243], v[110:111]
    v_subrev_f32_dpp v112, v224, v112 row_newbcast:0 row_mask:0xf bank_mask:0xf
    v_subrev_f32_dpp v113, v225, v113 row_newbcast:0 row_mask:0xf bank_mask:0xf
    v_subrev_f32_dpp v114, v226, v114 row_newbcast:0 row_mask:0xf bank_mask:0xf
    v_subrev_f32_dpp v115, v227, v115 row_newbcast:0 row_mask:0xf bank_mask:0xf
    v_pk_add_f32 v[244:245], v[112:113], v[114:115]
    v_subrev_f32_dpp v116, v224, v116 row_newbcast:4 row_mask:0xf bank_mask:0xf
    v_subrev_f32_dpp v117, v225, v117 row_newbcast:4 row_mask:0xf bank_mask:0xf
    v_pk_add_f32 v[244:245], v[244:245], v[116:117]
    v_subrev_f32_dpp v118, v226, v118 row_newbcast:4 row_mask:0xf bank_mask:0xf
    v_subrev_f32_dpp v119, v227, v119 row_newbcast:4 row_mask:0xf bank_mask:0xf
    v_pk_add_f32 v[244:245], v[244:245], v[118:119]
    v_subrev_f32_dpp v120, v224, v120 row_newbcast:8 row_mask:0xf bank_mask:0xf
    v_subrev_f32_dpp v121, v225, v121 row_newbcast:8 row_mask:0xf bank_mask:0xf
    v_pk_add_f32 v[244:245], v[244:245], v[120:121]
    v_subrev_f32_dpp v122, v226, v122 row_newbcast:8 row_mask:0xf bank_mask:0xf
    v_subrev_f32_dpp v123, v227, v123 row_newbcast:8 row_mask:0xf bank_mask:0xf
    v_pk_add_f32 v[244:245], v[244:245], v[122:123]
    v_subrev_f32_dpp v124, v224, v124 row_newbcast:12 row_mask:0xf bank_mask:0xf
    v_subrev_f32_dpp v125, v225, v125 row_newbcast:12 row_mask:0xf bank_mask:0xf
    v_pk_add_f32 v[244:245], v[244:245], v[124:125]
    v_subrev_f32_dpp v126, v226, v126 row_newbcast:12 row_mask:0xf bank_mask:0xf
    v_subrev_f32_dpp v127, v227, v127 row_newbcast:12 row_mask:0xf bank_mask:0xf
    v_pk_add_f32 v[244:245], v[244:245], v[126:127]
    s_waitcnt vmcnt(6)
    s_add_u32 m0, s35, 0
    s_nop 0
    buffer_load_dwordx4 v0, s[16:19], s38 offen offset:0 sc0 sc1 nt lds
    v_mfma_f32_32x32x16_bf16 v[128:143], a[96:99], a[144:147], 0
    v_mfma_f32_32x32x16_bf16 v[144:159], a[96:99], a[168:171], 0
    v_mfma_f32_32x32x16_bf16 v[160:175], a[96:99], a[192:195], 0
    v_mfma_f32_32x32x16_bf16 v[128:143], a[100:103], a[148:151], v[128:143]
    v_mfma_f32_32x32x16_bf16 v[144:159], a[100:103], a[172:175], v[144:159]
    v_mfma_f32_32x32x16_bf16 v[160:175], a[100:103], a[196:199], v[160:175]
    v_mfma_f32_32x32x16_bf16 v[128:143], a[104:107], a[152:155], v[128:143]
    v_mfma_f32_32x32x16_bf16 v[144:159], a[104:107], a[176:179], v[144:159]
    buffer_load_dwordx4 v1, s[16:19], s38 offen offset:1024 sc0 sc1 nt lds
    v_mfma_f32_32x32x16_bf16 v[160:175], a[104:107], a[200:203], v[160:175]
    v_mfma_f32_32x32x16_bf16 v[128:143], a[108:111], a[156:159], v[128:143]
    v_mfma_f32_32x32x16_bf16 v[144:159], a[108:111], a[180:183], v[144:159]
    v_mfma_f32_32x32x16_bf16 v[160:175], a[108:111], a[204:207], v[160:175]
    v_mfma_f32_32x32x16_bf16 v[128:143], a[112:115], a[160:163], v[128:143]
    v_mfma_f32_32x32x16_bf16 v[144:159], a[112:115], a[184:187], v[144:159]
    v_mfma_f32_32x32x16_bf16 v[160:175], a[112:115], a[208:211], v[160:175]
    v_mfma_f32_32x32x16_bf16 v[128:143], a[116:119], a[164:167], v[128:143]
    buffer_load_dwordx4 v2, s[16:19], s38 offen offset:2048 sc0 sc1 nt lds
    v_mfma_f32_32x32x16_bf16 v[144:159], a[116:119], a[188:191], v[144:159]
    v_mfma_f32_32x32x16_bf16 v[160:175], a[116:119], a[212:215], v[160:175]
    s_nop 3
    v_pk_add_f32 v[224:225], v[128:129], v[144:145]
    s_nop 6
    v_pk_add_f32 v[224:225], v[224:225], v[160:161]
    v_pk_add_f32 v[226:227], v[130:131], v[146:147]
    v_pk_add_f32 v[226:227], v[226:227], v[162:163]
    v_pk_add_f32 v[228:229], v[132:133], v[148:149]
    v_pk_add_f32 v[228:229], v[228:229], v[164:165]
    s_add_u32 m0, s35, 3072
    s_nop 0
    buffer_load_dwordx4 v3, s[16:19], s38 offen offset:0 sc0 sc1 nt lds
    v_pk_add_f32 v[230:231], v[134:135], v[150:151]
    v_pk_add_f32 v[230:231], v[230:231], v[166:167]
    v_pk_add_f32 v[232:233], v[136:137], v[152:153]
    v_pk_add_f32 v[232:233], v[232:233], v[168:169]
    v_pk_add_f32 v[234:235], v[138:139], v[154:155]
    v_pk_add_f32 v[234:235], v[234:235], v[170:171]
    v_pk_add_f32 v[236:237], v[140:141], v[156:157]
    v_pk_add_f32 v[236:237], v[236:237], v[172:173]
    buffer_load_dwordx4 v4, s[16:19], s38 offen offset:1024 sc0 sc1 nt lds
    v_pk_add_f32 v[238:239], v[142:143], v[158:159]
    v_pk_add_f32 v[238:239], v[238:239], v[174:175]
    v_add_f32_dpp v224, v224, v224 row_ror:8 row_mask:0xf bank_mask:0x3
    v_add_f32_dpp v225, v225, v225 row_ror:8 row_mask:0xf bank_mask:0x3
    v_add_f32_dpp v226, v226, v226 row_ror:8 row_mask:0xf bank_mask:0x3
    v_add_f32_dpp v224, v232, v232 row_ror:8 row_mask:0xf bank_mask:0xc
    v_add_f32_dpp v225, v233, v233 row_ror:8 row_mask:0xf bank_mask:0xc
    v_add_f32_dpp v226, v234, v234 row_ror:8 row_mask:0xf bank_mask:0xc
    buffer_load_dwordx4 v5, s[16:19], s38 offen offset:2048 sc0 sc1 nt lds
    v_add_f32_dpp v227, v227, v227 row_ror:8 row_mask:0xf bank_mask:0x3
    v_add_f32_dpp v228, v228, v228 row_ror:8 row_mask:0xf bank_mask:0x3
    v_add_f32_dpp v229, v229, v229 row_ror:8 row_mask:0xf bank_mask:0x3
    v_add_f32_dpp v227, v235, v235 row_ror:8 row_mask:0xf bank_mask:0xc
    v_add_f32_dpp v228, v236, v236 row_ror:8 row_mask:0xf bank_mask:0xc
    v_add_f32_dpp v229, v237, v237 row_ror:8 row_mask:0xf bank_mask:0xc
    v_add_f32_dpp v230, v230, v230 row_ror:8 row_mask:0xf bank_mask:0x3
    v_add_f32_dpp v231, v231, v231 row_ror:8 row_mask:0xf bank_mask:0x3
    s_add_u32 m0, s35, 6144
    s_nop 0
    buffer_load_dwordx4 v0, s[16:19], s39 offen offset:0 sc0 sc1 nt lds
    v_add_f32_dpp v224, v224, v224 row_half_mirror row_mask:0xf bank_mask:0x5
    v_add_f32_dpp v230, v238, v238 row_ror:8 row_mask:0xf bank_mask:0xc
    v_add_f32_dpp v231, v239, v239 row_ror:8 row_mask:0xf bank_mask:0xc
    v_add_f32_dpp v224, v228, v228 row_half_mirror row_mask:0xf bank_mask:0xa
    v_add_f32_dpp v225, v225, v225 row_half_mirror row_mask:0xf bank_mask:0x5
    v_add_f32_dpp v226, v226, v226 row_half_mirror row_mask:0xf bank_mask:0x5
    v_add_f32_dpp v227, v227, v227 row_half_mirror row_mask:0xf bank_mask:0x5
    v_add_f32_dpp v225, v229, v229 row_half_mirror row_mask:0xf bank_mask:0xa
    buffer_load_dwordx4 v1, s[16:19], s39 offen offset:1024 sc0 sc1 nt lds
    v_add_f32_dpp v226, v230, v230 row_half_mirror row_mask:0xf bank_mask:0xa
    v_add_f32_dpp v227, v231, v231 row_half_mirror row_mask:0xf bank_mask:0xa
    v_add_f32_dpp v224, v224, v224 quad_perm:[1,0,3,2] row_mask:0xf bank_mask:0xf
    v_add_f32_dpp v225, v225, v225 quad_perm:[1,0,3,2] row_mask:0xf bank_mask:0xf
    v_add_f32_dpp v226, v226, v226 quad_perm:[1,0,3,2] row_mask:0xf bank_mask:0xf
    v_add_f32_dpp v227, v227, v227 quad_perm:[1,0,3,2] row_mask:0xf bank_mask:0xf
    v_add_f32_dpp v224, v224, v224 quad_perm:[2,3,0,1] row_mask:0xf bank_mask:0xf
    v_add_f32_dpp v225, v225, v225 quad_perm:[2,3,0,1] row_mask:0xf bank_mask:0xf
    buffer_load_dwordx4 v2, s[16:19], s39 offen offset:2048 sc0 sc1 nt lds
    v_add_f32_dpp v226, v226, v226 quad_perm:[2,3,0,1] row_mask:0xf bank_mask:0xf
    v_add_f32_dpp v227, v227, v227 quad_perm:[2,3,0,1] row_mask:0xf bank_mask:0xf
    v_mov_b32 v228, v224
    v_mov_b32 v229, v225
    v_mov_b32 v230, v226
    v_permlane16_swap_b32 v224, v228
    v_add_f32 v224, v224, v228
    v_mul_f32 v224, s63, v224
    s_add_u32 m0, s35, 9216
    s_nop 0
    buffer_load_dwordx4 v3, s[16:19], s39 offen offset:0 sc0 sc1 nt lds
    v_permlane16_swap_b32 v225, v229
    v_add_f32 v225, v225, v229
    v_mul_f32 v225, s63, v225
    v_permlane16_swap_b32 v226, v230
    v_add_f32 v226, v226, v230
    v_mul_f32 v226, s63, v226
    v_mov_b32 v231, v227
    v_subrev_f32_dpp v128, v224, v128 row_newbcast:0 row_mask:0xf bank_mask:0xf
    buffer_load_dwordx4 v4, s[16:19], s39 offen offset:1024 sc0 sc1 nt lds
    v_subrev_f32_dpp v129, v225, v129 row_newbcast:0 row_mask:0xf bank_mask:0xf
    v_permlane16_swap_b32 v227, v231
    v_add_f32 v227, v227, v231
    v_mul_f32 v227, s63, v227
    v_pk_add_f32 v[240:241], v[240:241], v[128:129]
    v_subrev_f32_dpp v130, v226, v130 row_newbcast:0 row_mask:0xf bank_mask:0xf
    v_subrev_f32_dpp v131, v227, v131 row_newbcast:0 row_mask:0xf bank_mask:0xf
    v_pk_add_f32 v[240:241], v[240:241], v[130:131]
    buffer_load_dwordx4 v5, s[16:19], s39 offen offset:2048 sc0 sc1 nt lds
    v_subrev_f32_dpp v132, v224, v132 row_newbcast:4 row_mask:0xf bank_mask:0xf
    v_subrev_f32_dpp v133, v225, v133 row_newbcast:4 row_mask:0xf bank_mask:0xf
    v_pk_add_f32 v[240:241], v[240:241], v[132:133]
    v_subrev_f32_dpp v134, v226, v134 row_newbcast:4 row_mask:0xf bank_mask:0xf
    v_subrev_f32_dpp v135, v227, v135 row_newbcast:4 row_mask:0xf bank_mask:0xf
    v_pk_add_f32 v[240:241], v[240:241], v[134:135]
    v_subrev_f32_dpp v136, v224, v136 row_newbcast:8 row_mask:0xf bank_mask:0xf
    v_subrev_f32_dpp v137, v225, v137 row_newbcast:8 row_mask:0xf bank_mask:0xf
    s_mov_b32 s40, s38
    s_add_u32 s36, s36, 256
    s_mul_i32 s42, s36, 43691
    s_lshr_b32 s42, s42, 21
    s_mul_i32 s45, s42, 48
    s_sub_u32 s45, s36, s45
    s_mul_i32 s42, s42, 589824
    s_mul_i32 s45, s45, 1536
    s_add_u32 s38, s42, s45
    s_add_u32 s39, s38, 73728
    s_mov_b32 s41, s38
    s_add_u32 s35, s35, 49152
    v_pk_add_f32 v[240:241], v[240:241], v[136:137]
    v_subrev_f32_dpp v138, v226, v138 row_newbcast:8 row_mask:0xf bank_mask:0xf
    v_subrev_f32_dpp v139, v227, v139 row_newbcast:8 row_mask:0xf bank_mask:0xf
    v_pk_add_f32 v[240:241], v[240:241], v[138:139]
    v_subrev_f32_dpp v140, v224, v140 row_newbcast:12 row_mask:0xf bank_mask:0xf
    v_subrev_f32_dpp v141, v225, v141 row_newbcast:12 row_mask:0xf bank_mask:0xf
    v_pk_add_f32 v[240:241], v[240:241], v[140:141]
    v_subrev_f32_dpp v142, v226, v142 row_newbcast:12 row_mask:0xf bank_mask:0xf
    v_subrev_f32_dpp v143, v227, v143 row_newbcast:12 row_mask:0xf bank_mask:0xf
    v_pk_add_f32 v[240:241], v[240:241], v[142:143]
    v_subrev_f32_dpp v144, v224, v144 row_newbcast:0 row_mask:0xf bank_mask:0xf
    v_subrev_f32_dpp v145, v225, v145 row_newbcast:0 row_mask:0xf bank_mask:0xf
    v_pk_add_f32 v[242:243], v[242:243], v[144:145]
    v_subrev_f32_dpp v146, v226, v146 row_newbcast:0 row_mask:0xf bank_mask:0xf
    v_subrev_f32_dpp v147, v227, v147 row_newbcast:0 row_mask:0xf bank_mask:0xf
    v_pk_add_f32 v[242:243], v[242:243], v[146:147]
    v_subrev_f32_dpp v148, v224, v148 row_newbcast:4 row_mask:0xf bank_mask:0xf
    v_subrev_f32_dpp v149, v225, v149 row_newbcast:4 row_mask:0xf bank_mask:0xf
    v_pk_add_f32 v[242:243], v[242:243], v[148:149]
    v_subrev_f32_dpp v150, v226, v150 row_newbcast:4 row_mask:0xf bank_mask:0xf
    v_subrev_f32_dpp v151, v227, v151 row_newbcast:4 row_mask:0xf bank_mask:0xf
    v_pk_add_f32 v[242:243], v[242:243], v[150:151]
    v_subrev_f32_dpp v152, v224, v152 row_newbcast:8 row_mask:0xf bank_mask:0xf
    v_subrev_f32_dpp v153, v225, v153 row_newbcast:8 row_mask:0xf bank_mask:0xf
    v_pk_add_f32 v[242:243], v[242:243], v[152:153]
    v_subrev_f32_dpp v154, v226, v154 row_newbcast:8 row_mask:0xf bank_mask:0xf
    v_subrev_f32_dpp v155, v227, v155 row_newbcast:8 row_mask:0xf bank_mask:0xf
    v_pk_add_f32 v[242:243], v[242:243], v[154:155]
    v_subrev_f32_dpp v156, v224, v156 row_newbcast:12 row_mask:0xf bank_mask:0xf
    v_subrev_f32_dpp v157, v225, v157 row_newbcast:12 row_mask:0xf bank_mask:0xf
    v_pk_add_f32 v[242:243], v[242:243], v[156:157]
    v_subrev_f32_dpp v158, v226, v158 row_newbcast:12 row_mask:0xf bank_mask:0xf
    v_subrev_f32_dpp v159, v227, v159 row_newbcast:12 row_mask:0xf bank_mask:0xf
    v_pk_add_f32 v[242:243], v[242:243], v[158:159]
    v_subrev_f32_dpp v160, v224, v160 row_newbcast:0 row_mask:0xf bank_mask:0xf
    v_subrev_f32_dpp v161, v225, v161 row_newbcast:0 row_mask:0xf bank_mask:0xf
    v_pk_add_f32 v[244:245], v[244:245], v[160:161]
    v_subrev_f32_dpp v162, v226, v162 row_newbcast:0 row_mask:0xf bank_mask:0xf
    v_subrev_f32_dpp v163, v227, v163 row_newbcast:0 row_mask:0xf bank_mask:0xf
    v_pk_add_f32 v[244:245], v[244:245], v[162:163]
    v_subrev_f32_dpp v164, v224, v164 row_newbcast:4 row_mask:0xf bank_mask:0xf
    v_subrev_f32_dpp v165, v225, v165 row_newbcast:4 row_mask:0xf bank_mask:0xf
    v_pk_add_f32 v[244:245], v[244:245], v[164:165]
    v_subrev_f32_dpp v166, v226, v166 row_newbcast:4 row_mask:0xf bank_mask:0xf
    v_subrev_f32_dpp v167, v227, v167 row_newbcast:4 row_mask:0xf bank_mask:0xf
    v_pk_add_f32 v[244:245], v[244:245], v[166:167]
    v_subrev_f32_dpp v168, v224, v168 row_newbcast:8 row_mask:0xf bank_mask:0xf
    v_subrev_f32_dpp v169, v225, v169 row_newbcast:8 row_mask:0xf bank_mask:0xf
    v_pk_add_f32 v[244:245], v[244:245], v[168:169]
    v_subrev_f32_dpp v170, v226, v170 row_newbcast:8 row_mask:0xf bank_mask:0xf
    v_subrev_f32_dpp v171, v227, v171 row_newbcast:8 row_mask:0xf bank_mask:0xf
    v_pk_add_f32 v[244:245], v[244:245], v[170:171]
    v_subrev_f32_dpp v172, v224, v172 row_newbcast:12 row_mask:0xf bank_mask:0xf
    v_subrev_f32_dpp v173, v225, v173 row_newbcast:12 row_mask:0xf bank_mask:0xf
    v_pk_add_f32 v[244:245], v[244:245], v[172:173]
    v_subrev_f32_dpp v174, v226, v174 row_newbcast:12 row_mask:0xf bank_mask:0xf
    v_subrev_f32_dpp v175, v227, v175 row_newbcast:12 row_mask:0xf bank_mask:0xf
    v_pk_add_f32 v[244:245], v[244:245], v[174:175]
    s_waitcnt vmcnt(12)
    v_mfma_f32_32x32x16_bf16 v[176:191], a[120:123], a[144:147], 0
    v_mfma_f32_32x32x16_bf16 v[192:207], a[120:123], a[168:171], 0
    v_mfma_f32_32x32x16_bf16 v[208:223], a[120:123], a[192:195], 0
    v_mfma_f32_32x32x16_bf16 v[176:191], a[124:127], a[148:151], v[176:191]
    v_mfma_f32_32x32x16_bf16 v[192:207], a[124:127], a[172:175], v[192:207]
    v_mfma_f32_32x32x16_bf16 v[208:223], a[124:127], a[196:199], v[208:223]
    v_mfma_f32_32x32x16_bf16 v[176:191], a[128:131], a[152:155], v[176:191]
    v_mfma_f32_32x32x16_bf16 v[192:207], a[128:131], a[176:179], v[192:207]
    v_mfma_f32_32x32x16_bf16 v[208:223], a[128:131], a[200:203], v[208:223]
    v_mfma_f32_32x32x16_bf16 v[176:191], a[132:135], a[156:159], v[176:191]
    v_mfma_f32_32x32x16_bf16 v[192:207], a[132:135], a[180:183], v[192:207]
    v_mfma_f32_32x32x16_bf16 v[208:223], a[132:135], a[204:207], v[208:223]
    v_mfma_f32_32x32x16_bf16 v[176:191], a[136:139], a[160:163], v[176:191]
    v_mfma_f32_32x32x16_bf16 v[192:207], a[136:139], a[184:187], v[192:207]
    v_mfma_f32_32x32x16_bf16 v[208:223], a[136:139], a[208:211], v[208:223]
    v_mfma_f32_32x32x16_bf16 v[176:191], a[140:143], a[164:167], v[176:191]
    v_mfma_f32_32x32x16_bf16 v[192:207], a[140:143], a[188:191], v[192:207]
    v_mfma_f32_32x32x16_bf16 v[208:223], a[140:143], a[212:215], v[208:223]
    s_nop 3
    v_pk_add_f32 v[238:239], v[190:191], v[206:207]
    s_nop 6
    v_pk_add_f32 v[238:239], v[238:239], v[222:223]
    v_pk_add_f32 v[230:231], v[182:183], v[198:199]
    v_pk_add_f32 v[236:237], v[188:189], v[204:205]
    v_pk_add_f32 v[236:237], v[236:237], v[220:221]
    v_pk_add_f32 v[230:231], v[230:231], v[214:215]
    v_pk_add_f32 v[224:225], v[176:177], v[192:193]
    v_pk_add_f32 v[232:233], v[184:185], v[200:201]
    v_pk_add_f32 v[232:233], v[232:233], v[216:217]
    v_pk_add_f32 v[224:225], v[224:225], v[208:209]
    v_pk_add_f32 v[226:227], v[178:179], v[194:195]
    v_pk_add_f32 v[226:227], v[226:227], v[210:211]
    v_pk_add_f32 v[228:229], v[180:181], v[196:197]
    v_pk_add_f32 v[234:235], v[186:187], v[202:203]
    v_pk_add_f32 v[228:229], v[228:229], v[212:213]
    v_add_f32_dpp v226, v226, v226 row_ror:8 row_mask:0xf bank_mask:0x3
    v_add_f32_dpp v225, v225, v225 row_ror:8 row_mask:0xf bank_mask:0x3
    v_add_f32_dpp v224, v224, v224 row_ror:8 row_mask:0xf bank_mask:0x3
    v_add_f32_dpp v227, v227, v227 row_ror:8 row_mask:0xf bank_mask:0x3
    v_add_f32_dpp v225, v233, v233 row_ror:8 row_mask:0xf bank_mask:0xc
    v_add_f32_dpp v228, v228, v228 row_ror:8 row_mask:0xf bank_mask:0x3
    v_add_f32_dpp v224, v232, v232 row_ror:8 row_mask:0xf bank_mask:0xc
    v_add_f32_dpp v230, v230, v230 row_ror:8 row_mask:0xf bank_mask:0x3
    v_pk_add_f32 v[234:235], v[234:235], v[218:219]
    v_add_f32_dpp v229, v229, v229 row_ror:8 row_mask:0xf bank_mask:0x3
    v_add_f32_dpp v225, v225, v225 row_half_mirror row_mask:0xf bank_mask:0x5
    v_add_f32_dpp v228, v236, v236 row_ror:8 row_mask:0xf bank_mask:0xc
    v_add_f32_dpp v230, v238, v238 row_ror:8 row_mask:0xf bank_mask:0xc
    v_add_f32_dpp v229, v237, v237 row_ror:8 row_mask:0xf bank_mask:0xc
    v_add_f32_dpp v226, v234, v234 row_ror:8 row_mask:0xf bank_mask:0xc
    v_add_f32_dpp v224, v224, v224 row_half_mirror row_mask:0xf bank_mask:0x5
    v_add_f32_dpp v231, v231, v231 row_ror:8 row_mask:0xf bank_mask:0x3
    v_add_f32_dpp v226, v226, v226 row_half_mirror row_mask:0xf bank_mask:0x5
    v_add_f32_dpp v227, v235, v235 row_ror:8 row_mask:0xf bank_mask:0xc
    v_add_f32_dpp v225, v229, v229 row_half_mirror row_mask:0xf bank_mask:0xa
    v_add_f32_dpp v231, v239, v239 row_ror:8 row_mask:0xf bank_mask:0xc
    v_add_f32_dpp v227, v227, v227 row_half_mirror row_mask:0xf bank_mask:0x5
    v_add_f32_dpp v224, v228, v228 row_half_mirror row_mask:0xf bank_mask:0xa
    v_add_f32_dpp v226, v230, v230 row_half_mirror row_mask:0xf bank_mask:0xa
    v_add_f32_dpp v227, v231, v231 row_half_mirror row_mask:0xf bank_mask:0xa
    v_add_f32_dpp v224, v224, v224 quad_perm:[1,0,3,2] row_mask:0xf bank_mask:0xf
    v_add_f32_dpp v225, v225, v225 quad_perm:[1,0,3,2] row_mask:0xf bank_mask:0xf
    v_add_f32_dpp v226, v226, v226 quad_perm:[1,0,3,2] row_mask:0xf bank_mask:0xf
    v_add_f32_dpp v227, v227, v227 quad_perm:[1,0,3,2] row_mask:0xf bank_mask:0xf
    v_add_f32_dpp v224, v224, v224 quad_perm:[2,3,0,1] row_mask:0xf bank_mask:0xf
    v_mov_b32 v228, v224
    v_add_f32_dpp v226, v226, v226 quad_perm:[2,3,0,1] row_mask:0xf bank_mask:0xf
    v_mov_b32 v230, v226
    v_add_f32_dpp v225, v225, v225 quad_perm:[2,3,0,1] row_mask:0xf bank_mask:0xf
    v_mov_b32 v229, v225
    v_add_f32_dpp v227, v227, v227 quad_perm:[2,3,0,1] row_mask:0xf bank_mask:0xf
    v_mov_b32 v231, v227
    v_permlane16_swap_b32 v225, v229
    v_add_f32 v225, v225, v229
    v_mul_f32 v225, s63, v225
    v_permlane16_swap_b32 v226, v230
    v_add_f32 v226, v226, v230
    v_mul_f32 v226, s63, v226
    v_permlane16_swap_b32 v224, v228
    v_add_f32 v224, v224, v228
    v_mul_f32 v224, s63, v224
    v_subrev_f32_dpp v217, v225, v217 row_newbcast:8 row_mask:0xf bank_mask:0xf
    v_subrev_f32_dpp v177, v225, v177 row_newbcast:0 row_mask:0xf bank_mask:0xf
    v_subrev_f32_dpp v200, v224, v200 row_newbcast:8 row_mask:0xf bank_mask:0xf
    v_subrev_f32_dpp v176, v224, v176 row_newbcast:0 row_mask:0xf bank_mask:0xf
    v_pk_add_f32 v[240:241], v[240:241], v[176:177]
    v_subrev_f32_dpp v196, v224, v196 row_newbcast:4 row_mask:0xf bank_mask:0xf
    v_subrev_f32_dpp v181, v225, v181 row_newbcast:4 row_mask:0xf bank_mask:0xf
    v_permlane16_swap_b32 v227, v231
    v_add_f32 v227, v227, v231
    v_mul_f32_e64 v227, s63, v227
    v_subrev_f32_dpp v184, v224, v184 row_newbcast:8 row_mask:0xf bank_mask:0xf
    v_subrev_f32_dpp v213, v225, v213 row_newbcast:4 row_mask:0xf bank_mask:0xf
    v_subrev_f32_dpp v183, v227, v183 row_newbcast:4 row_mask:0xf bank_mask:0xf
    v_subrev_f32_dpp v206, v226, v206 row_newbcast:12 row_mask:0xf bank_mask:0xf
    v_subrev_f32_dpp v201, v225, v201 row_newbcast:8 row_mask:0xf bank_mask:0xf
    v_subrev_f32_dpp v198, v226, v198 row_newbcast:4 row_mask:0xf bank_mask:0xf
    v_subrev_f32_dpp v189, v225, v189 row_newbcast:12 row_mask:0xf bank_mask:0xf
    v_subrev_f32_dpp v178, v226, v178 row_newbcast:0 row_mask:0xf bank_mask:0xf
    v_subrev_f32_dpp v194, v226, v194 row_newbcast:0 row_mask:0xf bank_mask:0xf
    v_subrev_f32_dpp v197, v225, v197 row_newbcast:4 row_mask:0xf bank_mask:0xf
    v_subrev_f32_dpp v179, v227, v179 row_newbcast:0 row_mask:0xf bank_mask:0xf
    v_subrev_f32_dpp v192, v224, v192 row_newbcast:0 row_mask:0xf bank_mask:0xf
    v_subrev_f32_dpp v205, v225, v205 row_newbcast:12 row_mask:0xf bank_mask:0xf
    v_subrev_f32_dpp v182, v226, v182 row_newbcast:4 row_mask:0xf bank_mask:0xf
    v_subrev_f32_dpp v193, v225, v193 row_newbcast:0 row_mask:0xf bank_mask:0xf
    v_pk_add_f32 v[242:243], v[242:243], v[192:193]
    v_pk_add_f32 v[240:241], v[240:241], v[178:179]
    v_subrev_f32_dpp v195, v227, v195 row_newbcast:0 row_mask:0xf bank_mask:0xf
    v_pk_add_f32 v[242:243], v[242:243], v[194:195]
    v_subrev_f32_dpp v180, v224, v180 row_newbcast:4 row_mask:0xf bank_mask:0xf
    v_subrev_f32_dpp v221, v225, v221 row_newbcast:12 row_mask:0xf bank_mask:0xf
    v_subrev_f32_dpp v207, v227, v207 row_newbcast:12 row_mask:0xf bank_mask:0xf
    v_pk_add_f32 v[240:241], v[240:241], v[180:181]
    v_subrev_f32_dpp v190, v226, v190 row_newbcast:12 row_mask:0xf bank_mask:0xf
    v_subrev_f32_dpp v191, v227, v191 row_newbcast:12 row_mask:0xf bank_mask:0xf
    v_pk_add_f32 v[240:241], v[240:241], v[182:183]
    v_subrev_f32_dpp v185, v225, v185 row_newbcast:8 row_mask:0xf bank_mask:0xf
    v_pk_add_f32 v[242:243], v[242:243], v[196:197]
    v_pk_add_f32 v[240:241], v[240:241], v[184:185]
    v_subrev_f32_dpp v187, v227, v187 row_newbcast:8 row_mask:0xf bank_mask:0xf
    v_subrev_f32_dpp v199, v227, v199 row_newbcast:4 row_mask:0xf bank_mask:0xf
    v_subrev_f32_dpp v188, v224, v188 row_newbcast:12 row_mask:0xf bank_mask:0xf
    v_subrev_f32_dpp v186, v226, v186 row_newbcast:8 row_mask:0xf bank_mask:0xf
    v_pk_add_f32 v[240:241], v[240:241], v[186:187]
    v_pk_add_f32 v[240:241], v[240:241], v[188:189]
    v_pk_add_f32 v[242:243], v[242:243], v[198:199]
    v_pk_add_f32 v[242:243], v[242:243], v[200:201]
    v_subrev_f32_dpp v203, v227, v203 row_newbcast:8 row_mask:0xf bank_mask:0xf
    v_subrev_f32_dpp v202, v226, v202 row_newbcast:8 row_mask:0xf bank_mask:0xf
    v_pk_add_f32 v[242:243], v[242:243], v[202:203]
    v_subrev_f32_dpp v204, v224, v204 row_newbcast:12 row_mask:0xf bank_mask:0xf
    v_pk_add_f32 v[242:243], v[242:243], v[204:205]
    v_pk_add_f32 v[240:241], v[240:241], v[190:191]
    v_pk_add_f32 v[242:243], v[242:243], v[206:207]
    v_add_f32 v242, v242, v243
    v_mov_b32 v243, v242
    v_subrev_f32_dpp v216, v224, v216 row_newbcast:8 row_mask:0xf bank_mask:0xf
    v_add_f32 v240, v240, v241
    v_permlane32_swap_b32 v242, v243
    v_add_f32 v242, v242, v243
    v_mul_f32 v242, s72, v242
    v_pk_fma_f32 v[204:205], v[204:205], s[70:71], v[242:243] op_sel_hi:[1,1,0]
    v_pk_fma_f32 v[152:153], v[152:153], s[70:71], v[242:243] op_sel_hi:[1,1,0]
    v_pk_fma_f32 v[196:197], v[196:197], s[70:71], v[242:243] op_sel_hi:[1,1,0]
    v_pk_fma_f32 v[96:97], v[96:97], s[70:71], v[242:243] op_sel_hi:[1,1,0]
    v_pk_fma_f32 v[98:99], v[98:99], s[70:71], v[242:243] op_sel_hi:[1,1,0]
    v_cvt_pk_bf16_f32 v96, v96, v97
    v_pk_fma_f32 v[202:203], v[202:203], s[70:71], v[242:243] op_sel_hi:[1,1,0]
    v_pk_fma_f32 v[192:193], v[192:193], s[70:71], v[242:243] op_sel_hi:[1,1,0]
    v_cvt_pk_bf16_f32 v192, v192, v193
    v_pk_fma_f32 v[198:199], v[198:199], s[70:71], v[242:243] op_sel_hi:[1,1,0]
    v_pk_fma_f32 v[100:101], v[100:101], s[70:71], v[242:243] op_sel_hi:[1,1,0]
    v_pk_fma_f32 v[106:107], v[106:107], s[70:71], v[242:243] op_sel_hi:[1,1,0]
    v_pk_fma_f32 v[194:195], v[194:195], s[70:71], v[242:243] op_sel_hi:[1,1,0]
    v_subrev_f32_dpp v223, v227, v223 row_newbcast:12 row_mask:0xf bank_mask:0xf
    v_cvt_pk_bf16_f32 v193, v194, v195
    v_cvt_pk_bf16_f32 v195, v198, v199
    v_cvt_pk_bf16_f32 v194, v196, v197
    v_pk_fma_f32 v[206:207], v[206:207], s[70:71], v[242:243] op_sel_hi:[1,1,0]
    v_cvt_pk_bf16_f32 v199, v206, v207
    v_subrev_f32_dpp v220, v224, v220 row_newbcast:12 row_mask:0xf bank_mask:0xf
    v_pk_fma_f32 v[102:103], v[102:103], s[70:71], v[242:243] op_sel_hi:[1,1,0]
    v_cvt_pk_bf16_f32 v97, v98, v99
    v_cvt_pk_bf16_f32 v99, v102, v103
    v_pk_fma_f32 v[104:105], v[104:105], s[70:71], v[242:243] op_sel_hi:[1,1,0]
    v_pk_fma_f32 v[144:145], v[144:145], s[70:71], v[242:243] op_sel_hi:[1,1,0]
    v_cvt_pk_bf16_f32 v144, v144, v145
    v_cvt_pk_bf16_f32 v98, v100, v101
    v_cvt_pk_bf16_f32 v100, v104, v105
    v_cvt_pk_bf16_f32 v197, v202, v203
    v_pk_fma_f32 v[146:147], v[146:147], s[70:71], v[242:243] op_sel_hi:[1,1,0]
    v_cvt_pk_bf16_f32 v145, v146, v147
    v_pk_fma_f32 v[154:155], v[154:155], s[70:71], v[242:243] op_sel_hi:[1,1,0]
    v_pk_fma_f32 v[148:149], v[148:149], s[70:71], v[242:243] op_sel_hi:[1,1,0]
    v_subrev_f32_dpp v210, v226, v210 row_newbcast:0 row_mask:0xf bank_mask:0xf
    v_cvt_pk_bf16_f32 v146, v148, v149
    v_subrev_f32_dpp v212, v224, v212 row_newbcast:4 row_mask:0xf bank_mask:0xf
    v_cvt_pk_bf16_f32 v149, v154, v155
    v_cvt_pk_bf16_f32 v148, v152, v153
    v_pk_fma_f32 v[150:151], v[150:151], s[70:71], v[242:243] op_sel_hi:[1,1,0]
    v_subrev_f32_dpp v219, v227, v219 row_newbcast:8 row_mask:0xf bank_mask:0xf
    v_pk_fma_f32 v[158:159], v[158:159], s[70:71], v[242:243] op_sel_hi:[1,1,0]
    v_subrev_f32_dpp v208, v224, v208 row_newbcast:0 row_mask:0xf bank_mask:0xf
    v_subrev_f32_dpp v218, v226, v218 row_newbcast:8 row_mask:0xf bank_mask:0xf
    v_pk_fma_f32 v[156:157], v[156:157], s[70:71], v[242:243] op_sel_hi:[1,1,0]
    v_cvt_pk_bf16_f32 v198, v204, v205
    v_cvt_pk_bf16_f32 v147, v150, v151
    v_subrev_f32_dpp v209, v225, v209 row_newbcast:0 row_mask:0xf bank_mask:0xf
    v_cvt_pk_bf16_f32 v150, v156, v157
    v_pk_fma_f32 v[200:201], v[200:201], s[70:71], v[242:243] op_sel_hi:[1,1,0]
    v_cvt_pk_bf16_f32 v151, v158, v159
    ds_write_b128 v39, v[144:147] offset:8192
    ds_write_b128 v39, v[148:151] offset:9216
    v_pk_add_f32 v[244:245], v[244:245], v[208:209]
    v_cvt_pk_bf16_f32 v196, v200, v201
    v_subrev_f32_dpp v211, v227, v211 row_newbcast:0 row_mask:0xf bank_mask:0xf
    v_pk_add_f32 v[244:245], v[244:245], v[210:211]
    v_pk_add_f32 v[244:245], v[244:245], v[212:213]
    v_subrev_f32_dpp v215, v227, v215 row_newbcast:4 row_mask:0xf bank_mask:0xf
    v_subrev_f32_dpp v214, v226, v214 row_newbcast:4 row_mask:0xf bank_mask:0xf
    v_pk_add_f32 v[244:245], v[244:245], v[214:215]
    v_pk_add_f32 v[244:245], v[244:245], v[216:217]
    v_pk_add_f32 v[244:245], v[244:245], v[218:219]
    v_pk_fma_f32 v[108:109], v[108:109], s[70:71], v[242:243] op_sel_hi:[1,1,0]
    v_cvt_pk_bf16_f32 v102, v108, v109
    v_pk_fma_f32 v[110:111], v[110:111], s[70:71], v[242:243] op_sel_hi:[1,1,0]
    v_cvt_pk_bf16_f32 v103, v110, v111
    v_cvt_pk_bf16_f32 v101, v106, v107
    ds_write_b128 v39, v[96:99] offset:6144
    ds_write_b128 v39, v[100:103] offset:7168
    v_pk_add_f32 v[244:245], v[244:245], v[220:221]
    v_subrev_f32_dpp v222, v226, v222 row_newbcast:12 row_mask:0xf bank_mask:0xf
    v_pk_add_f32 v[244:245], v[244:245], v[222:223]
    v_add_f32 v244, v244, v245
    v_mov_b32 v245, v244
    ds_write_b128 v40, v[192:195] offset:10240
    ds_write_b128 v40, v[196:199] offset:11264
    v_permlane32_swap_b32 v244, v245
    v_add_f32 v244, v244, v245
    v_mul_f32_e64 v244, s72, v244
    v_pk_fma_f32 v[216:217], v[216:217], s[70:71], v[244:245] op_sel_hi:[1,1,0]
    v_pk_fma_f32 v[214:215], v[214:215], s[70:71], v[244:245] op_sel_hi:[1,1,0]
    v_pk_fma_f32 v[112:113], v[112:113], s[70:71], v[244:245] op_sel_hi:[1,1,0]
    v_pk_fma_f32 v[120:121], v[120:121], s[70:71], v[244:245] op_sel_hi:[1,1,0]
    v_pk_fma_f32 v[170:171], v[170:171], s[70:71], v[244:245] op_sel_hi:[1,1,0]
    v_pk_fma_f32 v[222:223], v[222:223], s[70:71], v[244:245] op_sel_hi:[1,1,0]
    v_pk_fma_f32 v[160:161], v[160:161], s[70:71], v[244:245] op_sel_hi:[1,1,0]
    v_cvt_pk_bf16_f32 v160, v160, v161
    v_pk_fma_f32 v[208:209], v[208:209], s[70:71], v[244:245] op_sel_hi:[1,1,0]
    v_cvt_pk_bf16_f32 v208, v208, v209
    v_pk_fma_f32 v[162:163], v[162:163], s[70:71], v[244:245] op_sel_hi:[1,1,0]
    v_pk_fma_f32 v[124:125], v[124:125], s[70:71], v[244:245] op_sel_hi:[1,1,0]
    v_mov_b32_e64 v241, v240
    v_pk_fma_f32 v[210:211], v[210:211], s[70:71], v[244:245] op_sel_hi:[1,1,0]
    v_cvt_pk_bf16_f32 v112, v112, v113
    v_cvt_pk_bf16_f32 v209, v210, v211
    v_pk_fma_f32 v[116:117], v[116:117], s[70:71], v[244:245] op_sel_hi:[1,1,0]
    v_pk_fma_f32 v[220:221], v[220:221], s[70:71], v[244:245] op_sel_hi:[1,1,0]
    v_cvt_pk_bf16_f32 v211, v214, v215
    v_cvt_pk_bf16_f32 v214, v220, v221
    v_permlane32_swap_b32 v240, v241
    v_pk_fma_f32 v[122:123], v[122:123], s[70:71], v[244:245] op_sel_hi:[1,1,0]
    v_add_f32 v240, v240, v241
    v_mul_f32_e64 v240, s72, v240
    v_pk_fma_f32 v[126:127], v[126:127], s[70:71], v[244:245] op_sel_hi:[1,1,0]
    v_pk_fma_f32 v[114:115], v[114:115], s[70:71], v[244:245] op_sel_hi:[1,1,0]
    v_cvt_pk_bf16_f32 v113, v114, v115
    v_pk_fma_f32 v[118:119], v[118:119], s[70:71], v[244:245] op_sel_hi:[1,1,0]
    v_cvt_pk_bf16_f32 v115, v118, v119
    v_cvt_pk_bf16_f32 v119, v126, v127
    v_pk_fma_f32 v[92:93], v[92:93], s[70:71], v[240:241] op_sel_hi:[1,1,0]
    v_pk_fma_f32 v[130:131], v[130:131], s[70:71], v[240:241] op_sel_hi:[1,1,0]
    v_pk_fma_f32 v[188:189], v[188:189], s[70:71], v[240:241] op_sel_hi:[1,1,0]
    v_cvt_pk_bf16_f32 v118, v124, v125
    v_pk_fma_f32 v[218:219], v[218:219], s[70:71], v[244:245] op_sel_hi:[1,1,0]
    v_pk_fma_f32 v[140:141], v[140:141], s[70:71], v[240:241] op_sel_hi:[1,1,0]
    v_pk_fma_f32 v[212:213], v[212:213], s[70:71], v[244:245] op_sel_hi:[1,1,0]
    v_cvt_pk_bf16_f32 v210, v212, v213
    v_cvt_pk_bf16_f32 v213, v218, v219
    v_pk_fma_f32 v[142:143], v[142:143], s[70:71], v[240:241] op_sel_hi:[1,1,0]
    v_pk_fma_f32 v[138:139], v[138:139], s[70:71], v[240:241] op_sel_hi:[1,1,0]
    v_cvt_pk_bf16_f32 v114, v116, v117
    v_cvt_pk_bf16_f32 v116, v120, v121
    v_cvt_pk_bf16_f32 v117, v122, v123
    v_pk_fma_f32 v[90:91], v[90:91], s[70:71], v[240:241] op_sel_hi:[1,1,0]
    v_cvt_pk_bf16_f32 v161, v162, v163
    v_pk_fma_f32 v[164:165], v[164:165], s[70:71], v[244:245] op_sel_hi:[1,1,0]
    v_cvt_pk_bf16_f32 v162, v164, v165
    v_cvt_pk_bf16_f32 v165, v170, v171
    v_pk_fma_f32 v[82:83], v[82:83], s[70:71], v[240:241] op_sel_hi:[1,1,0]
    v_pk_fma_f32 v[94:95], v[94:95], s[70:71], v[240:241] op_sel_hi:[1,1,0]
    v_pk_fma_f32 v[84:85], v[84:85], s[70:71], v[240:241] op_sel_hi:[1,1,0]
    v_pk_fma_f32 v[174:175], v[174:175], s[70:71], v[244:245] op_sel_hi:[1,1,0]
    ds_write_b128 v40, v[116:119] offset:13312
    ds_write_b128 v40, v[112:115] offset:12288
    v_pk_fma_f32 v[168:169], v[168:169], s[70:71], v[244:245] op_sel_hi:[1,1,0]
    v_cvt_pk_bf16_f32 v164, v168, v169
    v_pk_fma_f32 v[128:129], v[128:129], s[70:71], v[240:241] op_sel_hi:[1,1,0]
    v_pk_fma_f32 v[134:135], v[134:135], s[70:71], v[240:241] op_sel_hi:[1,1,0]
    v_cvt_pk_bf16_f32 v128, v128, v129
    v_pk_fma_f32 v[176:177], v[176:177], s[70:71], v[240:241] op_sel_hi:[1,1,0]
    v_cvt_pk_bf16_f32 v129, v130, v131
    v_cvt_pk_bf16_f32 v131, v134, v135
    v_cvt_pk_bf16_f32 v176, v176, v177
    v_cvt_pk_bf16_f32 v135, v142, v143
    v_cvt_pk_bf16_f32 v215, v222, v223
    v_pk_fma_f32 v[182:183], v[182:183], s[70:71], v[240:241] op_sel_hi:[1,1,0]
    v_cvt_pk_bf16_f32 v212, v216, v217
    v_pk_fma_f32 v[132:133], v[132:133], s[70:71], v[240:241] op_sel_hi:[1,1,0]
    v_cvt_pk_bf16_f32 v130, v132, v133
    v_cvt_pk_bf16_f32 v134, v140, v141
    ds_write_b128 v40, v[212:215] offset:17408
    ds_write_b128 v39, v[128:131] offset:2048
    v_pk_fma_f32 v[80:81], v[80:81], s[70:71], v[240:241] op_sel_hi:[1,1,0]
    v_cvt_pk_bf16_f32 v80, v80, v81
    v_cvt_pk_bf16_f32 v81, v82, v83
    v_pk_fma_f32 v[86:87], v[86:87], s[70:71], v[240:241] op_sel_hi:[1,1,0]
    v_cvt_pk_bf16_f32 v83, v86, v87
    v_pk_fma_f32 v[166:167], v[166:167], s[70:71], v[244:245] op_sel_hi:[1,1,0]
    v_cvt_pk_bf16_f32 v163, v166, v167
    v_pk_fma_f32 v[178:179], v[178:179], s[70:71], v[240:241] op_sel_hi:[1,1,0]
    v_cvt_pk_bf16_f32 v167, v174, v175
    v_cvt_pk_bf16_f32 v82, v84, v85
    v_cvt_pk_bf16_f32 v85, v90, v91
    v_pk_fma_f32 v[172:173], v[172:173], s[70:71], v[244:245] op_sel_hi:[1,1,0]
    v_cvt_pk_bf16_f32 v87, v94, v95
    v_pk_fma_f32 v[136:137], v[136:137], s[70:71], v[240:241] op_sel_hi:[1,1,0]
    v_cvt_pk_bf16_f32 v166, v172, v173
    v_pk_fma_f32 v[88:89], v[88:89], s[70:71], v[240:241] op_sel_hi:[1,1,0]
    v_cvt_pk_bf16_f32 v84, v88, v89
    v_cvt_pk_bf16_f32 v86, v92, v93
    ds_write_b128 v40, v[164:167] offset:15360
    ds_write_b128 v40, v[208:211] offset:16384
    v_cvt_pk_bf16_f32 v132, v136, v137
    v_cvt_pk_bf16_f32 v177, v178, v179
    v_cvt_pk_bf16_f32 v179, v182, v183
    ds_write_b128 v39, v[80:83] offset:0
    ds_write_b128 v39, v[84:87] offset:1024
    v_pk_fma_f32 v[180:181], v[180:181], s[70:71], v[240:241] op_sel_hi:[1,1,0]
    v_cvt_pk_bf16_f32 v178, v180, v181
    v_cvt_pk_bf16_f32 v133, v138, v139
    ds_write_b128 v39, v[132:135] offset:3072
    ds_write_b128 v40, v[160:163] offset:14336
    v_cvt_pk_bf16_f32 v182, v188, v189
    v_pk_fma_f32 v[186:187], v[186:187], s[70:71], v[240:241] op_sel_hi:[1,1,0]
    v_pk_fma_f32 v[184:185], v[184:185], s[70:71], v[240:241] op_sel_hi:[1,1,0]
    v_cvt_pk_bf16_f32 v180, v184, v185
    v_pk_fma_f32 v[190:191], v[190:191], s[70:71], v[240:241] op_sel_hi:[1,1,0]
    v_cvt_pk_bf16_f32 v181, v186, v187
    v_cvt_pk_bf16_f32 v183, v190, v191
    ds_write_b128 v39, v[180:183] offset:5120
    ds_write_b128 v39, v[176:179] offset:4096
    s_branch L_bf
L_wf:
    s_mov_b32 s18, 113246208
    s_mov_b32 s19, 0x00020000
    s_mul_i32 s35, s32, 12288
    s_mov_b32 s36, s2
    s_mul_i32 s96, s32, 28311552
    s_mov_b32 s98, 147456
    s_mul_i32 s94, s36, 43691
    s_lshr_b32 s94, s94, 21
    s_mul_i32 s95, s94, 48
    s_sub_u32 s95, s36, s95
    s_mul_i32 s94, s94, 589824
    s_mul_i32 s95, s95, 1536
    s_add_u32 s38, s94, s95
    s_add_u32 s39, s38, 73728
    v_add_u32 v49, 0, v45
    v_mul_u32_u24 v47, 683, v49
    v_lshrrev_b32 v47, 16, v47
    v_mul_u32_u24 v48, 96, v47
    v_sub_u32 v48, v49, v48
    v_xor_b32 v48, v48, v47
    v_xor_b32 v48, s32, v48
    v_lshlrev_b32 v48, 4, v48
    v_mul_lo_u32 v47, v47, s98
    v_add3_u32 v0, v47, v48, s96
    v_xor_b32 v3, 32, v0
    v_add_u32 v3, 294912, v3
    v_add_u32 v49, 64, v45
    v_mul_u32_u24 v47, 683, v49
    v_lshrrev_b32 v47, 16, v47
    v_mul_u32_u24 v48, 96, v47
    v_sub_u32 v48, v49, v48
    v_xor_b32 v48, v48, v47
    v_xor_b32 v48, s32, v48
    v_lshlrev_b32 v48, 4, v48
    v_mul_lo_u32 v47, v47, s98
    v_add3_u32 v1, v47, v48, s96
    v_subrev_u32 v1, 1024, v1
    v_xor_b32 v4, 32, v1
    v_add_u32 v4, 294912, v4
    v_add_u32 v49, 128, v45
    v_mul_u32_u24 v47, 683, v49
    v_lshrrev_b32 v47, 16, v47
    v_mul_u32_u24 v48, 96, v47
    v_sub_u32 v48, v49, v48
    v_xor_b32 v48, v48, v47
    v_xor_b32 v48, s32, v48
    v_lshlrev_b32 v48, 4, v48
    v_mul_lo_u32 v47, v47, s98
    v_add3_u32 v2, v47, v48, s96
    v_subrev_u32 v2, 2048, v2
    v_xor_b32 v5, 32, v2
    v_add_u32 v5, 294912, v5
    s_mov_b32 s65, 49152
    s_mov_b32 s66, 49152
    s_mov_b32 s20, s14
    s_mov_b32 s21, s15
    s_mov_b32 s22, 113246208
    s_mov_b32 s23, 0x00020000
    s_mov_b32 s62, 0xffff0000
    s_mov_b32 s63, 0x3c2aaaab
    s_mov_b32 s64, 0x3dbcbe62
    s_mov_b32 s67, 0x42c00000
    s_mov_b32 s74, 0x42c00000
    s_mov_b32 s75, 0x42c00000
    s_mov_b32 s70, 0x44a9a027
    s_mov_b32 s71, 0x44a9a027
    s_mov_b32 s72, 0xc1622adf
    v_bfe_u32 v47, v46, 2, 2
    v_xor_b32 v47, v47, v43
    v_mul_u32_u24 v48, 192, v46
    v_lshl_add_u32 v48, v47, 4, v48
    v_add_u32 v36, s43, v48
    v_xor_b32 v37, 32, v36
    v_bfe_u32 v47, v45, 2, 2
    v_lshl_add_u32 v47, v43, 3, v47
    v_mul_u32_u24 v47, 192, v47
    v_and_b32 v48, 16, v45
    v_lshl_add_u32 v47, v48, 1, v47
    v_and_b32 v48, 1, v45
    v_lshl_add_u32 v47, v48, 4, v47
    v_and_b32 v48, 2, v45
    v_lshl_add_u32 v47, v48, 2, v47
    v_add_u32 v38, s43, v47
    s_cmp_eq_u32 s33, 0
    s_mov_b32 s96, 124928
    s_mov_b32 s97, 143360
    s_cselect_b32 s94, 49152, s96
    s_cselect_b32 s95, 88064, s96
    s_cselect_b32 s93, 106496, s97
    s_cmp_eq_u32 s34, 0
    s_cselect_b32 s94, s94, s93
    s_cselect_b32 s95, s95, s93
    v_add_u32 v39, s94, v41
    v_add_u32 v40, s95, v41
    v_add_u32 v11, 98304, v41
    v_add_u32 v42, 49152, v41
    v_and_b32 v50, 3, v44
    v_lshrrev_b32 v49, 2, v44
    v_mul_u32_u24 v48, 192, v49
    v_mul_u32_u24 v47, 12288, v50
    s_mul_i32 s96, s32, 1536
    v_add3_u32 v48, v48, v47, s96
    v_xor_b32 v47, v43, v50
    v_xor_b32 v47, s32, v47
    v_lshl_add_u32 v6, v47, 4, v48
    v_xor_b32 v7, 32, v6
    v_mul_u32_u24 v48, 192, v49
    v_mul_u32_u24 v51, 1536, v50
    v_add_u32 v48, v48, v51
    v_lshl_add_u32 v48, v47, 4, v48
    s_mul_i32 s96, s32, 12288
    v_add_u32 v8, s96, v48
    v_xor_b32 v9, 32, v8
    s_mul_i32 s96, s32, 9216
    s_add_u32 s96, s96, 124928
    v_add_u32 v10, s96, v48
    v_xor_b32 v21, 32, v10
    v_add_u32 v18, s96, v41
    v_sub_u32 v48, v49, v43
    v_cmp_eq_u32 s[48:49], 0, v48
    v_cmp_eq_u32 s[50:51], 2, v48
    v_cmp_eq_u32 s[52:53], 4, v48
    v_cmp_eq_u32 s[54:55], 6, v48
    v_cmp_eq_u32 s[56:57], 1, v50
    v_cmp_eq_u32 s[58:59], 2, v50
    v_cmp_eq_u32 s[60:61], 3, v50
    v_bfe_u32 v47, v45, 2, 2
    v_lshlrev_b32 v47, 5, v47
    v_lshl_add_u32 v47, v43, 4, v47
    v_lshl_add_u32 v12, v50, 2, v47
    v_lshrrev_b32 v47, 3, v45
    v_and_b32 v48, 7, v45
    s_mul_i32 s96, s32, 28311552
    v_mul_u32_u24 v47, 73728, v47
    v_lshlrev_b32 v48, 6, v48
    v_add3_u32 v31, v47, v48, s96
    v_and_b32 v47, 1, v45
    v_lshlrev_b32 v47, 4, v47
    v_mov_b32 v48, 0x3f80
    v_lshlrev_b32 v48, v47, v48
    v_cmp_gt_u32 vcc, 2, v50
    v_bfe_u32 v47, v45, 2, 1
    v_bfe_u32 v51, v45, 4, 1
    v_cndmask_b32 v22, 0, v48, vcc
    v_sub_u32 v23, v48, v22
    v_cmp_eq_u32 vcc, v47, v51
    v_mov_b32 v48, 0x3f803f80
    v_bfe_u32 v47, v45, 3, 1
    v_cndmask_b32 v48, 0, v48, vcc
    v_cmp_eq_u32 vcc, 0, v47
    s_nop 1
    v_cndmask_b32 v47, 0, v48, vcc
    v_sub_u32 v48, v48, v47
    v_accvgpr_write_b32 a48, v47
    v_accvgpr_write_b32 a52, v48
    v_accvgpr_write_b32 a49, v47
    v_accvgpr_write_b32 a53, v48
    v_accvgpr_write_b32 a50, v47
    v_accvgpr_write_b32 a54, v48
    v_accvgpr_write_b32 a51, v47
    v_accvgpr_write_b32 a55, v48
    s_barrier
    s_add_u32 m0, s43, 0
    s_nop 0
    buffer_load_dwordx4 v32, s[28:31], s42 offen offset:0 lds
    buffer_load_dwordx4 v33, s[28:31], s42 offen offset:1024 lds
    buffer_load_dwordx4 v34, s[28:31], s42 offen offset:2048 lds
    s_add_u32 m0, s43, 3072
    s_add_u32 s42, s42, s45
    buffer_load_dwordx4 v32, s[28:31], s42 offen offset:0 lds
    buffer_load_dwordx4 v33, s[28:31], s42 offen offset:1024 lds
    buffer_load_dwordx4 v34, s[28:31], s42 offen offset:2048 lds
    s_add_u32 m0, s43, 6144
    s_add_u32 s42, s42, s45
    buffer_load_dwordx4 v32, s[28:31], s42 offen offset:0 lds
    buffer_load_dwordx4 v33, s[28:31], s42 offen offset:1024 lds
    buffer_load_dwordx4 v34, s[28:31], s42 offen offset:2048 lds
    s_add_u32 m0, s43, 9216
    s_add_u32 s42, s42, s45
    buffer_load_dwordx4 v32, s[28:31], s42 offen offset:0 lds
    buffer_load_dwordx4 v33, s[28:31], s42 offen offset:1024 lds
    buffer_load_dwordx4 v34, s[28:31], s42 offen offset:2048 lds
    s_add_u32 m0, s43, 12288
    s_add_u32 s42, s42, s45
    buffer_load_dwordx4 v32, s[28:31], s42 offen offset:0 lds
    buffer_load_dwordx4 v33, s[28:31], s42 offen offset:1024 lds
    buffer_load_dwordx4 v34, s[28:31], s42 offen offset:2048 lds
    s_add_u32 m0, s43, 15360
    s_add_u32 s42, s42, s45
    buffer_load_dwordx4 v32, s[28:31], s42 offen offset:0 lds
    buffer_load_dwordx4 v33, s[28:31], s42 offen offset:1024 lds
    buffer_load_dwordx4 v34, s[28:31], s42 offen offset:2048 lds
    s_add_u32 s42, s44, 0
    buffer_load_dwordx4 a[72:75], v35, s[24:27], s42 offen offset:0
    buffer_load_dwordx4 a[76:79], v35, s[24:27], s42 offen offset:32
    buffer_load_dwordx4 a[80:83], v35, s[24:27], s42 offen offset:64
    buffer_load_dwordx4 a[84:87], v35, s[24:27], s42 offen offset:96
    buffer_load_dwordx4 a[88:91], v35, s[24:27], s42 offen offset:128
    buffer_load_dwordx4 a[92:95], v35, s[24:27], s42 offen offset:160
    s_add_u32 s42, s44, 18432
    buffer_load_dwordx4 a[96:99], v35, s[24:27], s42 offen offset:0
    buffer_load_dwordx4 a[100:103], v35, s[24:27], s42 offen offset:32
    buffer_load_dwordx4 a[104:107], v35, s[24:27], s42 offen offset:64
    buffer_load_dwordx4 a[108:111], v35, s[24:27], s42 offen offset:96
    buffer_load_dwordx4 a[112:115], v35, s[24:27], s42 offen offset:128
    buffer_load_dwordx4 a[116:119], v35, s[24:27], s42 offen offset:160
    s_waitcnt vmcnt(6)
.p2align 5
    s_add_u32 s42, s44, 36864
    buffer_load_dwordx4 a[120:123], v35, s[24:27], s42 offen offset:0
    ds_read_b64_tr_b16 a[144:145], v38 offset:0
    ds_read_b64_tr_b16 a[146:147], v38 offset:768
    ds_read_b64_tr_b16 a[168:169], v38 offset:64
    buffer_load_dwordx4 a[124:127], v35, s[24:27], s42 offen offset:32
    ds_read_b64_tr_b16 a[170:171], v38 offset:832
    ds_read_b64_tr_b16 a[192:193], v38 offset:128
    ds_read_b64_tr_b16 a[194:195], v38 offset:896
    buffer_load_dwordx4 a[128:131], v35, s[24:27], s42 offen offset:64
    ds_read_b64_tr_b16 a[148:149], v38 offset:3072
    ds_read_b64_tr_b16 a[150:151], v38 offset:3840
    ds_read_b64_tr_b16 a[172:173], v38 offset:3136
    buffer_load_dwordx4 a[132:135], v35, s[24:27], s42 offen offset:96
    ds_read_b64_tr_b16 a[174:175], v38 offset:3904
    ds_read_b64_tr_b16 a[196:197], v38 offset:3200
    s_waitcnt lgkmcnt(9)
    buffer_load_dwordx4 a[136:139], v35, s[24:27], s42 offen offset:128
    v_mfma_f32_32x32x16_bf16 v[80:95], a[72:75], a[144:147], 0
    ds_read_b64_tr_b16 a[198:199], v38 offset:3968
    ds_read_b64_tr_b16 a[152:153], v38 offset:6144
    buffer_load_dwordx4 a[140:143], v35, s[24:27], s42 offen offset:160
    s_waitcnt lgkmcnt(9)
    v_mfma_f32_32x32x16_bf16 v[96:111], a[72:75], a[168:171], 0
    ds_read_b64_tr_b16 a[154:155], v38 offset:6912
    ds_read_b64_tr_b16 a[176:177], v38 offset:6208
    s_waitcnt lgkmcnt(9)
    v_mfma_f32_32x32x16_bf16 v[112:127], a[72:75], a[192:195], 0
    ds_read_b64_tr_b16 a[178:179], v38 offset:6976
    ds_read_b64_tr_b16 a[200:201], v38 offset:6272
    s_waitcnt lgkmcnt(9)
    v_mfma_f32_32x32x16_bf16 v[80:95], a[76:79], a[148:151], v[80:95]
    ds_read_b64_tr_b16 a[202:203], v38 offset:7040
    ds_read_b64_tr_b16 a[156:157], v38 offset:9216
    s_waitcnt lgkmcnt(9)
    v_mfma_f32_32x32x16_bf16 v[96:111], a[76:79], a[172:175], v[96:111]
    ds_read_b64_tr_b16 a[158:159], v38 offset:9984
    ds_read_b64_tr_b16 a[180:181], v38 offset:9280
    s_waitcnt lgkmcnt(9)
    v_mfma_f32_32x32x16_bf16 v[112:127], a[76:79], a[196:199], v[112:127]
    ds_read_b64_tr_b16 a[182:183], v38 offset:10048
    ds_read_b64_tr_b16 a[204:205], v38 offset:9344
    s_waitcnt lgkmcnt(9)
    v_mfma_f32_32x32x16_bf16 v[80:95], a[80:83], a[152:155], v[80:95]
    ds_read_b64_tr_b16 a[206:207], v38 offset:10112
    ds_read_b64_tr_b16 a[160:161], v38 offset:12288
    s_waitcnt lgkmcnt(9)
    v_mfma_f32_32x32x16_bf16 v[96:111], a[80:83], a[176:179], v[96:111]
    ds_read_b64_tr_b16 a[162:163], v38 offset:13056
    ds_read_b64_tr_b16 a[184:185], v38 offset:12352
    s_waitcnt lgkmcnt(9)
    v_mfma_f32_32x32x16_bf16 v[112:127], a[80:83], a[200:203], v[112:127]
    ds_read_b64_tr_b16 a[186:187], v38 offset:13120
    ds_read_b64_tr_b16 a[208:209], v38 offset:12416
    s_waitcnt lgkmcnt(9)
    v_mfma_f32_32x32x16_bf16 v[80:95], a[84:87], a[156:159], v[80:95]
    ds_read_b64_tr_b16 a[210:211], v38 offset:13184
    ds_read_b64_tr_b16 a[164:165], v38 offset:15360
    s_waitcnt lgkmcnt(9)
    v_mfma_f32_32x32x16_bf16 v[96:111], a[84:87], a[180:183], v[96:111]
    ds_read_b64_tr_b16 a[166:167], v38 offset:16128
    ds_read_b64_tr_b16 a[188:189], v38 offset:15424
    s_waitcnt lgkmcnt(9)
    v_mfma_f32_32x32x16_bf16 v[112:127], a[84:87], a[204:207], v[112:127]
    ds_read_b64_tr_b16 a[190:191], v38 offset:16192
    ds_read_b64_tr_b16 a[212:213], v38 offset:15488
    s_waitcnt lgkmcnt(9)
    v_mfma_f32_32x32x16_bf16 v[80:95], a[88:91], a[160:163], v[80:95]
    ds_read_b64_tr_b16 a[214:215], v38 offset:16256
    s_waitcnt lgkmcnt(8)
    v_mfma_f32_32x32x16_bf16 v[96:111], a[88:91], a[184:187], v[96:111]
    s_waitcnt lgkmcnt(6)
    v_mfma_f32_32x32x16_bf16 v[112:127], a[88:91], a[208:211], v[112:127]
    s_waitcnt lgkmcnt(4)
    v_mfma_f32_32x32x16_bf16 v[80:95], a[92:95], a[164:167], v[80:95]
    s_waitcnt lgkmcnt(2)
    v_mfma_f32_32x32x16_bf16 v[96:111], a[92:95], a[188:191], v[96:111]
    s_waitcnt lgkmcnt(0)
    v_mfma_f32_32x32x16_bf16 v[112:127], a[92:95], a[212:215], v[112:127]
    v_pk_add_f32 v[240:241], v[80:81], v[82:83]
    v_pk_add_f32 v[240:241], v[240:241], v[84:85]
    v_pk_add_f32 v[240:241], v[240:241], v[86:87]
    v_pk_add_f32 v[240:241], v[240:241], v[88:89]
    v_pk_add_f32 v[240:241], v[240:241], v[90:91]
    v_pk_add_f32 v[242:243], v[96:97], v[98:99]
    v_pk_add_f32 v[240:241], v[240:241], v[92:93]
    v_pk_add_f32 v[242:243], v[242:243], v[100:101]
    v_pk_add_f32 v[240:241], v[240:241], v[94:95]
    v_pk_add_f32 v[242:243], v[242:243], v[102:103]
    v_pk_add_f32 v[242:243], v[242:243], v[104:105]
    v_pk_add_f32 v[242:243], v[242:243], v[106:107]
    v_pk_add_f32 v[244:245], v[112:113], v[114:115]
    v_pk_add_f32 v[242:243], v[242:243], v[108:109]
    v_pk_add_f32 v[244:245], v[244:245], v[116:117]
    v_pk_add_f32 v[242:243], v[242:243], v[110:111]
    v_pk_add_f32 v[244:245], v[244:245], v[118:119]
    v_pk_add_f32 v[244:245], v[244:245], v[120:121]
    v_pk_add_f32 v[244:245], v[244:245], v[122:123]
    v_pk_add_f32 v[244:245], v[244:245], v[124:125]
    v_pk_add_f32 v[244:245], v[244:245], v[126:127]
    s_waitcnt vmcnt(6)
    s_add_u32 m0, s35, 0
    s_nop 0
    buffer_load_dwordx4 v0, s[16:19], s38 offen offset:0 sc0 sc1 nt lds
    v_mfma_f32_32x32x16_bf16 v[128:143], a[96:99], a[144:147], 0
    buffer_load_dwordx4 v1, s[16:19], s38 offen offset:1024 sc0 sc1 nt lds
    v_mfma_f32_32x32x16_bf16 v[144:159], a[96:99], a[168:171], 0
    buffer_load_dwordx4 v2, s[16:19], s38 offen offset:2048 sc0 sc1 nt lds
    v_mfma_f32_32x32x16_bf16 v[160:175], a[96:99], a[192:195], 0
    s_add_u32 m0, s35, 3072
    s_nop 0
    buffer_load_dwordx4 v3, s[16:19], s38 offen offset:0 sc0 sc1 nt lds
    v_mfma_f32_32x32x16_bf16 v[128:143], a[100:103], a[148:151], v[128:143]
    buffer_load_dwordx4 v4, s[16:19], s38 offen offset:1024 sc0 sc1 nt lds
    v_mfma_f32_32x32x16_bf16 v[144:159], a[100:103], a[172:175], v[144:159]
    buffer_load_dwordx4 v5, s[16:19], s38 offen offset:2048 sc0 sc1 nt lds
    v_mfma_f32_32x32x16_bf16 v[160:175], a[100:103], a[196:199], v[160:175]
    s_add_u32 m0, s35, 6144
    s_nop 0
    buffer_load_dwordx4 v0, s[16:19], s39 offen offset:0 sc0 sc1 nt lds
    v_mfma_f32_32x32x16_bf16 v[128:143], a[104:107], a[152:155], v[128:143]
    buffer_load_dwordx4 v1, s[16:19], s39 offen offset:1024 sc0 sc1 nt lds
    v_mfma_f32_32x32x16_bf16 v[144:159], a[104:107], a[176:179], v[144:159]
    buffer_load_dwordx4 v2, s[16:19], s39 offen offset:2048 sc0 sc1 nt lds
    v_mfma_f32_32x32x16_bf16 v[160:175], a[104:107], a[200:203], v[160:175]
    s_add_u32 m0, s35, 9216
    s_nop 0
    buffer_load_dwordx4 v3, s[16:19], s39 offen offset:0 sc0 sc1 nt lds
    v_mfma_f32_32x32x16_bf16 v[128:143], a[108:111], a[156:159], v[128:143]
    buffer_load_dwordx4 v4, s[16:19], s39 offen offset:1024 sc0 sc1 nt lds
    v_mfma_f32_32x32x16_bf16 v[144:159], a[108:111], a[180:183], v[144:159]
    buffer_load_dwordx4 v5, s[16:19], s39 offen offset:2048 sc0 sc1 nt lds
    v_mfma_f32_32x32x16_bf16 v[160:175], a[108:111], a[204:207], v[160:175]
    s_mov_b32 s40, s38
    s_add_u32 s36, s36, 256
    s_mul_i32 s42, s36, 43691
    s_lshr_b32 s42, s42, 21
    s_mul_i32 s45, s42, 48
    s_sub_u32 s45, s36, s45
    s_mul_i32 s42, s42, 589824
    s_mul_i32 s45, s45, 1536
    s_add_u32 s38, s42, s45
    s_add_u32 s39, s38, 73728
    s_mov_b32 s41, s38
    s_add_u32 s35, s35, 49152
    v_mfma_f32_32x32x16_bf16 v[128:143], a[112:115], a[160:163], v[128:143]
    v_mfma_f32_32x32x16_bf16 v[144:159], a[112:115], a[184:187], v[144:159]
    v_mfma_f32_32x32x16_bf16 v[160:175], a[112:115], a[208:211], v[160:175]
    v_mfma_f32_32x32x16_bf16 v[128:143], a[116:119], a[164:167], v[128:143]
    v_mfma_f32_32x32x16_bf16 v[144:159], a[116:119], a[188:191], v[144:159]
    v_mfma_f32_32x32x16_bf16 v[160:175], a[116:119], a[212:215], v[160:175]
    v_pk_add_f32 v[240:241], v[240:241], v[128:129]
    v_pk_add_f32 v[240:241], v[240:241], v[130:131]
    v_pk_add_f32 v[240:241], v[240:241], v[132:133]
    v_pk_add_f32 v[240:241], v[240:241], v[134:135]
    v_pk_add_f32 v[240:241], v[240:241], v[136:137]
    v_pk_add_f32 v[242:243], v[242:243], v[144:145]
    v_pk_add_f32 v[240:241], v[240:241], v[138:139]
    v_pk_add_f32 v[242:243], v[242:243], v[146:147]
    v_pk_add_f32 v[240:241], v[240:241], v[140:141]
    v_pk_add_f32 v[242:243], v[242:243], v[148:149]
    v_pk_add_f32 v[240:241], v[240:241], v[142:143]
    v_pk_add_f32 v[242:243], v[242:243], v[150:151]
    v_pk_add_f32 v[242:243], v[242:243], v[152:153]
    v_pk_add_f32 v[244:245], v[244:245], v[160:161]
    v_pk_add_f32 v[242:243], v[242:243], v[154:155]
    v_pk_add_f32 v[244:245], v[244:245], v[162:163]
    v_pk_add_f32 v[242:243], v[242:243], v[156:157]
    v_pk_add_f32 v[244:245], v[244:245], v[164:165]
    v_pk_add_f32 v[242:243], v[242:243], v[158:159]
    v_pk_add_f32 v[244:245], v[244:245], v[166:167]
    v_pk_add_f32 v[244:245], v[244:245], v[168:169]
    v_pk_add_f32 v[244:245], v[244:245], v[170:171]
    v_pk_add_f32 v[244:245], v[244:245], v[172:173]
    v_pk_add_f32 v[244:245], v[244:245], v[174:175]
    s_waitcnt vmcnt(12)
    v_mfma_f32_32x32x16_bf16 v[176:191], a[120:123], a[144:147], 0
    v_mfma_f32_32x32x16_bf16 v[192:207], a[120:123], a[168:171], 0
    v_mfma_f32_32x32x16_bf16 v[208:223], a[120:123], a[192:195], 0
    v_mfma_f32_32x32x16_bf16 v[176:191], a[124:127], a[148:151], v[176:191]
    v_mfma_f32_32x32x16_bf16 v[192:207], a[124:127], a[172:175], v[192:207]
    v_mfma_f32_32x32x16_bf16 v[208:223], a[124:127], a[196:199], v[208:223]
    v_mfma_f32_32x32x16_bf16 v[176:191], a[128:131], a[152:155], v[176:191]
    v_mfma_f32_32x32x16_bf16 v[192:207], a[128:131], a[176:179], v[192:207]
    v_mfma_f32_32x32x16_bf16 v[208:223], a[128:131], a[200:203], v[208:223]
    v_mfma_f32_32x32x16_bf16 v[176:191], a[132:135], a[156:159], v[176:191]
    v_mfma_f32_32x32x16_bf16 v[192:207], a[132:135], a[180:183], v[192:207]
    v_mfma_f32_32x32x16_bf16 v[208:223], a[132:135], a[204:207], v[208:223]
    v_mfma_f32_32x32x16_bf16 v[176:191], a[136:139], a[160:163], v[176:191]
    v_mfma_f32_32x32x16_bf16 v[192:207], a[136:139], a[184:187], v[192:207]
    v_mfma_f32_32x32x16_bf16 v[208:223], a[136:139], a[208:211], v[208:223]
    v_mfma_f32_32x32x16_bf16 v[176:191], a[140:143], a[164:167], v[176:191]
    v_mfma_f32_32x32x16_bf16 v[192:207], a[140:143], a[188:191], v[192:207]
    v_mfma_f32_32x32x16_bf16 v[208:223], a[140:143], a[212:215], v[208:223]
    s_nop 7
    s_nop 3
    v_pk_add_f32 v[244:245], v[244:245], v[208:209]
    v_pk_add_f32 v[244:245], v[244:245], v[210:211]
    v_pk_add_f32 v[242:243], v[242:243], v[192:193]
    v_pk_add_f32 v[242:243], v[242:243], v[194:195]
    v_pk_add_f32 v[244:245], v[244:245], v[212:213]
    v_pk_add_f32 v[244:245], v[244:245], v[214:215]
    v_pk_add_f32 v[244:245], v[244:245], v[216:217]
    v_pk_add_f32 v[244:245], v[244:245], v[218:219]
    v_pk_add_f32 v[244:245], v[244:245], v[220:221]
    v_pk_add_f32 v[244:245], v[244:245], v[222:223]
    v_pk_add_f32 v[242:243], v[242:243], v[196:197]
    v_pk_add_f32 v[242:243], v[242:243], v[198:199]
    v_pk_add_f32 v[242:243], v[242:243], v[200:201]
    v_pk_add_f32 v[242:243], v[242:243], v[202:203]
    v_pk_add_f32 v[242:243], v[242:243], v[204:205]
    v_pk_add_f32 v[242:243], v[242:243], v[206:207]
    v_add_f32 v242, v242, v243
    v_mov_b32 v243, v242
    v_pk_add_f32 v[240:241], v[240:241], v[176:177]
    v_pk_add_f32 v[240:241], v[240:241], v[178:179]
    v_permlane32_swap_b32 v242, v243
    v_add_f32 v242, v242, v243
    v_mul_f32 v242, -1.0, v242
    v_pk_fma_f32 v[206:207], v[206:207], s[74:75], v[242:243] op_sel_hi:[1,1,0]
    v_pk_fma_f32 v[158:159], v[158:159], s[74:75], v[242:243] op_sel_hi:[1,1,0]
    v_pk_fma_f32 v[192:193], v[192:193], s[74:75], v[242:243] op_sel_hi:[1,1,0]
    v_pk_fma_f32 v[144:145], v[144:145], s[74:75], v[242:243] op_sel_hi:[1,1,0]
    v_cvt_pk_bf16_f32 v144, v144, v145
    v_pk_fma_f32 v[146:147], v[146:147], s[74:75], v[242:243] op_sel_hi:[1,1,0]
    v_pk_fma_f32 v[104:105], v[104:105], s[74:75], v[242:243] op_sel_hi:[1,1,0]
    v_cvt_pk_bf16_f32 v192, v192, v193
    v_pk_fma_f32 v[204:205], v[204:205], s[74:75], v[242:243] op_sel_hi:[1,1,0]
    v_pk_fma_f32 v[98:99], v[98:99], s[74:75], v[242:243] op_sel_hi:[1,1,0]
    v_pk_add_f32 v[240:241], v[240:241], v[180:181]
    v_pk_add_f32 v[240:241], v[240:241], v[182:183]
    v_pk_fma_f32 v[198:199], v[198:199], s[74:75], v[242:243] op_sel_hi:[1,1,0]
    v_pk_fma_f32 v[154:155], v[154:155], s[74:75], v[242:243] op_sel_hi:[1,1,0]
    v_pk_add_f32 v[240:241], v[240:241], v[184:185]
    v_pk_fma_f32 v[102:103], v[102:103], s[74:75], v[242:243] op_sel_hi:[1,1,0]
    v_pk_add_f32 v[240:241], v[240:241], v[186:187]
    v_pk_fma_f32 v[194:195], v[194:195], s[74:75], v[242:243] op_sel_hi:[1,1,0]
    v_pk_fma_f32 v[148:149], v[148:149], s[74:75], v[242:243] op_sel_hi:[1,1,0]
    v_pk_fma_f32 v[100:101], v[100:101], s[74:75], v[242:243] op_sel_hi:[1,1,0]
    v_cvt_pk_bf16_f32 v193, v194, v195
    v_cvt_pk_bf16_f32 v195, v198, v199
    v_pk_fma_f32 v[196:197], v[196:197], s[74:75], v[242:243] op_sel_hi:[1,1,0]
    v_pk_fma_f32 v[96:97], v[96:97], s[74:75], v[242:243] op_sel_hi:[1,1,0]
    v_cvt_pk_bf16_f32 v194, v196, v197
    v_cvt_pk_bf16_f32 v145, v146, v147
    v_cvt_pk_bf16_f32 v96, v96, v97
    v_pk_fma_f32 v[150:151], v[150:151], s[74:75], v[242:243] op_sel_hi:[1,1,0]
    v_cvt_pk_bf16_f32 v147, v150, v151
    v_cvt_pk_bf16_f32 v97, v98, v99
    v_cvt_pk_bf16_f32 v146, v148, v149
    v_pk_fma_f32 v[108:109], v[108:109], s[74:75], v[242:243] op_sel_hi:[1,1,0]
    v_cvt_pk_bf16_f32 v98, v100, v101
    v_pk_fma_f32 v[156:157], v[156:157], s[74:75], v[242:243] op_sel_hi:[1,1,0]
    v_cvt_pk_bf16_f32 v150, v156, v157
    v_pk_fma_f32 v[110:111], v[110:111], s[74:75], v[242:243] op_sel_hi:[1,1,0]
    v_pk_add_f32 v[240:241], v[240:241], v[188:189]
    v_pk_add_f32 v[240:241], v[240:241], v[190:191]
    v_add_f32 v240, v240, v241
    v_cvt_pk_bf16_f32 v151, v158, v159
    v_cvt_pk_bf16_f32 v100, v104, v105
    v_cvt_pk_bf16_f32 v99, v102, v103
    v_cvt_pk_bf16_f32 v103, v110, v111
    v_pk_fma_f32 v[106:107], v[106:107], s[74:75], v[242:243] op_sel_hi:[1,1,0]
    v_mov_b32 v241, v240
    v_cvt_pk_bf16_f32 v102, v108, v109
    v_pk_fma_f32 v[200:201], v[200:201], s[74:75], v[242:243] op_sel_hi:[1,1,0]
    v_permlane32_swap_b32 v240, v241
    v_add_f32 v240, v240, v241
    v_mul_f32_e64 v240, -1.0, v240
    v_pk_fma_f32 v[138:139], v[138:139], s[74:75], v[240:241] op_sel_hi:[1,1,0]
    v_pk_fma_f32 v[178:179], v[178:179], s[74:75], v[240:241] op_sel_hi:[1,1,0]
    v_pk_fma_f32 v[80:81], v[80:81], s[74:75], v[240:241] op_sel_hi:[1,1,0]
    v_pk_fma_f32 v[86:87], v[86:87], s[74:75], v[240:241] op_sel_hi:[1,1,0]
    v_pk_fma_f32 v[142:143], v[142:143], s[74:75], v[240:241] op_sel_hi:[1,1,0]
    v_cvt_pk_bf16_f32 v101, v106, v107
    ds_write_b128 v39, v[100:103] offset:7168
    ds_write_b128 v39, v[96:99] offset:6144
    v_pk_fma_f32 v[130:131], v[130:131], s[74:75], v[240:241] op_sel_hi:[1,1,0]
    v_cvt_pk_bf16_f32 v199, v206, v207
    v_pk_fma_f32 v[188:189], v[188:189], s[74:75], v[240:241] op_sel_hi:[1,1,0]
    v_pk_fma_f32 v[84:85], v[84:85], s[74:75], v[240:241] op_sel_hi:[1,1,0]
    v_cvt_pk_bf16_f32 v149, v154, v155
    v_pk_fma_f32 v[180:181], v[180:181], s[74:75], v[240:241] op_sel_hi:[1,1,0]
    v_pk_fma_f32 v[152:153], v[152:153], s[74:75], v[242:243] op_sel_hi:[1,1,0]
    v_cvt_pk_bf16_f32 v148, v152, v153
    v_pk_fma_f32 v[132:133], v[132:133], s[74:75], v[240:241] op_sel_hi:[1,1,0]
    v_pk_fma_f32 v[190:191], v[190:191], s[74:75], v[240:241] op_sel_hi:[1,1,0]
    ds_write_b128 v39, v[148:151] offset:9216
    ds_write_b128 v39, v[144:147] offset:8192
    v_pk_fma_f32 v[94:95], v[94:95], s[74:75], v[240:241] op_sel_hi:[1,1,0]
    v_pk_fma_f32 v[176:177], v[176:177], s[74:75], v[240:241] op_sel_hi:[1,1,0]
    v_pk_fma_f32 v[92:93], v[92:93], s[74:75], v[240:241] op_sel_hi:[1,1,0]
    v_cvt_pk_bf16_f32 v80, v80, v81
    v_pk_fma_f32 v[82:83], v[82:83], s[74:75], v[240:241] op_sel_hi:[1,1,0]
    v_cvt_pk_bf16_f32 v81, v82, v83
    v_cvt_pk_bf16_f32 v83, v86, v87
    v_cvt_pk_bf16_f32 v82, v84, v85
    v_add_f32 v244, v244, v245
    v_mov_b32 v245, v244
    v_pk_fma_f32 v[202:203], v[202:203], s[74:75], v[242:243] op_sel_hi:[1,1,0]
    v_cvt_pk_bf16_f32 v86, v92, v93
    v_cvt_pk_bf16_f32 v196, v200, v201
    v_pk_fma_f32 v[140:141], v[140:141], s[74:75], v[240:241] op_sel_hi:[1,1,0]
    v_pk_fma_f32 v[128:129], v[128:129], s[74:75], v[240:241] op_sel_hi:[1,1,0]
    v_pk_fma_f32 v[88:89], v[88:89], s[74:75], v[240:241] op_sel_hi:[1,1,0]
    v_pk_fma_f32 v[186:187], v[186:187], s[74:75], v[240:241] op_sel_hi:[1,1,0]
    v_pk_fma_f32 v[182:183], v[182:183], s[74:75], v[240:241] op_sel_hi:[1,1,0]
    v_permlane32_swap_b32 v244, v245
    v_pk_fma_f32 v[90:91], v[90:91], s[74:75], v[240:241] op_sel_hi:[1,1,0]
    v_add_f32 v244, v244, v245
    v_cvt_pk_bf16_f32 v85, v90, v91
    v_cvt_pk_bf16_f32 v84, v88, v89
    v_cvt_pk_bf16_f32 v87, v94, v95
    ds_write_b128 v39, v[84:87] offset:1024
    ds_write_b128 v39, v[80:83] offset:0
    v_cvt_pk_bf16_f32 v128, v128, v129
    v_cvt_pk_bf16_f32 v129, v130, v131
    v_cvt_pk_bf16_f32 v130, v132, v133
    v_cvt_pk_bf16_f32 v197, v202, v203
    v_mul_f32_e64 v244, -1.0, v244
    v_cvt_pk_bf16_f32 v198, v204, v205
    v_pk_fma_f32 v[118:119], v[118:119], s[74:75], v[244:245] op_sel_hi:[1,1,0]
    v_pk_fma_f32 v[210:211], v[210:211], s[74:75], v[244:245] op_sel_hi:[1,1,0]
    v_pk_fma_f32 v[122:123], v[122:123], s[74:75], v[244:245] op_sel_hi:[1,1,0]
    v_pk_fma_f32 v[184:185], v[184:185], s[74:75], v[240:241] op_sel_hi:[1,1,0]
    v_pk_fma_f32 v[222:223], v[222:223], s[74:75], v[244:245] op_sel_hi:[1,1,0]
    ds_write_b128 v40, v[196:199] offset:11264
    ds_write_b128 v40, v[192:195] offset:10240
    v_pk_fma_f32 v[164:165], v[164:165], s[74:75], v[244:245] op_sel_hi:[1,1,0]
    v_cvt_pk_bf16_f32 v176, v176, v177
    v_cvt_pk_bf16_f32 v177, v178, v179
    v_cvt_pk_bf16_f32 v179, v182, v183
    v_cvt_pk_bf16_f32 v182, v188, v189
    v_pk_fma_f32 v[212:213], v[212:213], s[74:75], v[244:245] op_sel_hi:[1,1,0]
    v_cvt_pk_bf16_f32 v178, v180, v181
    v_cvt_pk_bf16_f32 v181, v186, v187
    v_pk_fma_f32 v[208:209], v[208:209], s[74:75], v[244:245] op_sel_hi:[1,1,0]
    v_pk_fma_f32 v[124:125], v[124:125], s[74:75], v[244:245] op_sel_hi:[1,1,0]
    v_pk_fma_f32 v[172:173], v[172:173], s[74:75], v[244:245] op_sel_hi:[1,1,0]
    v_pk_fma_f32 v[126:127], v[126:127], s[74:75], v[244:245] op_sel_hi:[1,1,0]
    v_pk_fma_f32 v[134:135], v[134:135], s[74:75], v[240:241] op_sel_hi:[1,1,0]
    v_pk_fma_f32 v[112:113], v[112:113], s[74:75], v[244:245] op_sel_hi:[1,1,0]
    v_cvt_pk_bf16_f32 v112, v112, v113
    v_cvt_pk_bf16_f32 v208, v208, v209
    v_cvt_pk_bf16_f32 v209, v210, v211
    v_pk_fma_f32 v[114:115], v[114:115], s[74:75], v[244:245] op_sel_hi:[1,1,0]
    v_cvt_pk_bf16_f32 v113, v114, v115
    v_pk_fma_f32 v[136:137], v[136:137], s[74:75], v[240:241] op_sel_hi:[1,1,0]
    v_cvt_pk_bf16_f32 v115, v118, v119
    v_cvt_pk_bf16_f32 v119, v126, v127
    v_cvt_pk_bf16_f32 v210, v212, v213
    v_cvt_pk_bf16_f32 v131, v134, v135
    v_pk_fma_f32 v[116:117], v[116:117], s[74:75], v[244:245] op_sel_hi:[1,1,0]
    v_pk_fma_f32 v[120:121], v[120:121], s[74:75], v[244:245] op_sel_hi:[1,1,0]
    v_cvt_pk_bf16_f32 v183, v190, v191
    v_cvt_pk_bf16_f32 v180, v184, v185
    v_cvt_pk_bf16_f32 v114, v116, v117
    v_cvt_pk_bf16_f32 v135, v142, v143
    v_cvt_pk_bf16_f32 v134, v140, v141
    v_cvt_pk_bf16_f32 v132, v136, v137
    v_cvt_pk_bf16_f32 v133, v138, v139
    ds_write_b128 v39, v[128:131] offset:2048
    ds_write_b128 v39, v[132:135] offset:3072
    v_pk_fma_f32 v[166:167], v[166:167], s[74:75], v[244:245] op_sel_hi:[1,1,0]
    v_pk_fma_f32 v[160:161], v[160:161], s[74:75], v[244:245] op_sel_hi:[1,1,0]
    v_cvt_pk_bf16_f32 v160, v160, v161
    v_pk_fma_f32 v[162:163], v[162:163], s[74:75], v[244:245] op_sel_hi:[1,1,0]
    v_cvt_pk_bf16_f32 v161, v162, v163
    v_cvt_pk_bf16_f32 v162, v164, v165
    v_pk_fma_f32 v[216:217], v[216:217], s[74:75], v[244:245] op_sel_hi:[1,1,0]
    v_cvt_pk_bf16_f32 v212, v216, v217
    v_pk_fma_f32 v[218:219], v[218:219], s[74:75], v[244:245] op_sel_hi:[1,1,0]
    v_cvt_pk_bf16_f32 v163, v166, v167
    ds_write_b128 v40, v[160:163] offset:14336
    ds_write_b128 v40, v[112:115] offset:12288
    v_pk_fma_f32 v[174:175], v[174:175], s[74:75], v[244:245] op_sel_hi:[1,1,0]
    v_pk_fma_f32 v[168:169], v[168:169], s[74:75], v[244:245] op_sel_hi:[1,1,0]
    v_cvt_pk_bf16_f32 v167, v174, v175
    ds_write_b128 v39, v[176:179] offset:4096
    ds_write_b128 v39, v[180:183] offset:5120
    v_pk_fma_f32 v[170:171], v[170:171], s[74:75], v[244:245] op_sel_hi:[1,1,0]
    v_cvt_pk_bf16_f32 v164, v168, v169
    v_pk_fma_f32 v[220:221], v[220:221], s[74:75], v[244:245] op_sel_hi:[1,1,0]
    v_cvt_pk_bf16_f32 v166, v172, v173
    v_cvt_pk_bf16_f32 v165, v170, v171
    v_pk_fma_f32 v[214:215], v[214:215], s[74:75], v[244:245] op_sel_hi:[1,1,0]
    v_cvt_pk_bf16_f32 v211, v214, v215
    v_cvt_pk_bf16_f32 v215, v222, v223
    v_cvt_pk_bf16_f32 v214, v220, v221
    v_cvt_pk_bf16_f32 v213, v218, v219
    ds_write_b128 v40, v[164:167] offset:15360
    ds_write_b128 v40, v[212:215] offset:17408
    v_cvt_pk_bf16_f32 v117, v122, v123
    v_cvt_pk_bf16_f32 v118, v124, v125
    v_cvt_pk_bf16_f32 v116, v120, v121
    ds_write_b128 v40, v[116:119] offset:13312
    ds_write_b128 v40, v[208:211] offset:16384
L_bf:
    s_waitcnt vmcnt(0) lgkmcnt(0)
    s_barrier
.p2align 5
    ds_read_b128 a[0:3], v6 offset:0
    ds_read_b128 a[72:75], v42 offset:0
    ds_read_b128 a[28:31], v7 offset:6144
    ds_read_b128 a[24:27], v6 offset:6144
    ds_read_b128 a[4:7], v7 offset:0
    ds_read_b128 a[76:79], v42 offset:1024
    ds_read_b128 a[96:99], v42 offset:6144
    ds_read_b128 a[84:87], v42 offset:3072
    ds_read_b128 a[104:107], v42 offset:8192
    ds_read_b128 a[8:11], v6 offset:64
    s_waitcnt lgkmcnt(9)
    v_mfma_f32_16x16x32_bf16 v[152:155], a[48:51], a[0:3], 0
    ds_read_b128 a[88:91], v42 offset:4096
    s_waitcnt lgkmcnt(9)
    v_mfma_f32_32x32x16_bf16 v[80:95], a[72:75], a[0:3], 0
    ds_read_b128 a[12:15], v7 offset:64
    ds_read_b128 a[16:19], v6 offset:128
    s_waitcnt lgkmcnt(9)
    v_mfma_f32_4x4x4_16b_bf16 v[148:151], a[24:25], a[24:25], 0
    ds_read_b128 a[80:83], v42 offset:2048
    v_mfma_f32_4x4x4_16b_bf16 v[144:147], a[0:1], a[0:1], 0
    v_mfma_f32_4x4x4_16b_bf16 v[148:151], a[26:27], a[26:27], v[148:151]
    ds_read_b128 a[44:47], v7 offset:6272
    v_mfma_f32_4x4x4_16b_bf16 v[144:147], a[2:3], a[2:3], v[144:147]
    s_waitcnt lgkmcnt(10)
    v_mfma_f32_4x4x4_16b_bf16 v[148:151], a[28:29], a[28:29], v[148:151]
    v_mfma_f32_4x4x4_16b_bf16 v[144:147], a[4:5], a[4:5], v[144:147]
    s_waitcnt lgkmcnt(9)
    v_mfma_f32_4x4x4_16b_bf16 v[148:151], a[30:31], a[30:31], v[148:151]
    ds_read_b128 a[92:95], v42 offset:5120
    v_mfma_f32_4x4x4_16b_bf16 v[144:147], a[6:7], a[6:7], v[144:147]
    ds_read_b128 a[108:111], v42 offset:9216
    v_mfma_f32_32x32x16_bf16 v[80:95], a[76:79], a[4:7], v[80:95]
    ds_read_b128 a[100:103], v42 offset:7168
    ds_read_b128 a[36:39], v7 offset:6208
    v_mfma_f32_32x32x16_bf16 v[96:111], a[72:75], a[24:27], 0
    v_mfma_f32_32x32x16_bf16 v[96:111], a[76:79], a[28:31], v[96:111]
    ds_read_b128 a[40:43], v6 offset:6272
    v_mfma_f32_16x16x32_bf16 v[152:155], a[48:51], a[4:7], v[152:155]
    s_waitcnt lgkmcnt(10)
    ds_read_b128 a[20:23], v7 offset:128
    s_waitcnt lgkmcnt(9)
    v_mfma_f32_16x16x32_bf16 v[152:155], a[48:51], a[8:11], v[152:155]
    s_add_u32 m0, s35, 0
    ds_read_b128 a[32:35], v6 offset:6208
    v_mfma_f32_16x16x32_bf16 v[152:155], a[48:51], a[12:15], v[152:155]
    s_waitcnt lgkmcnt(8)
    ds_read_b128 a[64:67], v11 offset:2048
    v_mfma_f32_32x32x16_bf16 v[80:95], a[80:83], a[8:11], v[80:95]
    s_waitcnt lgkmcnt(5)
    s_barrier
    buffer_load_dwordx4 v2, s[16:19], s38 offen offset:2048 sc0 sc1 nt lds
    v_mfma_f32_32x32x16_bf16 v[128:143], a[96:99], a[24:27], 0
    ds_read_b128 a[56:59], v11 offset:0
    ds_read_b128 a[220:223], v11 offset:54272
    v_mfma_f32_32x32x16_bf16 v[80:95], a[84:87], a[12:15], v[80:95]
    v_mfma_f32_32x32x16_bf16 v[80:95], a[88:91], a[16:19], v[80:95]
    ds_read_b128 a[228:231], v11 offset:56320
    s_waitcnt lgkmcnt(5)
    ds_read_b128 a[244:247], v11 offset:60416
    v_mfma_f32_32x32x16_bf16 v[80:95], a[92:95], a[20:23], v[80:95]
    s_waitcnt lgkmcnt(5)
    buffer_load_dwordx4 v1, s[16:19], s38 offen offset:1024 sc0 sc1 nt lds
    v_mfma_f32_32x32x16_bf16 v[96:111], a[80:83], a[32:35], v[96:111]
    ds_read_b128 a[252:255], v11 offset:62464
    s_nop 2
    v_cvt_pk_bf16_f32 v80, v80, v81
    v_mfma_f32_32x32x16_bf16 v[96:111], a[84:87], a[36:39], v[96:111]
    v_cvt_pk_bf16_f32 v81, v82, v83
    v_mfma_f32_32x32x16_bf16 v[96:111], a[88:91], a[40:43], v[96:111]
    v_cvt_pk_bf16_f32 v83, v86, v87
    v_cvt_pk_bf16_f32 v86, v92, v93
    v_cvt_pk_bf16_f32 v87, v94, v95
    v_cvt_pk_bf16_f32 v82, v84, v85
    v_mfma_f32_32x32x16_bf16 v[96:111], a[92:95], a[44:47], v[96:111]
    ds_read_b128 a[216:219], v11 offset:53248
    buffer_load_dwordx4 v0, s[16:19], s38 offen offset:0 sc0 sc1 nt lds
    s_add_u32 m0, s35, 3072
    v_mfma_f32_16x16x32_bf16 v[152:155], a[48:51], a[16:19], v[152:155]
    v_mfma_f32_16x16x32_bf16 v[152:155], a[48:51], a[20:23], v[152:155]
    v_mfma_f32_32x32x16_bf16 v[128:143], a[100:103], a[28:31], v[128:143]
    ds_read_b128 a[240:243], v11 offset:59392
    v_cvt_pk_bf16_f32 v96, v96, v97
    v_cvt_pk_bf16_f32 v97, v98, v99
    v_cvt_pk_bf16_f32 v99, v102, v103
    v_cvt_pk_bf16_f32 v103, v110, v111
    v_cvt_pk_bf16_f32 v102, v108, v109
    v_mfma_f32_32x32x16_bf16 v[112:127], a[96:99], a[0:3], 0
    ds_read_b128 a[224:227], v11 offset:55296
    v_mfma_f32_32x32x16_bf16 v[128:143], a[104:107], a[32:35], v[128:143]
    buffer_load_dwordx4 v4, s[16:19], s38 offen offset:1024 sc0 sc1 nt lds
    ds_read_b128 a[152:155], v11 offset:36864
    ds_read_b128 a[60:63], v11 offset:1024
    v_mfma_f32_4x4x4_16b_bf16 v[144:147], a[8:9], a[8:9], v[144:147]
    v_mfma_f32_4x4x4_16b_bf16 v[148:151], a[32:33], a[32:33], v[148:151]
    ds_read_b128 a[116:119], v11 offset:27648
    v_mfma_f32_4x4x4_16b_bf16 v[144:147], a[10:11], a[10:11], v[144:147]
    v_mfma_f32_4x4x4_16b_bf16 v[148:151], a[34:35], a[34:35], v[148:151]
    v_cvt_pk_bf16_f32 v85, v90, v91
    v_mfma_f32_4x4x4_16b_bf16 v[144:147], a[12:13], a[12:13], v[144:147]
    v_mfma_f32_4x4x4_16b_bf16 v[148:151], a[36:37], a[36:37], v[148:151]
    ds_read_b128 a[136:139], v11 offset:32768
    v_mfma_f32_4x4x4_16b_bf16 v[144:147], a[14:15], a[14:15], v[144:147]
    v_mfma_f32_4x4x4_16b_bf16 v[148:151], a[38:39], a[38:39], v[148:151]
    ds_read_b128 a[168:171], v11 offset:40960
    v_mfma_f32_4x4x4_16b_bf16 v[144:147], a[16:17], a[16:17], v[144:147]
    v_mfma_f32_4x4x4_16b_bf16 v[148:151], a[40:41], a[40:41], v[148:151]
    v_mfma_f32_4x4x4_16b_bf16 v[144:147], a[18:19], a[18:19], v[144:147]
    ds_read_b128 a[164:167], v11 offset:39936
    v_mfma_f32_4x4x4_16b_bf16 v[148:151], a[42:43], a[42:43], v[148:151]
    v_mfma_f32_4x4x4_16b_bf16 v[144:147], a[20:21], a[20:21], v[144:147]
    v_mfma_f32_4x4x4_16b_bf16 v[148:151], a[44:45], a[44:45], v[148:151]
    v_mfma_f32_4x4x4_16b_bf16 v[144:147], a[22:23], a[22:23], v[144:147]
    v_mfma_f32_4x4x4_16b_bf16 v[148:151], a[46:47], a[46:47], v[148:151]
    ds_read_b128 a[68:71], v11 offset:3072
    v_mfma_f32_16x16x32_bf16 v[152:155], a[52:55], a[24:27], v[152:155]
    v_mfma_f32_32x32x16_bf16 v[112:127], a[100:103], a[4:7], v[112:127]
    buffer_load_dwordx4 v5, s[16:19], s38 offen offset:2048 sc0 sc1 nt lds
    v_mfma_f32_16x16x32_bf16 v[152:155], a[52:55], a[28:31], v[152:155]
    v_cndmask_b32_e64 v148, v148, v149, s[56:57]
    v_cndmask_b32_e64 v148, v148, v150, s[58:59]
    v_mfma_f32_16x16x32_bf16 v[152:155], a[52:55], a[32:35], v[152:155]
    v_mfma_f32_16x16x32_bf16 v[152:155], a[52:55], a[36:39], v[152:155]
    v_cndmask_b32_e64 v144, v144, v145, s[56:57]
    v_cndmask_b32_e64 v144, v144, v146, s[58:59]
    v_mfma_f32_16x16x32_bf16 v[152:155], a[52:55], a[40:43], v[152:155]
    ds_read_b128 a[160:163], v11 offset:38912
    v_cvt_pk_bf16_f32 v84, v88, v89
    v_mfma_f32_16x16x32_bf16 v[152:155], a[52:55], a[44:47], v[152:155]
    v_cvt_pk_bf16_f32 v98, v100, v101
    v_cvt_pk_bf16_f32 v100, v104, v105
    v_mfma_f32_32x32x16_bf16 v[128:143], a[108:111], a[36:39], v[128:143]
    buffer_load_dwordx4 v3, s[16:19], s38 offen offset:0 sc0 sc1 nt lds
    v_mfma_f32_32x32x16_bf16 v[112:127], a[104:107], a[8:11], v[112:127]
    v_cndmask_b32_e64 v148, v148, v151, s[60:61]
    v_cndmask_b32_e64 v144, v144, v147, s[60:61]
    s_add_u32 m0, s35, 6144
    v_fma_f32 v152, -v152, v152, s64
    v_permlane32_swap_b32 v144, v148
    v_mfma_f32_32x32x16_bf16 v[112:127], a[108:111], a[12:15], v[112:127]
    ds_read_b128 a[200:203], v11 offset:49152
    v_add_f32_e64 v144, v144, v148
    s_waitcnt lgkmcnt(15)
    ds_read_b128 a[188:191], v11 offset:46080
    v_mfma_f32_32x32x16_bf16 v[128:143], a[56:59], a[40:43], v[128:143]
    s_waitcnt lgkmcnt(8)
    ds_read_b128 a[156:159], v11 offset:37888
    v_cvt_pk_bf16_f32 v101, v106, v107
    v_mfma_f32_32x32x16_bf16 v[128:143], a[60:63], a[44:47], v[128:143]
    buffer_load_dwordx4 v1, s[16:19], s39 offen offset:1024 sc0 sc1 nt lds
    v_fma_f32 v144, v144, s67, v152
    v_max_f32_e64 v144, s64, v144
    v_rsq_f32_e64 v156, v144
    v_mfma_f32_4x4x4_16b_bf16 v[144:147], a[0:1], v[80:81], 0
    v_mfma_f32_4x4x4_16b_bf16 v[148:151], a[24:25], v[96:97], 0
    s_nop 1
    v_mfma_f32_4x4x4_16b_bf16 v[148:151], a[26:27], v[98:99], v[148:151]
    ds_read_b128 a[236:239], v11 offset:58368
    v_mfma_f32_4x4x4_16b_bf16 v[144:147], a[2:3], v[82:83], v[144:147]
    ds_read_b128 a[112:115], v11 offset:26624
    v_mfma_f32_4x4x4_16b_bf16 v[148:151], a[28:29], v[100:101], v[148:151]
    v_mfma_f32_4x4x4_16b_bf16 v[144:147], a[4:5], v[84:85], v[144:147]
    v_mfma_f32_4x4x4_16b_bf16 v[148:151], a[30:31], v[102:103], v[148:151]
    v_mfma_f32_4x4x4_16b_bf16 v[144:147], a[6:7], v[86:87], v[144:147]
    ds_read_b128 a[124:127], v11 offset:29696
    v_mfma_f32_32x32x16_bf16 v[80:95], a[64:67], a[0:3], 0
    ds_read_b128 a[232:235], v11 offset:57344
    buffer_load_dwordx4 v0, s[16:19], s39 offen offset:0 sc0 sc1 nt lds
    v_mfma_f32_32x32x16_bf16 v[112:127], a[56:59], a[16:19], v[112:127]
    ds_read_b128 a[56:59], v11 offset:4096
    v_cvt_pk_bf16_f32 v128, v128, v129
    v_cvt_pk_bf16_f32 v129, v130, v131
    v_cvt_pk_bf16_f32 v131, v134, v135
    v_cvt_pk_bf16_f32 v135, v142, v143
    v_mfma_f32_32x32x16_bf16 v[112:127], a[60:63], a[20:23], v[112:127]
    ds_read_b128 a[60:63], v11 offset:5120
    v_cvt_pk_bf16_f32 v130, v132, v133
    v_cvt_pk_bf16_f32 v133, v138, v139
    v_cvt_pk_bf16_f32 v132, v136, v137
    v_mfma_f32_32x32x16_bf16 v[96:111], a[64:67], a[24:27], 0
    s_waitcnt lgkmcnt(10)
    ds_read_b128 a[64:67], v11 offset:6144
    v_mfma_f32_32x32x16_bf16 v[96:111], a[68:71], a[28:31], v[96:111]
    buffer_load_dwordx4 v2, s[16:19], s39 offen offset:2048 sc0 sc1 nt lds
    v_mfma_f32_32x32x16_bf16 v[80:95], a[68:71], a[4:7], v[80:95]
    ds_read_b128 a[68:71], v11 offset:7168
    ds_read_b128 a[176:179], v11 offset:43008
    s_waitcnt lgkmcnt(4)
    v_mfma_f32_32x32x16_bf16 v[80:95], a[56:59], a[8:11], v[80:95]
    v_mfma_f32_32x32x16_bf16 v[96:111], a[56:59], a[32:35], v[96:111]
    s_waitcnt lgkmcnt(3)
    ds_read_b128 a[56:59], v11 offset:8192
    v_cvt_pk_bf16_f32 v112, v112, v113
    v_cvt_pk_bf16_f32 v113, v114, v115
    v_cvt_pk_bf16_f32 v115, v118, v119
    v_cvt_pk_bf16_f32 v114, v116, v117
    v_mfma_f32_32x32x16_bf16 v[96:111], a[60:63], a[36:39], v[96:111]
    v_cvt_pk_bf16_f32 v119, v126, v127
    s_waitcnt lgkmcnt(3)
    ds_read_b128 a[132:135], v11 offset:31744
    v_cvt_pk_bf16_f32 v118, v124, v125
    v_mfma_f32_32x32x16_bf16 v[96:111], a[64:67], a[40:43], v[96:111]
    s_add_u32 m0, s35, 9216
    s_nop 0
    buffer_load_dwordx4 v3, s[16:19], s39 offen offset:0 sc0 sc1 nt lds
    s_waitcnt lgkmcnt(3)
    v_mfma_f32_32x32x16_bf16 v[96:111], a[68:71], a[44:47], v[96:111]
    v_cvt_pk_bf16_f32 v117, v122, v123
    v_mfma_f32_32x32x16_bf16 v[80:95], a[60:63], a[12:15], v[80:95]
    v_cvt_pk_bf16_f32 v134, v140, v141
    v_cvt_pk_bf16_f32 v116, v120, v121
    ds_read_b128 a[60:63], v11 offset:9216
    v_mfma_f32_32x32x16_bf16 v[80:95], a[64:67], a[16:19], v[80:95]
    ds_read_b128 a[64:67], v11 offset:10240
    v_cvt_pk_bf16_f32 v96, v96, v97
    v_cvt_pk_bf16_f32 v97, v98, v99
    v_cvt_pk_bf16_f32 v99, v102, v103
    v_cvt_pk_bf16_f32 v102, v108, v109
    v_mfma_f32_32x32x16_bf16 v[80:95], a[68:71], a[20:23], v[80:95]
    buffer_load_dwordx4 v5, s[16:19], s39 offen offset:2048 sc0 sc1 nt lds
    v_cvt_pk_bf16_f32 v98, v100, v101
    v_cvt_pk_bf16_f32 v100, v104, v105
    v_cvt_pk_bf16_f32 v103, v110, v111
    v_mfma_f32_4x4x4_16b_bf16 v[148:151], a[32:33], v[128:129], v[148:151]
    v_mfma_f32_4x4x4_16b_bf16 v[144:147], a[8:9], v[112:113], v[144:147]
    ds_read_b128 a[68:71], v11 offset:11264
    v_mfma_f32_4x4x4_16b_bf16 v[148:151], a[34:35], v[130:131], v[148:151]
    v_cvt_pk_bf16_f32 v101, v106, v107
    v_mfma_f32_4x4x4_16b_bf16 v[144:147], a[10:11], v[114:115], v[144:147]
    v_cvt_pk_bf16_f32 v80, v80, v81
    v_mfma_f32_4x4x4_16b_bf16 v[148:151], a[36:37], v[132:133], v[148:151]
    v_cvt_pk_bf16_f32 v81, v82, v83
    v_mfma_f32_4x4x4_16b_bf16 v[144:147], a[12:13], v[116:117], v[144:147]
    v_cvt_pk_bf16_f32 v82, v84, v85
    v_mfma_f32_4x4x4_16b_bf16 v[148:151], a[38:39], v[134:135], v[148:151]
    v_cvt_pk_bf16_f32 v83, v86, v87
    v_mfma_f32_4x4x4_16b_bf16 v[144:147], a[14:15], v[118:119], v[144:147]
    v_cvt_pk_bf16_f32 v87, v94, v95
    v_mfma_f32_4x4x4_16b_bf16 v[148:151], a[40:41], v[96:97], v[148:151]
    v_cvt_pk_bf16_f32 v85, v90, v91
    v_mfma_f32_4x4x4_16b_bf16 v[144:147], a[16:17], v[80:81], v[144:147]
    v_mfma_f32_4x4x4_16b_bf16 v[148:151], a[42:43], v[98:99], v[148:151]
    v_cvt_pk_bf16_f32 v86, v92, v93
    v_mfma_f32_4x4x4_16b_bf16 v[144:147], a[18:19], v[82:83], v[144:147]
    v_cvt_pk_bf16_f32 v84, v88, v89
    v_mfma_f32_4x4x4_16b_bf16 v[148:151], a[44:45], v[100:101], v[148:151]
    s_nop 0
    v_mfma_f32_4x4x4_16b_bf16 v[144:147], a[20:21], v[84:85], v[144:147]
    v_mfma_f32_4x4x4_16b_bf16 v[148:151], a[46:47], v[102:103], v[148:151]
    s_waitcnt lgkmcnt(4)
    v_mfma_f32_4x4x4_16b_bf16 v[144:147], a[22:23], v[86:87], v[144:147]
    ds_read_b128 a[196:199], v11 offset:48128
    v_mfma_f32_32x32x16_bf16 v[112:127], a[0:3], a[56:59], 0
    buffer_load_dwordx4 v4, s[16:19], s39 offen offset:1024 sc0 sc1 nt lds
    v_mfma_f32_32x32x16_bf16 v[128:143], a[24:27], a[56:59], 0
    v_permlane32_swap_b32 v146, v150
    v_add_f32_e64 v146, v146, v150
    s_waitcnt lgkmcnt(3)
    ds_read_b128 a[56:59], v11 offset:12288
    v_mfma_f32_32x32x16_bf16 v[128:143], a[28:31], a[60:63], v[128:143]
    ds_read_b128 a[140:143], v11 offset:33792
    v_permlane32_swap_b32 v147, v151
    v_mfma_f32_32x32x16_bf16 v[112:127], a[4:7], a[60:63], v[112:127]
    s_waitcnt lgkmcnt(4)
    ds_read_b128 a[60:63], v11 offset:13312
    v_add_f32_e64 v147, v147, v151
    v_permlane32_swap_b32 v145, v149
    v_add_f32_e64 v145, v145, v149
    s_waitcnt lgkmcnt(4)
    v_mfma_f32_32x32x16_bf16 v[112:127], a[8:11], a[64:67], v[112:127]
    v_mfma_f32_32x32x16_bf16 v[112:127], a[12:15], a[68:71], v[112:127]
    v_mul_f32_dpp v147, v156, v147 quad_perm:[3,3,3,3] row_mask:0xf bank_mask:0xf
    v_permlane32_swap_b32 v144, v148
    v_add_f32_e64 v144, v144, v148
    v_mfma_f32_32x32x16_bf16 v[128:143], a[32:35], a[64:67], v[128:143]
    ds_read_b128 a[64:67], v11 offset:14336
    v_mul_f32_dpp v144, v156, v144 quad_perm:[0,0,0,0] row_mask:0xf bank_mask:0xf
    ds_read_b128 a[172:175], v11 offset:41984
    v_mfma_f32_32x32x16_bf16 v[128:143], a[36:39], a[68:71], v[128:143]
    s_waitcnt lgkmcnt(4)
    v_mul_f32_dpp v145, v156, v145 quad_perm:[1,1,1,1] row_mask:0xf bank_mask:0xf
    v_mul_f32_dpp v146, v156, v146 quad_perm:[2,2,2,2] row_mask:0xf bank_mask:0xf
    v_max3_f32 v154, v144, v145, v146
    v_max_f32 v154, v154, v147
    v_mul_f32_e64 v155, v154, v156
    v_fma_f32 v146, v146, v156, -v155
    v_mfma_f32_32x32x16_bf16 v[128:143], a[40:43], a[56:59], v[128:143]
    s_waitcnt lgkmcnt(2)
    ds_read_b128 a[68:71], v11 offset:15360
    v_fma_f32 v144, v144, v156, -v155
    v_fma_f32 v147, v147, v156, -v155
    v_exp_f32 v147, v147
    v_mfma_f32_32x32x16_bf16 v[128:143], a[44:47], a[60:63], v[128:143]
    v_exp_f32 v146, v146
    v_exp_f32 v144, v144
    v_add_f32 v154, v146, v147
    v_mul_f32_dpp v147, v156, v147 quad_perm:[3,3,3,3] row_mask:0xf bank_mask:0xf
    v_mfma_f32_32x32x16_bf16 v[112:127], a[16:19], a[56:59], v[112:127]
    ds_read_b128 a[56:59], v11 offset:16384
    v_fma_f32 v145, v145, v156, -v155
    v_exp_f32 v145, v145
    s_nop 0
    v_add_f32 v157, v144, v145
    v_mfma_f32_32x32x16_bf16 v[112:127], a[20:23], a[60:63], v[112:127]
    s_waitcnt lgkmcnt(3)
    ds_read_b128 a[60:63], v11 offset:17408
    v_mul_f32_dpp v144, v156, v144 quad_perm:[0,0,0,0] row_mask:0xf bank_mask:0xf
    v_add_f32 v157, v157, v154
    v_rcp_f32 v157, v157
    v_mfma_f32_32x32x16_bf16 v[80:95], a[0:3], a[64:67], 0
    v_mul_f32_dpp v145, v156, v145 quad_perm:[1,1,1,1] row_mask:0xf bank_mask:0xf
    v_mul_f32 v145, v145, v157
    v_mul_f32 v144, v144, v157
    v_cvt_pk_bf16_f32 v158, v144, v145
    v_cvt_pk_bf16_f32 v152, v144, v145
    v_mfma_f32_32x32x16_bf16 v[96:111], a[24:27], a[64:67], 0
    s_waitcnt lgkmcnt(2)
    ds_read_b128 a[64:67], v11 offset:18432
    v_cvt_pk_bf16_f32 v112, v112, v113
    v_cvt_pk_bf16_f32 v113, v114, v115
    v_cvt_pk_bf16_f32 v114, v116, v117
    v_cvt_pk_bf16_f32 v116, v120, v121
    v_cvt_pk_bf16_f32 v117, v122, v123
    v_mfma_f32_32x32x16_bf16 v[96:111], a[28:31], a[68:71], v[96:111]
    v_cvt_pk_bf16_f32 v115, v118, v119
    v_cvt_pk_bf16_f32 v118, v124, v125
    v_permlane32_swap_b32 v152, v158
    v_cndmask_b32_e64 v144, 0, v152, s[48:49]
    v_cndmask_b32_e64 v154, 0, v158, s[50:51]
    v_mfma_f32_32x32x16_bf16 v[80:95], a[4:7], a[68:71], v[80:95]
    s_waitcnt lgkmcnt(2)
    ds_read_b128 a[68:71], v11 offset:19456
    v_mul_f32_dpp v146, v156, v146 quad_perm:[2,2,2,2] row_mask:0xf bank_mask:0xf
    v_mul_f32 v146, v146, v157
    v_cvt_pk_bf16_f32 v119, v126, v127
    v_cvt_pk_bf16_f32 v127, v142, v143
    v_mul_f32 v147, v147, v157
    v_mfma_f32_32x32x16_bf16 v[96:111], a[32:35], a[56:59], v[96:111]
    ds_read_b128 a[148:151], v11 offset:35840
    v_cvt_pk_bf16_f32 v121, v130, v131
    v_cvt_pk_bf16_f32 v159, v146, v147
    v_mfma_f32_32x32x16_bf16 v[80:95], a[8:11], a[56:59], v[80:95]
    s_waitcnt lgkmcnt(3)
    ds_read_b128 a[56:59], v11 offset:20480
    v_cvt_pk_bf16_f32 v153, v146, v147
    v_cndmask_b32_e64 v148, 0, v152, s[52:53]
    v_cndmask_b32_e64 v156, 0, v158, s[52:53]
    v_cvt_pk_bf16_f32 v126, v140, v141
    v_cvt_pk_bf16_f32 v124, v136, v137
    v_mfma_f32_32x32x16_bf16 v[80:95], a[12:15], a[60:63], v[80:95]
    ds_read_b128 a[184:187], v11 offset:45056
    v_permlane32_swap_b32 v153, v159
    v_cndmask_b32_e64 v151, 0, v153, s[54:55]
    v_cndmask_b32_e64 v157, 0, v159, s[52:53]
    v_cvt_pk_bf16_f32 v125, v138, v139
    v_cvt_pk_bf16_f32 v122, v132, v133
    v_mfma_f32_4x4x4_16b_bf16 v[136:139], v[22:23], a[4:5], 0
    v_cvt_pk_bf16_f32 v120, v128, v129
    v_mfma_f32_4x4x4_16b_bf16 v[128:131], v[22:23], a[0:1], 0
    v_cvt_pk_bf16_f32 v123, v134, v135
    v_mfma_f32_4x4x4_16b_bf16 v[132:135], v[22:23], a[2:3], 0
    v_mfma_f32_4x4x4_16b_bf16 v[140:143], v[22:23], a[6:7], 0
    v_cndmask_b32_e64 v155, 0, v159, s[50:51]
    v_mfma_f32_32x32x16_bf16 v[96:111], a[36:39], a[60:63], v[96:111]
    s_waitcnt lgkmcnt(4)
    ds_read_b128 a[60:63], v11 offset:21504
    v_cndmask_b32_e64 v146, 0, v152, s[50:51]
    v_mfma_f32_32x32x16_bf16 v[80:95], a[16:19], a[64:67], v[80:95]
    s_waitcnt lgkmcnt(4)
    v_cndmask_b32_e64 v149, 0, v153, s[52:53]
    v_cndmask_b32_e64 v150, 0, v152, s[54:55]
    v_cndmask_b32_e64 v152, 0, v158, s[48:49]
    v_cndmask_b32_e64 v158, 0, v158, s[54:55]
    v_mfma_f32_32x32x16_bf16 v[80:95], a[20:23], a[68:71], v[80:95]
    ds_read_b128 a[248:251], v11 offset:61440
    v_cndmask_b32_e64 v147, 0, v153, s[50:51]
    v_mfma_f32_32x32x16_bf16 v[96:111], a[40:43], a[64:67], v[96:111]
    ds_read_b128 a[64:67], v11 offset:22528
    v_cndmask_b32_e64 v145, 0, v153, s[48:49]
    v_cndmask_b32_e64 v153, 0, v159, s[48:49]
    ds_read_b128 a[120:123], v11 offset:28672
    v_mfma_f32_32x32x16_bf16 v[96:111], a[44:47], a[68:71], v[96:111]
    ds_read_b128 a[68:71], v11 offset:23552
    v_cvt_pk_bf16_f32 v80, v80, v81
    v_cvt_pk_bf16_f32 v81, v82, v83
    v_cvt_pk_bf16_f32 v83, v86, v87
    v_cvt_pk_bf16_f32 v86, v92, v93
    v_cvt_pk_bf16_f32 v87, v94, v95
    v_mfma_f32_32x32x16_bf16 v[128:143], v[112:115], v[144:147], v[128:143]
    v_cvt_pk_bf16_f32 v82, v84, v85
    v_cvt_pk_bf16_f32 v84, v88, v89
    v_cvt_pk_bf16_f32 v85, v90, v91
    s_nop 0
    v_cvt_pk_bf16_f32 v93, v106, v107
    v_cvt_pk_bf16_f32 v92, v104, v105
    v_mfma_f32_32x32x16_bf16 v[128:143], v[116:119], v[148:151], v[128:143]
    v_cvt_pk_bf16_f32 v88, v96, v97
    v_cvt_pk_bf16_f32 v91, v102, v103
    v_cvt_pk_bf16_f32 v95, v110, v111
    v_cvt_pk_bf16_f32 v90, v100, v101
    v_mfma_f32_4x4x4_16b_bf16 v[100:103], v[22:23], a[26:27], 0
    v_cvt_pk_bf16_f32 v89, v98, v99
    v_mfma_f32_4x4x4_16b_bf16 v[96:99], v[22:23], a[24:25], 0
    v_cvt_pk_bf16_f32 v94, v108, v109
    v_mfma_f32_4x4x4_16b_bf16 v[108:111], v[22:23], a[30:31], 0
    v_cndmask_b32_e64 v159, 0, v159, s[54:55]
    v_mfma_f32_4x4x4_16b_bf16 v[104:107], v[22:23], a[28:29], 0
    v_cvt_pk_bf16_f32 v128, v128, v129
    v_cvt_pk_bf16_f32 v129, v130, v131
    s_nop 1
    v_mfma_f32_32x32x16_bf16 v[96:111], v[120:123], v[152:155], v[96:111]
    v_cvt_pk_bf16_f32 v131, v134, v135
    v_cvt_pk_bf16_f32 v134, v140, v141
    v_cvt_pk_bf16_f32 v135, v142, v143
    v_cvt_pk_bf16_f32 v130, v132, v133
    v_mfma_f32_32x32x16_bf16 v[96:111], v[124:127], v[156:159], v[96:111]
    s_waitcnt lgkmcnt(6)
    ds_write_b128 v6, v[128:131] offset:0
    v_mfma_f32_32x32x16_bf16 v[112:127], a[0:3], a[56:59], 0
    s_waitcnt lgkmcnt(5)
    v_cvt_pk_bf16_f32 v132, v136, v137
    v_cvt_pk_bf16_f32 v133, v138, v139
    v_mfma_f32_32x32x16_bf16 v[112:127], a[4:7], a[60:63], v[112:127]
    ds_write_b128 v7, v[132:135] offset:0
    v_mfma_f32_32x32x16_bf16 v[128:143], a[24:27], a[56:59], 0
    v_cvt_pk_bf16_f32 v96, v96, v97
    ds_read_b128 a[56:59], v11 offset:24576
    v_cvt_pk_bf16_f32 v97, v98, v99
    v_cvt_pk_bf16_f32 v99, v102, v103
    v_mfma_f32_32x32x16_bf16 v[128:143], a[28:31], a[60:63], v[128:143]
    s_waitcnt lgkmcnt(5)
    ds_read_b128 a[60:63], v11 offset:25600
    v_mfma_f32_32x32x16_bf16 v[128:143], a[32:35], a[64:67], v[128:143]
    ds_read_b128 a[208:211], v11 offset:51200
    v_cvt_pk_bf16_f32 v98, v100, v101
    v_cvt_pk_bf16_f32 v101, v106, v107
    v_cvt_pk_bf16_f32 v100, v104, v105
    s_waitcnt lgkmcnt(5)
    v_mfma_f32_32x32x16_bf16 v[112:127], a[8:11], a[64:67], v[112:127]
    v_mfma_f32_32x32x16_bf16 v[112:127], a[12:15], a[68:71], v[112:127]
    ds_write_b128 v6, v[96:99] offset:6144
    v_cvt_pk_bf16_f32 v103, v110, v111
    v_mfma_f32_32x32x16_bf16 v[128:143], a[36:39], a[68:71], v[128:143]
    v_cvt_pk_bf16_f32 v102, v108, v109
    s_waitcnt lgkmcnt(3)
    ds_read_b128 a[144:147], v11 offset:34816
    v_mfma_f32_32x32x16_bf16 v[112:127], a[16:19], a[56:59], v[112:127]
    s_waitcnt lgkmcnt(3)
    ds_read_b128 a[180:183], v11 offset:44032
    v_mfma_f32_32x32x16_bf16 v[112:127], a[20:23], a[60:63], v[112:127]
    ds_write_b128 v7, v[100:103] offset:6144
    v_mfma_f32_4x4x4_16b_bf16 v[100:103], v[22:23], a[10:11], 0
    v_mfma_f32_4x4x4_16b_bf16 v[96:99], v[22:23], a[8:9], 0
    v_mfma_f32_4x4x4_16b_bf16 v[108:111], v[22:23], a[14:15], 0
    v_mfma_f32_4x4x4_16b_bf16 v[104:107], v[22:23], a[12:13], 0
    v_cvt_pk_bf16_f32 v112, v112, v113
    v_cvt_pk_bf16_f32 v113, v114, v115
    v_mfma_f32_32x32x16_bf16 v[128:143], a[40:43], a[56:59], v[128:143]
    ds_read_b128 a[192:195], v11 offset:47104
    v_mfma_f32_32x32x16_bf16 v[128:143], a[44:47], a[60:63], v[128:143]
    ds_read_b128 a[204:207], v11 offset:50176
    v_cvt_pk_bf16_f32 v114, v116, v117
    v_cvt_pk_bf16_f32 v117, v122, v123
    ds_read_b128 a[212:215], v11 offset:52224
    v_mfma_f32_32x32x16_bf16 v[96:111], v[80:83], v[144:147], v[96:111]
    v_cvt_pk_bf16_f32 v115, v118, v119
    v_cvt_pk_bf16_f32 v118, v124, v125
    v_cvt_pk_bf16_f32 v116, v120, v121
    s_nop 0
    v_cvt_pk_bf16_f32 v121, v130, v131
    v_cvt_pk_bf16_f32 v119, v126, v127
    v_mfma_f32_32x32x16_bf16 v[96:111], v[84:87], v[148:151], v[96:111]
    v_cvt_pk_bf16_f32 v125, v138, v139
    v_cvt_pk_bf16_f32 v122, v132, v133
    v_cvt_pk_bf16_f32 v120, v128, v129
    v_cvt_pk_bf16_f32 v127, v142, v143
    v_cvt_pk_bf16_f32 v124, v136, v137
    v_cvt_pk_bf16_f32 v126, v140, v141
    v_mfma_f32_4x4x4_16b_bf16 v[136:139], v[22:23], a[36:37], 0
    ds_read_b128 a[128:131], v11 offset:30720
    v_mfma_f32_4x4x4_16b_bf16 v[128:131], v[22:23], a[32:33], 0
    v_cvt_pk_bf16_f32 v123, v134, v135
    v_mfma_f32_4x4x4_16b_bf16 v[80:83], v[22:23], a[16:17], 0
    v_cvt_pk_bf16_f32 v96, v96, v97
    v_mfma_f32_4x4x4_16b_bf16 v[140:143], v[22:23], a[38:39], 0
    v_cvt_pk_bf16_f32 v97, v98, v99
    v_mfma_f32_4x4x4_16b_bf16 v[132:135], v[22:23], a[34:35], 0
    v_cvt_pk_bf16_f32 v98, v100, v101
    v_cvt_pk_bf16_f32 v101, v106, v107
    v_mfma_f32_4x4x4_16b_bf16 v[84:87], v[22:23], a[18:19], 0
    v_cvt_pk_bf16_f32 v100, v104, v105
    v_mfma_f32_4x4x4_16b_bf16 v[104:107], v[22:23], a[44:45], 0
    v_cvt_pk_bf16_f32 v99, v102, v103
    v_mfma_f32_32x32x16_bf16 v[128:143], v[88:91], v[152:155], v[128:143]
    ds_write_b128 v6, v[96:99] offset:64
    v_cvt_pk_bf16_f32 v102, v108, v109
    v_mfma_f32_32x32x16_bf16 v[128:143], v[92:95], v[156:159], v[128:143]
    v_cvt_pk_bf16_f32 v103, v110, v111
    ds_write_b128 v7, v[100:103] offset:64
    v_mfma_f32_4x4x4_16b_bf16 v[100:103], v[22:23], a[42:43], 0
    v_mfma_f32_4x4x4_16b_bf16 v[92:95], v[22:23], a[22:23], 0
    v_mfma_f32_4x4x4_16b_bf16 v[108:111], v[22:23], a[46:47], 0
    v_cvt_pk_bf16_f32 v128, v128, v129
    v_mfma_f32_4x4x4_16b_bf16 v[88:91], v[22:23], a[20:21], 0
    v_cvt_pk_bf16_f32 v129, v130, v131
    v_cvt_pk_bf16_f32 v131, v134, v135
    v_mfma_f32_4x4x4_16b_bf16 v[96:99], v[22:23], a[40:41], 0
    v_cvt_pk_bf16_f32 v130, v132, v133
    v_cvt_pk_bf16_f32 v133, v138, v139
    v_mfma_f32_32x32x16_bf16 v[80:95], v[112:115], v[144:147], v[80:95]
    ds_write_b128 v6, v[128:131] offset:6208
    v_cvt_pk_bf16_f32 v132, v136, v137
    v_cvt_pk_bf16_f32 v135, v142, v143
    v_cvt_pk_bf16_f32 v134, v140, v141
    v_mfma_f32_32x32x16_bf16 v[80:95], v[116:119], v[148:151], v[80:95]
    ds_write_b128 v7, v[132:135] offset:6208
    v_mfma_f32_32x32x16_bf16 v[96:111], v[120:123], v[152:155], v[96:111]
    s_nop 3
    v_cvt_pk_bf16_f32 v80, v80, v81
    v_cvt_pk_bf16_f32 v81, v82, v83
    v_cvt_pk_bf16_f32 v83, v86, v87
    v_cvt_pk_bf16_f32 v82, v84, v85
    v_mfma_f32_32x32x16_bf16 v[96:111], v[124:127], v[156:159], v[96:111]
    ds_write_b128 v6, v[80:83] offset:128
    v_cvt_pk_bf16_f32 v86, v92, v93
    v_cvt_pk_bf16_f32 v87, v94, v95
    v_cvt_pk_bf16_f32 v84, v88, v89
    v_cvt_pk_bf16_f32 v85, v90, v91
    ds_write_b128 v7, v[84:87] offset:128
    s_nop 5
    v_cvt_pk_bf16_f32 v96, v96, v97
    v_cvt_pk_bf16_f32 v97, v98, v99
    v_cvt_pk_bf16_f32 v98, v100, v101
    v_cvt_pk_bf16_f32 v99, v102, v103
    ds_write_b128 v6, v[96:99] offset:6272
    v_cvt_pk_bf16_f32 v101, v106, v107
    v_cvt_pk_bf16_f32 v103, v110, v111
    v_cvt_pk_bf16_f32 v102, v108, v109
    v_cvt_pk_bf16_f32 v100, v104, v105
    ds_write_b128 v7, v[100:103] offset:6272
    v_add_u32 v7, s65, v7
    v_add_u32 v6, s65, v6
    s_sub_u32 s65, 0, s65
    s_sub_u32 s35, s35, 49152
    s_waitcnt vmcnt(0) lgkmcnt(0)
    s_barrier
    ds_read_b128 v[32:35], v8 offset:0
    s_add_u32 s36, s36, 256
    s_mul_i32 s42, s36, 43691
    ds_read_b128 a[36:39], v7 offset:6208
    ds_read_b128 v[36:39], v9 offset:0
    ds_read_b128 v[40:43], v8 offset:64
    ds_read_b128 v[44:47], v9 offset:64
    s_lshr_b32 s42, s42, 21
    s_mul_i32 s43, s42, 48
    s_sub_u32 s43, s36, s43
    s_mul_i32 s42, s42, 589824
    ds_read_b128 v[52:55], v9 offset:128
    ds_read_b128 v[48:51], v8 offset:128
    s_mul_i32 s43, s43, 1536
    ds_read_b128 v[56:59], v8 offset:6144
    ds_read_b128 a[40:43], v6 offset:6272
    ds_read_b128 v[60:63], v9 offset:6144
    s_waitcnt lgkmcnt(9)
    v_mfma_f32_32x32x16_bf16 v[192:207], a[160:163], v[32:35], 0
    s_waitcnt lgkmcnt(7)
    v_mfma_f32_32x32x16_bf16 v[192:207], a[164:167], v[36:39], v[192:207]
    ds_read_b128 v[68:71], v9 offset:6208
    s_waitcnt lgkmcnt(7)
    ds_read_b128 a[24:27], v6 offset:6144
    s_add_u32 s38, s42, s43
    v_mfma_f32_32x32x16_bf16 v[192:207], a[168:171], v[40:43], v[192:207]
    s_cmp_lt_u32 s36, 2304
    s_cselect_b32 s38, s38, 0x80000000
    ds_read_b128 a[20:23], v7 offset:128
    v_mfma_f32_16x16x32_bf16 v[248:251], a[48:51], v[32:35], 0
    v_mfma_f32_16x16x32_bf16 v[248:251], a[48:51], v[36:39], v[248:251]
    s_waitcnt lgkmcnt(6)
    v_mfma_f32_16x16x32_bf16 v[248:251], a[48:51], v[40:43], v[248:251]
    s_add_u32 s39, s38, 73728
    s_add_u32 m0, s35, 0
    ds_read_b128 a[0:3], v6 offset:0
    v_mfma_f32_32x32x16_bf16 v[160:175], a[112:115], v[32:35], 0
    buffer_load_dwordx4 v1, s[16:19], s38 offen offset:1024 sc0 sc1 nt lds
    ds_read_b128 a[4:7], v7 offset:0
    v_mfma_f32_32x32x16_bf16 v[176:191], a[136:139], v[32:35], 0
    v_mfma_f32_32x32x16_bf16 v[160:175], a[116:119], v[36:39], v[160:175]
    v_mfma_f32_32x32x16_bf16 v[160:175], a[120:123], v[40:43], v[160:175]
    ds_read_b128 a[28:31], v7 offset:6144
    v_mfma_f32_32x32x16_bf16 v[192:207], a[172:175], v[44:47], v[192:207]
    v_mfma_f32_32x32x16_bf16 v[192:207], a[176:179], v[48:51], v[192:207]
    v_mfma_f32_32x32x16_bf16 v[192:207], a[180:183], v[52:55], v[192:207]
    s_mov_b32 s44, s40
    s_waitcnt lgkmcnt(4)
    buffer_load_dwordx4 v0, s[16:19], s38 offen offset:0 sc0 sc1 nt lds
    v_mfma_f32_32x32x16_bf16 v[128:143], a[96:99], a[24:27], 0
    v_mfma_f32_32x32x16_bf16 v[176:191], a[140:143], v[36:39], v[176:191]
    v_mfma_f32_32x32x16_bf16 v[176:191], a[144:147], v[40:43], v[176:191]
    v_mfma_f32_32x32x16_bf16 v[176:191], a[148:151], v[44:47], v[176:191]
    v_mfma_f32_32x32x16_bf16 v[176:191], a[152:155], v[48:51], v[176:191]
    s_waitcnt lgkmcnt(2)
    v_mfma_f32_32x32x16_bf16 v[176:191], a[156:159], v[52:55], v[176:191]
    v_mfma_f32_32x32x16_bf16 v[80:95], a[72:75], a[0:3], 0
    buffer_load_dwordx4 v2, s[16:19], s38 offen offset:2048 sc0 sc1 nt lds
    ds_read_b128 v[64:67], v8 offset:6208
    s_waitcnt lgkmcnt(2)
    v_mfma_f32_16x16x32_bf16 v[152:155], a[48:51], a[0:3], 0
    s_waitcnt lgkmcnt(1)
    v_mfma_f32_16x16x32_bf16 v[152:155], a[48:51], a[4:7], v[152:155]
    v_mfma_f32_32x32x16_bf16 v[128:143], a[100:103], a[28:31], v[128:143]
    ds_read_b128 a[32:35], v6 offset:6208
    ds_read_b128 a[60:63], v11 offset:1024
    v_mfma_f32_32x32x16_bf16 v[80:95], a[76:79], a[4:7], v[80:95]
    v_mfma_f32_32x32x16_bf16 v[160:175], a[124:127], v[44:47], v[160:175]
    v_mfma_f32_32x32x16_bf16 v[160:175], a[128:131], v[48:51], v[160:175]
    ds_read_b128 a[8:11], v6 offset:64
    v_mfma_f32_32x32x16_bf16 v[112:127], a[96:99], a[0:3], 0
    ds_read_b128 a[12:15], v7 offset:64
    v_cvt_pk_bf16_f32 v221, v186, v187
    s_add_u32 m0, s35, 3072
    v_mfma_f32_32x32x16_bf16 v[160:175], a[132:135], v[52:55], v[160:175]
    v_cvt_pk_bf16_f32 v231, v206, v207
    buffer_load_dwordx4 v5, s[16:19], s38 offen offset:2048 sc0 sc1 nt lds
    v_mfma_f32_4x4x4_16b_bf16 v[144:147], a[0:1], a[0:1], 0
    v_mfma_f32_4x4x4_16b_bf16 v[244:247], v[56:57], v[56:57], 0
    v_mfma_f32_4x4x4_16b_bf16 v[148:151], a[24:25], a[24:25], 0
    v_mfma_f32_4x4x4_16b_bf16 v[240:243], v[32:33], v[32:33], 0
    ds_read_b128 v[72:75], v8 offset:6272
    v_mfma_f32_4x4x4_16b_bf16 v[244:247], v[58:59], v[58:59], v[244:247]
    ds_read_b128 a[44:47], v7 offset:6272
    v_mfma_f32_4x4x4_16b_bf16 v[240:243], v[34:35], v[34:35], v[240:243]
    v_mfma_f32_4x4x4_16b_bf16 v[148:151], a[26:27], a[26:27], v[148:151]
    v_mfma_f32_4x4x4_16b_bf16 v[144:147], a[2:3], a[2:3], v[144:147]
    v_mfma_f32_4x4x4_16b_bf16 v[148:151], a[28:29], a[28:29], v[148:151]
    v_mfma_f32_4x4x4_16b_bf16 v[144:147], a[4:5], a[4:5], v[144:147]
    v_mfma_f32_4x4x4_16b_bf16 v[240:243], v[36:37], v[36:37], v[240:243]
    v_mfma_f32_4x4x4_16b_bf16 v[244:247], v[60:61], v[60:61], v[244:247]
    v_mfma_f32_4x4x4_16b_bf16 v[240:243], v[38:39], v[38:39], v[240:243]
    v_cvt_pk_bf16_f32 v217, v178, v179
    v_mfma_f32_4x4x4_16b_bf16 v[244:247], v[62:63], v[62:63], v[244:247]
    s_waitcnt lgkmcnt(6)
    v_mfma_f32_4x4x4_16b_bf16 v[148:151], a[30:31], a[30:31], v[148:151]
    s_waitcnt lgkmcnt(5)
    v_mfma_f32_4x4x4_16b_bf16 v[244:247], v[64:65], v[64:65], v[244:247]
    ds_read_b128 v[76:79], v9 offset:6272
    v_mfma_f32_4x4x4_16b_bf16 v[148:151], a[32:33], a[32:33], v[148:151]
    ds_read_b128 a[16:19], v6 offset:128
    v_mfma_f32_4x4x4_16b_bf16 v[144:147], a[6:7], a[6:7], v[144:147]
    v_cvt_pk_bf16_f32 v218, v180, v181
    v_mfma_f32_4x4x4_16b_bf16 v[148:151], a[34:35], a[34:35], v[148:151]
    v_mfma_f32_4x4x4_16b_bf16 v[244:247], v[66:67], v[66:67], v[244:247]
    s_waitcnt lgkmcnt(5)
    v_mfma_f32_4x4x4_16b_bf16 v[148:151], a[36:37], a[36:37], v[148:151]
    v_cvt_pk_bf16_f32 v223, v190, v191
    v_mfma_f32_4x4x4_16b_bf16 v[144:147], a[8:9], a[8:9], v[144:147]
    v_mfma_f32_4x4x4_16b_bf16 v[148:151], a[38:39], a[38:39], v[148:151]
    v_mfma_f32_4x4x4_16b_bf16 v[240:243], v[40:41], v[40:41], v[240:243]
    v_mfma_f32_4x4x4_16b_bf16 v[244:247], v[68:69], v[68:69], v[244:247]
    v_mfma_f32_4x4x4_16b_bf16 v[240:243], v[42:43], v[42:43], v[240:243]
    v_mfma_f32_4x4x4_16b_bf16 v[244:247], v[70:71], v[70:71], v[244:247]
    ds_read_b128 a[68:71], v11 offset:3072
    v_mfma_f32_4x4x4_16b_bf16 v[144:147], a[10:11], a[10:11], v[144:147]
    s_waitcnt lgkmcnt(5)
    v_mfma_f32_4x4x4_16b_bf16 v[240:243], v[44:45], v[44:45], v[240:243]
    v_mfma_f32_4x4x4_16b_bf16 v[144:147], a[12:13], a[12:13], v[144:147]
    s_waitcnt lgkmcnt(4)
    v_mfma_f32_4x4x4_16b_bf16 v[148:151], a[40:41], a[40:41], v[148:151]
    v_cvt_pk_bf16_f32 v220, v184, v185
    v_mfma_f32_4x4x4_16b_bf16 v[244:247], v[72:73], v[72:73], v[244:247]
    v_mfma_f32_4x4x4_16b_bf16 v[144:147], a[14:15], a[14:15], v[144:147]
    v_mfma_f32_4x4x4_16b_bf16 v[244:247], v[74:75], v[74:75], v[244:247]
    v_mfma_f32_4x4x4_16b_bf16 v[240:243], v[46:47], v[46:47], v[240:243]
    v_cvt_pk_bf16_f32 v228, v200, v201
    v_mfma_f32_4x4x4_16b_bf16 v[148:151], a[42:43], a[42:43], v[148:151]
    s_waitcnt lgkmcnt(1)
    v_mfma_f32_4x4x4_16b_bf16 v[240:243], v[48:49], v[48:49], v[240:243]
    v_mfma_f32_4x4x4_16b_bf16 v[144:147], a[16:17], a[16:17], v[144:147]
    v_mfma_f32_4x4x4_16b_bf16 v[240:243], v[50:51], v[50:51], v[240:243]
    ds_read_b128 a[64:67], v11 offset:2048
    v_mfma_f32_4x4x4_16b_bf16 v[144:147], a[18:19], a[18:19], v[144:147]
    v_mfma_f32_4x4x4_16b_bf16 v[240:243], v[52:53], v[52:53], v[240:243]
    v_mfma_f32_4x4x4_16b_bf16 v[244:247], v[76:77], v[76:77], v[244:247]
    ds_read_b128 a[56:59], v11 offset:0
    v_mfma_f32_4x4x4_16b_bf16 v[144:147], a[20:21], a[20:21], v[144:147]
    v_mfma_f32_4x4x4_16b_bf16 v[148:151], a[44:45], a[44:45], v[148:151]
    v_mfma_f32_4x4x4_16b_bf16 v[144:147], a[22:23], a[22:23], v[144:147]
    v_mfma_f32_4x4x4_16b_bf16 v[240:243], v[54:55], v[54:55], v[240:243]
    v_cvt_pk_bf16_f32 v208, v160, v161
    v_mfma_f32_4x4x4_16b_bf16 v[148:151], a[46:47], a[46:47], v[148:151]
    v_mfma_f32_4x4x4_16b_bf16 v[244:247], v[78:79], v[78:79], v[244:247]
    v_mfma_f32_32x32x16_bf16 v[96:111], a[72:75], a[24:27], 0
    buffer_load_dwordx4 v3, s[16:19], s38 offen offset:0 sc0 sc1 nt lds
    v_cvt_pk_bf16_f32 v222, v188, v189
    v_cvt_pk_bf16_f32 v213, v170, v171
    v_mfma_f32_16x16x32_bf16 v[152:155], a[48:51], a[8:11], v[152:155]
    v_mfma_f32_16x16x32_bf16 v[248:251], a[48:51], v[44:47], v[248:251]
    v_mfma_f32_16x16x32_bf16 v[248:251], a[48:51], v[48:51], v[248:251]
    v_mfma_f32_16x16x32_bf16 v[248:251], a[48:51], v[52:55], v[248:251]
    v_mfma_f32_16x16x32_bf16 v[248:251], a[52:55], v[56:59], v[248:251]
    v_mfma_f32_16x16x32_bf16 v[152:155], a[48:51], a[12:15], v[152:155]
    v_mfma_f32_16x16x32_bf16 v[152:155], a[48:51], a[16:19], v[152:155]
    v_cvt_pk_bf16_f32 v215, v174, v175
    v_mfma_f32_16x16x32_bf16 v[152:155], a[48:51], a[20:23], v[152:155]
    v_mfma_f32_32x32x16_bf16 v[96:111], a[76:79], a[28:31], v[96:111]
    v_mfma_f32_16x16x32_bf16 v[248:251], a[52:55], v[60:63], v[248:251]
    v_mfma_f32_32x32x16_bf16 v[96:111], a[80:83], a[32:35], v[96:111]
    buffer_load_dwordx4 v4, s[16:19], s38 offen offset:1024 sc0 sc1 nt lds
    s_add_u32 m0, s35, 6144
    v_mfma_f32_32x32x16_bf16 v[96:111], a[84:87], a[36:39], v[96:111]
    v_mfma_f32_32x32x16_bf16 v[96:111], a[88:91], a[40:43], v[96:111]
    v_mfma_f32_32x32x16_bf16 v[96:111], a[92:95], a[44:47], v[96:111]
    v_cvt_pk_bf16_f32 v210, v164, v165
    v_mfma_f32_16x16x32_bf16 v[248:251], a[52:55], v[64:67], v[248:251]
    v_mfma_f32_16x16x32_bf16 v[248:251], a[52:55], v[68:71], v[248:251]
    v_cvt_pk_bf16_f32 v96, v96, v97
    v_cvt_pk_bf16_f32 v209, v162, v163
    v_mfma_f32_16x16x32_bf16 v[248:251], a[52:55], v[72:75], v[248:251]
    v_mfma_f32_16x16x32_bf16 v[248:251], a[52:55], v[76:79], v[248:251]
    v_cvt_pk_bf16_f32 v97, v98, v99
    v_cvt_pk_bf16_f32 v98, v100, v101
    v_mfma_f32_32x32x16_bf16 v[112:127], a[100:103], a[4:7], v[112:127]
    v_mfma_f32_32x32x16_bf16 v[112:127], a[104:107], a[8:11], v[112:127]
    v_cvt_pk_bf16_f32 v101, v106, v107
    v_cvt_pk_bf16_f32 v100, v104, v105
    v_cvt_pk_bf16_f32 v230, v204, v205
    v_cvt_pk_bf16_f32 v219, v182, v183
    v_cvt_pk_bf16_f32 v212, v168, v169
    v_mfma_f32_32x32x16_bf16 v[80:95], a[80:83], a[8:11], v[80:95]
    v_mfma_f32_32x32x16_bf16 v[80:95], a[84:87], a[12:15], v[80:95]
    buffer_load_dwordx4 v1, s[16:19], s39 offen offset:1024 sc0 sc1 nt lds
    v_mfma_f32_16x16x32_bf16 v[152:155], a[52:55], a[24:27], v[152:155]
    v_mfma_f32_16x16x32_bf16 v[152:155], a[52:55], a[28:31], v[152:155]
    v_cvt_pk_bf16_f32 v225, v194, v195
    v_mfma_f32_32x32x16_bf16 v[112:127], a[108:111], a[12:15], v[112:127]
    s_waitcnt lgkmcnt(0)
    v_cvt_pk_bf16_f32 v227, v198, v199
    v_cvt_pk_bf16_f32 v229, v202, v203
    v_cndmask_b32_e64 v144, v144, v145, s[56:57]
    v_cndmask_b32_e64 v144, v144, v146, s[58:59]
    v_cvt_pk_bf16_f32 v214, v172, v173
    v_mfma_f32_32x32x16_bf16 v[112:127], a[56:59], a[16:19], v[112:127]
    v_mfma_f32_32x32x16_bf16 v[112:127], a[60:63], a[20:23], v[112:127]
    v_cndmask_b32_e64 v144, v144, v147, s[60:61]
    v_cndmask_b32_e64 v244, v244, v245, s[56:57]
    v_cndmask_b32_e64 v244, v244, v246, s[58:59]
    v_cndmask_b32_e64 v244, v244, v247, s[60:61]
    v_cndmask_b32_e64 v240, v240, v241, s[56:57]
    v_cndmask_b32_e64 v240, v240, v242, s[58:59]
    v_mfma_f32_32x32x16_bf16 v[80:95], a[88:91], a[16:19], v[80:95]
    v_mfma_f32_32x32x16_bf16 v[80:95], a[92:95], a[20:23], v[80:95]
    v_cvt_pk_bf16_f32 v112, v112, v113
    v_cvt_pk_bf16_f32 v113, v114, v115
    v_cvt_pk_bf16_f32 v224, v192, v193
    v_cvt_pk_bf16_f32 v216, v176, v177
    v_cndmask_b32_e64 v240, v240, v243, s[60:61]
    v_cvt_pk_bf16_f32 v211, v166, v167
    v_mfma_f32_32x32x16_bf16 v[128:143], a[104:107], a[32:35], v[128:143]
    buffer_load_dwordx4 v0, s[16:19], s39 offen offset:0 sc0 sc1 nt lds
    v_cvt_pk_bf16_f32 v114, v116, v117
    v_cvt_pk_bf16_f32 v116, v120, v121
    v_mfma_f32_32x32x16_bf16 v[160:175], v[32:35], v[208:211], 0
    v_add_u32 v8, s66, v8
    v_permlane32_swap_b32 v240, v244
    v_cvt_pk_bf16_f32 v80, v80, v81
    v_cvt_pk_bf16_f32 v81, v82, v83
    v_mfma_f32_16x16x32_bf16 v[152:155], a[52:55], a[32:35], v[152:155]
    v_mfma_f32_32x32x16_bf16 v[160:175], v[36:39], v[212:215], v[160:175]
    v_add_f32_e64 v240, v240, v244
    v_cvt_pk_bf16_f32 v82, v84, v85
    v_cvt_pk_bf16_f32 v85, v90, v91
    v_cvt_pk_bf16_f32 v99, v102, v103
    v_cvt_pk_bf16_f32 v103, v110, v111
    v_cvt_pk_bf16_f32 v102, v108, v109
    v_mfma_f32_32x32x16_bf16 v[176:191], v[56:59], v[208:211], 0
    v_cvt_pk_bf16_f32 v83, v86, v87
    v_cvt_pk_bf16_f32 v86, v92, v93
    v_fma_f32 v248, -v248, v248, s64
    v_fma_f32 v240, v240, s67, v248
    v_mfma_f32_32x32x16_bf16 v[128:143], a[108:111], a[36:39], v[128:143]
    v_max_f32 v240, s64, v240
    v_rsq_f32_e64 v252, v240
    v_mfma_f32_32x32x16_bf16 v[128:143], a[56:59], a[40:43], v[128:143]
    ds_read_b128 a[56:59], v11 offset:4096
    v_cvt_pk_bf16_f32 v115, v118, v119
    v_cvt_pk_bf16_f32 v118, v124, v125
    v_mfma_f32_32x32x16_bf16 v[160:175], v[40:43], v[216:219], v[160:175]
    buffer_load_dwordx4 v2, s[16:19], s39 offen offset:2048 sc0 sc1 nt lds
    v_mfma_f32_32x32x16_bf16 v[128:143], a[60:63], a[44:47], v[128:143]
    ds_read_b128 a[60:63], v11 offset:5120
    s_add_u32 m0, s35, 9216
    ds_bpermute_b32 v15, v12, v252 offset:0
    v_mfma_f32_16x16x32_bf16 v[152:155], a[52:55], a[36:39], v[152:155]
    v_mfma_f32_16x16x32_bf16 v[152:155], a[52:55], a[40:43], v[152:155]
    v_cvt_pk_bf16_f32 v84, v88, v89
    v_mfma_f32_16x16x32_bf16 v[152:155], a[52:55], a[44:47], v[152:155]
    v_mfma_f32_32x32x16_bf16 v[160:175], v[44:47], v[220:223], v[160:175]
    s_add_u32 s35, s35, s66
    v_mov_b32_e64 v13, v252
    v_cvt_pk_bf16_f32 v128, v128, v129
    v_cvt_pk_bf16_f32 v129, v130, v131
    v_cvt_pk_bf16_f32 v130, v132, v133
    v_cvt_pk_bf16_f32 v133, v138, v139
    v_cvt_pk_bf16_f32 v87, v94, v95
    v_mfma_f32_32x32x16_bf16 v[176:191], v[60:63], v[212:215], v[176:191]
    v_mfma_f32_32x32x16_bf16 v[176:191], v[64:67], v[216:219], v[176:191]
    v_cvt_pk_bf16_f32 v226, v196, v197
    v_cvt_pk_bf16_f32 v132, v136, v137
    v_cvt_pk_bf16_f32 v117, v122, v123
    v_mov_b32_e64 v14, v252
    v_cvt_pk_bf16_f32 v131, v134, v135
    v_mfma_f32_32x32x16_bf16 v[160:175], v[48:51], v[224:227], v[160:175]
    v_cvt_pk_bf16_f32 v135, v142, v143
    v_cndmask_b32_e64 v148, v148, v149, s[56:57]
    v_cndmask_b32_e64 v148, v148, v150, s[58:59]
    v_mfma_f32_32x32x16_bf16 v[160:175], v[52:55], v[228:231], v[160:175]
    v_cndmask_b32_e64 v148, v148, v151, s[60:61]
    ds_bpermute_b32 v16, v12, v252 offset:128
    v_cvt_pk_bf16_f32 v119, v126, v127
    v_mfma_f32_32x32x16_bf16 v[176:191], v[68:71], v[220:223], v[176:191]
    buffer_load_dwordx4 v4, s[16:19], s39 offen offset:1024 sc0 sc1 nt lds
    s_waitcnt lgkmcnt(1)
    v_mfma_f32_32x32x16_bf16 v[176:191], v[72:75], v[224:227], v[176:191]
    v_mul_f32_dpp v161, v15, v161 row_newbcast:1 row_mask:0xf bank_mask:0xf
    v_mul_f32_dpp v170, v15, v170 row_newbcast:10 row_mask:0xf bank_mask:0xf
    v_cvt_pk_bf16_f32 v134, v140, v141
    v_permlane32_swap_b32 v144, v148
    v_mul_f32_dpp v166, v15, v166 row_newbcast:6 row_mask:0xf bank_mask:0xf
    v_mfma_f32_32x32x16_bf16 v[176:191], v[76:79], v[228:231], v[176:191]
    v_mul_f32_dpp v168, v15, v168 row_newbcast:8 row_mask:0xf bank_mask:0xf
    v_fma_f32 v152, -v152, v152, s64
    v_add_f32_e64 v144, v144, v148
    v_fma_f32 v144, v144, s67, v152
    v_max_f32_e64 v144, s64, v144
    v_rsq_f32_e64 v156, v144
    v_mfma_f32_4x4x4_16b_bf16 v[144:147], a[0:1], v[80:81], 0
    v_mfma_f32_4x4x4_16b_bf16 v[148:151], a[24:25], v[96:97], 0
    v_mul_f32_dpp v174, v15, v174 row_newbcast:14 row_mask:0xf bank_mask:0xf
    v_mfma_f32_4x4x4_16b_bf16 v[144:147], a[2:3], v[82:83], v[144:147]
    v_mfma_f32_4x4x4_16b_bf16 v[148:151], a[26:27], v[98:99], v[148:151]
    v_mul_f32_dpp v167, v15, v167 row_newbcast:7 row_mask:0xf bank_mask:0xf
    v_mfma_f32_4x4x4_16b_bf16 v[144:147], a[4:5], v[84:85], v[144:147]
    v_mfma_f32_4x4x4_16b_bf16 v[148:151], a[28:29], v[100:101], v[148:151]
    s_waitcnt lgkmcnt(0)
    v_mfma_f32_4x4x4_16b_bf16 v[144:147], a[6:7], v[86:87], v[144:147]
    v_mul_f32_dpp v188, v16, v188 row_newbcast:12 row_mask:0xf bank_mask:0xf
    v_mfma_f32_4x4x4_16b_bf16 v[148:151], a[30:31], v[102:103], v[148:151]
    v_mfma_f32_4x4x4_16b_bf16 v[144:147], a[8:9], v[112:113], v[144:147]
    v_mfma_f32_4x4x4_16b_bf16 v[148:151], a[32:33], v[128:129], v[148:151]
    v_mfma_f32_4x4x4_16b_bf16 v[144:147], a[10:11], v[114:115], v[144:147]
    v_mfma_f32_4x4x4_16b_bf16 v[148:151], a[34:35], v[130:131], v[148:151]
    v_mfma_f32_4x4x4_16b_bf16 v[144:147], a[12:13], v[116:117], v[144:147]
    v_mfma_f32_4x4x4_16b_bf16 v[148:151], a[36:37], v[132:133], v[148:151]
    v_mul_f32_dpp v185, v16, v185 row_newbcast:9 row_mask:0xf bank_mask:0xf
    v_mfma_f32_4x4x4_16b_bf16 v[144:147], a[14:15], v[118:119], v[144:147]
    v_mul_f32_dpp v169, v15, v169 row_newbcast:9 row_mask:0xf bank_mask:0xf
    v_mul_f32_dpp v175, v15, v175 row_newbcast:15 row_mask:0xf bank_mask:0xf
    v_mfma_f32_32x32x16_bf16 v[96:111], a[64:67], a[24:27], 0
    buffer_load_dwordx4 v5, s[16:19], s39 offen offset:2048 sc0 sc1 nt lds
    v_mfma_f32_32x32x16_bf16 v[80:95], a[64:67], a[0:3], 0
    ds_read_b128 a[64:67], v11 offset:6144
    v_mul_f32_dpp v160, v15, v160 row_newbcast:0 row_mask:0xf bank_mask:0xf
    v_mul_f32_dpp v182, v16, v182 row_newbcast:6 row_mask:0xf bank_mask:0xf
    v_mul_f32_dpp v176, v16, v176 row_newbcast:0 row_mask:0xf bank_mask:0xf
    v_mul_f32_dpp v177, v16, v177 row_newbcast:1 row_mask:0xf bank_mask:0xf
    v_mfma_f32_32x32x16_bf16 v[96:111], a[68:71], a[28:31], v[96:111]
    v_mul_f32_dpp v162, v15, v162 row_newbcast:2 row_mask:0xf bank_mask:0xf
    v_permlane32_swap_b32 v13, v14
    v_mul_f32_dpp v181, v16, v181 row_newbcast:5 row_mask:0xf bank_mask:0xf
    v_mul_f32_dpp v173, v15, v173 row_newbcast:13 row_mask:0xf bank_mask:0xf
    v_mul_f32_dpp v180, v16, v180 row_newbcast:4 row_mask:0xf bank_mask:0xf
    v_mfma_f32_32x32x16_bf16 v[96:111], a[56:59], a[32:35], v[96:111]
    v_mul_f32_dpp v163, v15, v163 row_newbcast:3 row_mask:0xf bank_mask:0xf
    v_max3_f32 v17, v160, v161, v162
    v_mul_f32_dpp v164, v15, v164 row_newbcast:4 row_mask:0xf bank_mask:0xf
    v_max3_f32 v17, v17, v163, v164
    v_mul_f32_dpp v165, v15, v165 row_newbcast:5 row_mask:0xf bank_mask:0xf
    v_max3_f32 v17, v17, v165, v166
    v_mfma_f32_32x32x16_bf16 v[80:95], a[68:71], a[4:7], v[80:95]
    ds_read_b128 a[68:71], v11 offset:7168
    v_mul_f32_dpp v179, v16, v179 row_newbcast:3 row_mask:0xf bank_mask:0xf
    v_max3_f32 v17, v17, v167, v168
    v_max3_f32 v17, v17, v169, v170
    v_add_u32_e64 v9, s66, v9
    v_mul_f32_dpp v191, v16, v191 row_newbcast:15 row_mask:0xf bank_mask:0xf
    v_mfma_f32_32x32x16_bf16 v[96:111], a[60:63], a[36:39], v[96:111]
    v_mul_f32_dpp v171, v15, v171 row_newbcast:11 row_mask:0xf bank_mask:0xf
    v_mul_f32_dpp v172, v15, v172 row_newbcast:12 row_mask:0xf bank_mask:0xf
    v_max3_f32 v17, v17, v171, v172
    v_max3_f32 v17, v17, v173, v174
    v_mul_f32_dpp v186, v16, v186 row_newbcast:10 row_mask:0xf bank_mask:0xf
    v_mul_f32_dpp v183, v16, v183 row_newbcast:7 row_mask:0xf bank_mask:0xf
    v_mfma_f32_32x32x16_bf16 v[80:95], a[56:59], a[8:11], v[80:95]
    ds_read_b128 a[56:59], v11 offset:8192
    v_max3_f32 v17, v17, v175, v176
    v_mul_f32_dpp v178, v16, v178 row_newbcast:2 row_mask:0xf bank_mask:0xf
    v_max3_f32 v17, v17, v177, v178
    v_max3_f32 v17, v17, v179, v180
    v_max3_f32 v17, v17, v181, v182
    v_mfma_f32_32x32x16_bf16 v[80:95], a[60:63], a[12:15], v[80:95]
    s_waitcnt lgkmcnt(2)
    ds_read_b128 a[60:63], v11 offset:9216
    v_mul_f32_dpp v184, v16, v184 row_newbcast:8 row_mask:0xf bank_mask:0xf
    v_max3_f32 v17, v17, v183, v184
    v_mul_f32_dpp v187, v16, v187 row_newbcast:11 row_mask:0xf bank_mask:0xf
    v_max3_f32 v17, v17, v185, v186
    v_max3_f32 v17, v17, v187, v188
    v_mfma_f32_32x32x16_bf16 v[96:111], a[64:67], a[40:43], v[96:111]
    v_mul_f32_dpp v190, v16, v190 row_newbcast:14 row_mask:0xf bank_mask:0xf
    v_mul_f32_dpp v189, v16, v189 row_newbcast:13 row_mask:0xf bank_mask:0xf
    v_max3_f32 v17, v17, v189, v190
    v_max_f32 v20, v17, v191
    v_max_f32 v17, v17, v191
    s_waitcnt lgkmcnt(2)
    v_mfma_f32_32x32x16_bf16 v[80:95], a[64:67], a[16:19], v[80:95]
    s_nop 0
    v_permlane32_swap_b32 v17, v20
    v_max_f32 v17, v17, v20
    v_mul_f32 v17, v17, v13
    v_fma_f32 v191, v191, v13, -v17
    v_fma_f32 v169, v169, v13, -v17
    v_mfma_f32_32x32x16_bf16 v[80:95], a[68:71], a[20:23], v[80:95]
    v_fma_f32 v190, v190, v13, -v17
    v_fma_f32 v172, v172, v13, -v17
    ds_read_b128 a[64:67], v11 offset:10240
    v_fma_f32 v165, v165, v13, -v17
    v_mfma_f32_32x32x16_bf16 v[96:111], a[68:71], a[44:47], v[96:111]
    s_waitcnt lgkmcnt(2)
    ds_read_b128 a[68:71], v11 offset:11264
    v_fma_f32 v179, v179, v13, -v17
    v_exp_f32_e64 v179, v179
    v_fma_f32 v177, v177, v13, -v17
    v_fma_f32 v182, v182, v13, -v17
    v_mfma_f32_32x32x16_bf16 v[112:127], a[0:3], a[56:59], 0
    s_waitcnt lgkmcnt(2)
    v_fma_f32 v163, v163, v13, -v17
    v_cvt_pk_bf16_f32 v80, v80, v81
    v_cvt_pk_bf16_f32 v81, v82, v83
    v_cvt_pk_bf16_f32 v82, v84, v85
    v_cvt_pk_bf16_f32 v85, v90, v91
    v_cvt_pk_bf16_f32 v84, v88, v89
    v_mfma_f32_32x32x16_bf16 v[112:127], a[4:7], a[60:63], v[112:127]
    v_cvt_pk_bf16_f32 v96, v96, v97
    v_cvt_pk_bf16_f32 v97, v98, v99
    v_fma_f32 v167, v167, v13, -v17
    v_cvt_pk_bf16_f32 v98, v100, v101
    v_cvt_pk_bf16_f32 v101, v106, v107
    v_cvt_pk_bf16_f32 v100, v104, v105
    v_mfma_f32_32x32x16_bf16 v[192:207], a[112:115], v[56:59], 0
    v_exp_f32_e64 v182, v182
    v_cvt_pk_bf16_f32 v99, v102, v103
    v_cvt_pk_bf16_f32 v102, v108, v109
    v_cvt_pk_bf16_f32 v83, v86, v87
    v_cvt_pk_bf16_f32 v87, v94, v95
    v_mfma_f32_4x4x4_16b_bf16 v[148:151], a[38:39], v[134:135], v[148:151]
    v_fma_f32 v184, v184, v13, -v17
    v_mfma_f32_4x4x4_16b_bf16 v[144:147], a[16:17], v[80:81], v[144:147]
    v_cvt_pk_bf16_f32 v86, v92, v93
    v_mfma_f32_4x4x4_16b_bf16 v[148:151], a[40:41], v[96:97], v[148:151]
    v_mfma_f32_4x4x4_16b_bf16 v[144:147], a[18:19], v[82:83], v[144:147]
    v_cvt_pk_bf16_f32 v103, v110, v111
    v_mfma_f32_4x4x4_16b_bf16 v[148:151], a[42:43], v[98:99], v[148:151]
    v_mfma_f32_4x4x4_16b_bf16 v[144:147], a[20:21], v[84:85], v[144:147]
    v_fma_f32 v174, v174, v13, -v17
    v_mfma_f32_4x4x4_16b_bf16 v[148:151], a[44:45], v[100:101], v[148:151]
    v_mfma_f32_4x4x4_16b_bf16 v[144:147], a[22:23], v[86:87], v[144:147]
    v_mfma_f32_4x4x4_16b_bf16 v[148:151], a[46:47], v[102:103], v[148:151]
    v_mfma_f32_32x32x16_bf16 v[128:143], a[24:27], a[56:59], 0
    ds_read_b128 a[56:59], v11 offset:12288
    v_fma_f32 v170, v170, v13, -v17
    v_fma_f32 v176, v176, v13, -v17
    v_exp_f32 v172, v172
    v_mfma_f32_32x32x16_bf16 v[128:143], a[28:31], a[60:63], v[128:143]
    s_waitcnt lgkmcnt(2)
    ds_read_b128 a[60:63], v11 offset:13312
    v_fma_f32 v187, v187, v13, -v17
    v_permlane32_swap_b32 v145, v149
    v_permlane32_swap_b32 v147, v151
    v_mfma_f32_32x32x16_bf16 v[128:143], a[32:35], a[64:67], v[128:143]
    v_add_f32 v147, v147, v151
    v_permlane32_swap_b32 v144, v148
    v_permlane32_swap_b32 v146, v150
    v_add_f32 v146, v146, v150
    v_mfma_f32_32x32x16_bf16 v[192:207], a[116:119], v[60:63], v[192:207]
    v_fma_f32 v183, v183, v13, -v17
    v_fma_f32 v189, v189, v13, -v17
    v_exp_f32 v176, v176
    v_fma_f32 v160, v160, v13, -v17
    v_add_f32 v144, v144, v148
    v_mfma_f32_32x32x16_bf16 v[112:127], a[8:11], a[64:67], v[112:127]
    s_waitcnt lgkmcnt(2)
    ds_read_b128 a[64:67], v11 offset:14336
    v_add_f32 v145, v145, v149
    v_mul_f32_dpp v147, v156, v147 quad_perm:[3,3,3,3] row_mask:0xf bank_mask:0xf
    v_fma_f32 v162, v162, v13, -v17
    v_exp_f32 v162, v162
    v_mfma_f32_32x32x16_bf16 v[112:127], a[12:15], a[68:71], v[112:127]
    s_waitcnt lgkmcnt(2)
    v_exp_f32 v163, v163
    v_mul_f32_dpp v145, v156, v145 quad_perm:[1,1,1,1] row_mask:0xf bank_mask:0xf
    v_mul_f32_dpp v146, v156, v146 quad_perm:[2,2,2,2] row_mask:0xf bank_mask:0xf
    v_mul_f32_dpp v144, v156, v144 quad_perm:[0,0,0,0] row_mask:0xf bank_mask:0xf
    v_max3_f32 v154, v144, v145, v146
    v_mfma_f32_32x32x16_bf16 v[112:127], a[16:19], a[56:59], v[112:127]
    s_waitcnt lgkmcnt(1)
    v_max_f32 v154, v154, v147
    v_mul_f32 v155, v154, v156
    v_fma_f32 v145, v145, v156, -v155
    v_fma_f32 v146, v146, v156, -v155
    v_exp_f32 v146, v146
    v_mfma_f32_32x32x16_bf16 v[112:127], a[20:23], a[60:63], v[112:127]
    v_fma_f32 v147, v147, v156, -v155
    v_fma_f32 v181, v181, v13, -v17
    v_exp_f32 v147, v147
    v_fma_f32 v168, v168, v13, -v17
    v_add_f32 v154, v146, v147
    v_mfma_f32_32x32x16_bf16 v[128:143], a[36:39], a[68:71], v[128:143]
    ds_read_b128 a[68:71], v11 offset:15360
    v_exp_f32 v145, v145
    v_fma_f32 v188, v188, v13, -v17
    v_exp_f32 v165, v165
    v_mfma_f32_32x32x16_bf16 v[128:143], a[40:43], a[56:59], v[128:143]
    s_waitcnt lgkmcnt(1)
    ds_read_b128 a[56:59], v11 offset:16384
    v_fma_f32 v144, v144, v156, -v155
    v_exp_f32 v144, v144
    v_fma_f32 v180, v180, v13, -v17
    v_mfma_f32_32x32x16_bf16 v[80:95], a[0:3], a[64:67], 0
    v_add_f32 v157, v144, v145
    v_mul_f32_dpp v145, v156, v145 quad_perm:[1,1,1,1] row_mask:0xf bank_mask:0xf
    v_cvt_pk_bf16_f32 v112, v112, v113
    v_add_f32 v157, v157, v154
    v_rcp_f32 v157, v157
    v_mfma_f32_32x32x16_bf16 v[96:111], a[24:27], a[64:67], 0
    ds_read_b128 a[64:67], v11 offset:18432
    v_mul_f32_dpp v146, v156, v146 quad_perm:[2,2,2,2] row_mask:0xf bank_mask:0xf
    v_mul_f32 v146, v146, v157
    v_cvt_pk_bf16_f32 v113, v114, v115
    v_cvt_pk_bf16_f32 v115, v118, v119
    v_cvt_pk_bf16_f32 v118, v124, v125
    v_mfma_f32_32x32x16_bf16 v[128:143], a[44:47], a[60:63], v[128:143]
    ds_read_b128 a[60:63], v11 offset:17408
    buffer_load_dwordx4 v3, s[16:19], s39 offen offset:0 sc0 sc1 nt lds
    s_waitcnt lgkmcnt(3)
    v_mfma_f32_32x32x16_bf16 v[80:95], a[4:7], a[68:71], v[80:95]
    v_mul_f32_dpp v147, v156, v147 quad_perm:[3,3,3,3] row_mask:0xf bank_mask:0xf
    v_mul_f32 v147, v147, v157
    v_cvt_pk_bf16_f32 v153, v146, v147
    v_cvt_pk_bf16_f32 v159, v146, v147
    v_exp_f32 v191, v191
    v_mfma_f32_32x32x16_bf16 v[96:111], a[28:31], a[68:71], v[96:111]
    s_waitcnt lgkmcnt(2)
    ds_read_b128 a[68:71], v11 offset:19456
    v_mul_f32_dpp v144, v156, v144 quad_perm:[0,0,0,0] row_mask:0xf bank_mask:0xf
    v_mul_f32 v144, v144, v157
    v_mul_f32 v145, v145, v157
    v_cvt_pk_bf16_f32 v158, v144, v145
    v_cvt_pk_bf16_f32 v114, v116, v117
    v_mfma_f32_32x32x16_bf16 v[96:111], a[32:35], a[56:59], v[96:111]
    v_cvt_pk_bf16_f32 v116, v120, v121
    v_cvt_pk_bf16_f32 v120, v128, v129
    v_cvt_pk_bf16_f32 v124, v136, v137
    v_cvt_pk_bf16_f32 v125, v138, v139
    v_cvt_pk_bf16_f32 v117, v122, v123
    v_cvt_pk_bf16_f32 v122, v132, v133
    v_mfma_f32_32x32x16_bf16 v[80:95], a[8:11], a[56:59], v[80:95]
    ds_read_b128 a[56:59], v11 offset:20480
    v_fma_f32 v161, v161, v13, -v17
    v_exp_f32 v161, v161
    v_cvt_pk_bf16_f32 v152, v144, v145
    s_waitcnt lgkmcnt(2)
    v_mfma_f32_32x32x16_bf16 v[80:95], a[12:15], a[60:63], v[80:95]
    v_permlane32_swap_b32 v153, v159
    v_exp_f32 v177, v177
    v_cndmask_b32_e64 v145, 0, v153, s[48:49]
    v_cndmask_b32_e64 v149, 0, v153, s[52:53]
    v_mfma_f32_32x32x16_bf16 v[80:95], a[16:19], a[64:67], v[80:95]
    v_permlane32_swap_b32 v152, v158
    v_cndmask_b32_e64 v148, 0, v152, s[52:53]
    v_fma_f32 v166, v166, v13, -v17
    s_waitcnt lgkmcnt(1)
    v_mfma_f32_32x32x16_bf16 v[80:95], a[20:23], a[68:71], v[80:95]
    v_fma_f32 v173, v173, v13, -v17
    v_exp_f32 v173, v173
    v_cndmask_b32_e64 v154, 0, v158, s[50:51]
    v_exp_f32 v160, v160
    v_mfma_f32_32x32x16_bf16 v[96:111], a[36:39], a[60:63], v[96:111]
    v_exp_f32 v167, v167
    v_fma_f32 v178, v178, v13, -v17
    v_exp_f32 v178, v178
    v_mfma_f32_32x32x16_bf16 v[96:111], a[40:43], a[64:67], v[96:111]
    ds_read_b128 a[64:67], v11 offset:22528
    v_cvt_pk_bf16_f32 v80, v80, v81
    v_cvt_pk_bf16_f32 v81, v82, v83
    v_cvt_pk_bf16_f32 v83, v86, v87
    v_exp_f32 v187, v187
    v_mfma_f32_32x32x16_bf16 v[96:111], a[44:47], a[68:71], v[96:111]
    ds_read_b128 a[68:71], v11 offset:23552
    v_cvt_pk_bf16_f32 v82, v84, v85
    v_cndmask_b32_e64 v150, 0, v152, s[54:55]
    v_exp_f32_e64 v166, v166
    v_mfma_f32_32x32x16_bf16 v[192:207], a[120:123], v[64:67], v[192:207]
    v_fma_f32 v185, v185, v13, -v17
    v_cndmask_b32_e64 v151, 0, v153, s[54:55]
    v_cvt_pk_bf16_f32 v87, v94, v95
    v_cvt_pk_bf16_f32 v84, v88, v89
    v_cvt_pk_bf16_f32 v88, v96, v97
    v_cvt_pk_bf16_f32 v95, v110, v111
    v_mfma_f32_32x32x16_bf16 v[192:207], a[124:127], v[68:71], v[192:207]
    v_fma_f32 v164, v164, v13, -v17
    v_exp_f32 v164, v164
    v_cvt_pk_bf16_f32 v86, v92, v93
    v_exp_f32 v181, v181
    v_mfma_f32_32x32x16_bf16 v[192:207], a[128:131], v[72:75], v[192:207]
    ds_read_b128 a[60:63], v11 offset:21504
    v_cndmask_b32_e64 v144, 0, v152, s[48:49]
    v_add_f32 v19, v160, v161
    v_add_f32 v19, v19, v162
    v_add_f32 v19, v19, v163
    v_cvt_pk_bf16_f32 v123, v134, v135
    v_mfma_f32_32x32x16_bf16 v[240:255], a[136:139], v[56:59], 0
    v_add_f32 v19, v19, v164
    v_add_f32 v19, v19, v165
    v_cvt_pk_bf16_f32 v92, v104, v105
    v_cvt_pk_bf16_f32 v119, v126, v127
    v_add_f32 v19, v19, v166
    v_mfma_f32_32x32x16_bf16 v[192:207], a[132:135], v[76:79], v[192:207]
    v_cvt_pk_bf16_f32 v89, v98, v99
    v_cndmask_b32_e64 v147, 0, v153, s[50:51]
    v_cndmask_b32_e64 v146, 0, v152, s[50:51]
    v_cndmask_b32_e64 v152, 0, v158, s[48:49]
    v_cvt_pk_bf16_f32 v127, v142, v143
    v_cvt_pk_bf16_f32 v126, v140, v141
    v_cvt_pk_bf16_f32 v85, v90, v91
    v_mfma_f32_4x4x4_16b_bf16 v[140:143], v[22:23], a[6:7], 0
    v_cvt_pk_bf16_f32 v90, v100, v101
    v_mfma_f32_4x4x4_16b_bf16 v[96:99], v[22:23], a[24:25], 0
    v_cvt_pk_bf16_f32 v91, v102, v103
    v_mfma_f32_4x4x4_16b_bf16 v[100:103], v[22:23], a[26:27], 0
    v_cvt_pk_bf16_f32 v121, v130, v131
    v_mfma_f32_4x4x4_16b_bf16 v[128:131], v[22:23], a[0:1], 0
    v_cvt_pk_bf16_f32 v236, v200, v201
    v_mfma_f32_4x4x4_16b_bf16 v[136:139], v[22:23], a[4:5], 0
    v_mfma_f32_4x4x4_16b_bf16 v[132:135], v[22:23], a[2:3], 0
    v_cvt_pk_bf16_f32 v93, v106, v107
    v_mfma_f32_4x4x4_16b_bf16 v[104:107], v[22:23], a[28:29], 0
    v_cvt_pk_bf16_f32 v94, v108, v109
    v_mfma_f32_4x4x4_16b_bf16 v[108:111], v[22:23], a[30:31], 0
    v_exp_f32 v168, v168
    v_mfma_f32_32x32x16_bf16 v[128:143], v[112:115], v[144:147], v[128:143]
    v_cvt_pk_bf16_f32 v233, v194, v195
    v_exp_f32 v170, v170
    v_cndmask_b32_e64 v156, 0, v158, s[52:53]
    v_cndmask_b32_e64 v158, 0, v158, s[54:55]
    v_cvt_pk_bf16_f32 v232, v192, v193
    v_mfma_f32_32x32x16_bf16 v[128:143], v[116:119], v[148:151], v[128:143]
    v_exp_f32_e64 v183, v183
    v_cndmask_b32_e64 v155, 0, v159, s[50:51]
    v_cndmask_b32_e64 v153, 0, v159, s[48:49]
    v_cndmask_b32_e64 v157, 0, v159, s[52:53]
    v_cndmask_b32_e64 v159, 0, v159, s[54:55]
    v_mfma_f32_32x32x16_bf16 v[96:111], v[120:123], v[152:155], v[96:111]
    v_exp_f32 v184, v184
    v_exp_f32 v180, v180
    v_exp_f32 v169, v169
    v_mfma_f32_32x32x16_bf16 v[96:111], v[124:127], v[156:159], v[96:111]
    s_waitcnt lgkmcnt(3)
    v_cvt_pk_bf16_f32 v128, v128, v129
    v_cvt_pk_bf16_f32 v129, v130, v131
    v_cvt_pk_bf16_f32 v130, v132, v133
    v_exp_f32 v188, v188
    v_cvt_pk_bf16_f32 v132, v136, v137
    v_mfma_f32_32x32x16_bf16 v[112:127], a[0:3], a[56:59], 0
    s_waitcnt lgkmcnt(0)
    v_add_f32 v19, v19, v167
    v_add_f32 v19, v19, v168
    v_cvt_pk_bf16_f32 v131, v134, v135
    v_cvt_pk_bf16_f32 v134, v140, v141
    v_mul_f32_dpp v162, v15, v162 row_newbcast:2 row_mask:0xf bank_mask:0xf
    v_add_f32 v19, v19, v169
    v_mfma_f32_32x32x16_bf16 v[112:127], a[4:7], a[60:63], v[112:127]
    v_add_f32 v19, v19, v170
    v_mul_f32_dpp v166, v15, v166 row_newbcast:6 row_mask:0xf bank_mask:0xf
    v_cvt_pk_bf16_f32 v135, v142, v143
    v_fma_f32 v171, v171, v13, -v17
    v_exp_f32 v171, v171
    v_mfma_f32_32x32x16_bf16 v[240:255], a[140:143], v[60:63], v[240:255]
    v_exp_f32 v174, v174
    v_cvt_pk_bf16_f32 v133, v138, v139
    v_add_f32_e64 v19, v19, v171
    v_cvt_pk_bf16_f32 v238, v204, v205
    v_mfma_f32_32x32x16_bf16 v[112:127], a[8:11], a[64:67], v[112:127]
    ds_write_b128 v7, v[132:135] offset:0
    v_fma_f32 v175, v175, v13, -v17
    v_mfma_f32_32x32x16_bf16 v[240:255], a[144:147], v[64:67], v[240:255]
    v_cvt_pk_bf16_f32 v96, v96, v97
    v_cvt_pk_bf16_f32 v97, v98, v99
    v_cvt_pk_bf16_f32 v99, v102, v103
    v_cvt_pk_bf16_f32 v103, v110, v111
    v_cvt_pk_bf16_f32 v98, v100, v101
    v_cvt_pk_bf16_f32 v101, v106, v107
    v_mfma_f32_32x32x16_bf16 v[240:255], a[148:151], v[68:71], v[240:255]
    v_cvt_pk_bf16_f32 v102, v108, v109
    v_exp_f32 v175, v175
    v_add_f32 v19, v19, v172
    v_add_f32 v19, v19, v173
    v_add_f32 v19, v19, v174
    v_mfma_f32_32x32x16_bf16 v[240:255], a[152:155], v[72:75], v[240:255]
    v_add_f32 v19, v19, v175
    v_cvt_pk_bf16_f32 v235, v198, v199
    v_add_f32 v19, v19, v176
    v_mul_f32_dpp v175, v15, v175 row_newbcast:15 row_mask:0xf bank_mask:0xf
    v_mul_f32_dpp v174, v15, v174 row_newbcast:14 row_mask:0xf bank_mask:0xf
    v_mul_f32_dpp v176, v16, v176 row_newbcast:0 row_mask:0xf bank_mask:0xf
    v_mfma_f32_32x32x16_bf16 v[240:255], a[156:159], v[76:79], v[240:255]
    v_add_f32 v19, v19, v177
    v_add_f32 v19, v19, v178
    v_add_f32 v19, v19, v179
    v_mul_f32_dpp v178, v16, v178 row_newbcast:2 row_mask:0xf bank_mask:0xf
    v_add_f32 v19, v19, v180
    v_cvt_pk_bf16_f32 v239, v206, v207
    v_mfma_f32_32x32x16_bf16 v[112:127], a[12:15], a[68:71], v[112:127]
    ds_write_b128 v6, v[128:131] offset:0
    v_mfma_f32_32x32x16_bf16 v[128:143], a[24:27], a[56:59], 0
    v_add_f32 v19, v19, v181
    v_mul_f32_dpp v181, v16, v181 row_newbcast:5 row_mask:0xf bank_mask:0xf
    v_add_f32 v19, v19, v182
    v_add_f32 v19, v19, v183
    v_add_f32 v19, v19, v184
    v_mfma_f32_32x32x16_bf16 v[128:143], a[28:31], a[60:63], v[128:143]
    ds_read_b128 a[60:63], v11 offset:25600
    v_exp_f32 v185, v185
    ds_read_b128 a[56:59], v11 offset:24576
    v_mfma_f32_32x32x16_bf16 v[128:143], a[32:35], a[64:67], v[128:143]
    v_cvt_pk_bf16_f32 v100, v104, v105
    v_cvt_pk_bf16_f32 v215, v254, v255
    v_exp_f32 v190, v190
    v_cvt_pk_bf16_f32 v237, v202, v203
    v_cvt_pk_bf16_f32 v234, v196, v197
    v_mfma_f32_32x32x16_bf16 v[192:207], a[160:163], v[56:59], 0
    v_fma_f32 v186, v186, v13, -v17
    v_exp_f32 v186, v186
    v_add_f32 v19, v19, v185
    v_mul_f32_dpp v185, v16, v185 row_newbcast:9 row_mask:0xf bank_mask:0xf
    v_add_f32 v19, v19, v186
    v_mfma_f32_32x32x16_bf16 v[192:207], a[164:167], v[60:63], v[192:207]
    v_add_f32 v19, v19, v187
    v_add_f32 v19, v19, v188
    v_mul_f32_dpp v187, v16, v187 row_newbcast:11 row_mask:0xf bank_mask:0xf
    v_cvt_pk_bf16_f32 v211, v246, v247
    v_exp_f32 v189, v189
    v_mfma_f32_32x32x16_bf16 v[192:207], a[168:171], v[64:67], v[192:207]
    ds_write_b128 v6, v[96:99] offset:6144
    v_mfma_f32_32x32x16_bf16 v[192:207], a[172:175], v[68:71], v[192:207]
    v_mul_f32_dpp v188, v16, v188 row_newbcast:12 row_mask:0xf bank_mask:0xf
    v_add_f32 v19, v19, v189
    v_mul_f32_dpp v189, v16, v189 row_newbcast:13 row_mask:0xf bank_mask:0xf
    v_mul_f32_dpp v160, v15, v160 row_newbcast:0 row_mask:0xf bank_mask:0xf
    v_mfma_f32_32x32x16_bf16 v[192:207], a[176:179], v[72:75], v[192:207]
    v_add_f32 v19, v19, v190
    v_add_f32 v19, v19, v191
    v_mov_b32 v20, v19
    v_mfma_f32_32x32x16_bf16 v[128:143], a[36:39], a[68:71], v[128:143]
    s_nop 0
    v_permlane32_swap_b32 v19, v20
    v_add_f32 v19, v19, v20
    v_mul_f32_dpp v171, v15, v171 row_newbcast:11 row_mask:0xf bank_mask:0xf
    v_rcp_f32 v19, v19
    v_mfma_f32_32x32x16_bf16 v[192:207], a[180:183], v[76:79], v[192:207]
    ds_write_b128 v7, v[100:103] offset:6144
    s_waitcnt lgkmcnt(2)
    v_mfma_f32_4x4x4_16b_bf16 v[100:103], v[22:23], a[10:11], 0
    v_cvt_pk_bf16_f32 v210, v244, v245
    v_mfma_f32_4x4x4_16b_bf16 v[108:111], v[22:23], a[14:15], 0
    v_mul_f32 v160, v160, v19
    v_mfma_f32_4x4x4_16b_bf16 v[96:99], v[22:23], a[8:9], 0
    v_cvt_pk_bf16_f32 v219, v198, v199
    v_mfma_f32_4x4x4_16b_bf16 v[104:107], v[22:23], a[12:13], 0
    v_mul_f32 v181, v181, v19
    v_mfma_f32_32x32x16_bf16 v[112:127], a[16:19], a[56:59], v[112:127]
    v_mul_f32 v176, v176, v19
    v_mul_f32_dpp v165, v15, v165 row_newbcast:5 row_mask:0xf bank_mask:0xf
    v_mul_f32_dpp v177, v16, v177 row_newbcast:1 row_mask:0xf bank_mask:0xf
    v_mul_f32 v177, v177, v19
    v_mfma_f32_32x32x16_bf16 v[112:127], a[20:23], a[60:63], v[112:127]
    v_mul_f32_dpp v182, v16, v182 row_newbcast:6 row_mask:0xf bank_mask:0xf
    v_mul_f32 v182, v182, v19
    v_cvt_pk_bf16_f32 v222, v204, v205
    v_cvt_pk_bf16_f32 v214, v252, v253
    v_mul_f32_dpp v191, v16, v191 row_newbcast:15 row_mask:0xf bank_mask:0xf
    v_mul_f32 v191, v191, v19
    v_mfma_f32_32x32x16_bf16 v[96:111], v[80:83], v[144:147], v[96:111]
    v_mul_f32 v166, v166, v19
    v_mul_f32_dpp v183, v16, v183 row_newbcast:7 row_mask:0xf bank_mask:0xf
    v_mul_f32 v183, v183, v19
    v_cvt_pk_bf16_f32 v223, v206, v207
    v_mul_f32_dpp v172, v15, v172 row_newbcast:12 row_mask:0xf bank_mask:0xf
    v_mul_f32_dpp v170, v15, v170 row_newbcast:10 row_mask:0xf bank_mask:0xf
    v_mfma_f32_32x32x16_bf16 v[96:111], v[84:87], v[148:151], v[96:111]
    v_cvt_pk_bf16_f32 v220, v200, v201
    v_mul_f32 v172, v172, v19
    v_cvt_pk_bf16_f32 v217, v194, v195
    v_mul_f32_dpp v173, v15, v173 row_newbcast:13 row_mask:0xf bank_mask:0xf
    v_mul_f32 v173, v173, v19
    v_mfma_f32_32x32x16_bf16 v[128:143], a[40:43], a[56:59], v[128:143]
    v_cvt_pk_bf16_f32 v221, v202, v203
    v_mul_f32_dpp v164, v15, v164 row_newbcast:4 row_mask:0xf bank_mask:0xf
    v_mul_f32 v164, v164, v19
    v_mul_f32_dpp v163, v15, v163 row_newbcast:3 row_mask:0xf bank_mask:0xf
    v_mul_f32_dpp v184, v16, v184 row_newbcast:8 row_mask:0xf bank_mask:0xf
    v_mfma_f32_32x32x16_bf16 v[128:143], a[44:47], a[60:63], v[128:143]
    v_mul_f32_e64 v184, v184, v19
    v_cvt_pk_bf16_f32 v112, v112, v113
    v_cvt_pk_bf16_f32 v209, v242, v243
    v_cvt_pk_bf16_f32 v213, v250, v251
    v_cvt_pk_bf16_f32 v208, v240, v241
    v_cvt_pk_bf16_f32 v212, v248, v249
    v_mfma_f32_32x32x16_bf16 v[240:255], v[56:59], v[232:235], 0
    v_cvt_pk_bf16_f32 v113, v114, v115
    v_cvt_pk_bf16_f32 v115, v118, v119
    v_cvt_pk_bf16_f32 v118, v124, v125
    v_cvt_pk_bf16_f32 v218, v196, v197
    v_mul_f32_dpp v186, v16, v186 row_newbcast:10 row_mask:0xf bank_mask:0xf
    v_cvt_pk_bf16_f32 v216, v192, v193
    v_mfma_f32_32x32x16_bf16 v[192:207], v[32:35], v[232:235], 0
    v_cvt_pk_bf16_f32 v96, v96, v97
    v_cvt_pk_bf16_f32 v125, v138, v139
    v_cvt_pk_bf16_f32 v97, v98, v99
    v_cvt_pk_bf16_f32 v98, v100, v101
    v_mul_f32 v170, v170, v19
    v_cvt_pk_bf16_f32 v99, v102, v103
    v_mfma_f32_32x32x16_bf16 v[240:255], v[60:63], v[236:239], v[240:255]
    v_mul_f32 v188, v188, v19
    v_cvt_pk_bf16_f32 v101, v106, v107
    v_cvt_pk_bf16_f32 v100, v104, v105
    v_mul_f32_dpp v169, v15, v169 row_newbcast:9 row_mask:0xf bank_mask:0xf
    v_mul_f32 v169, v169, v19
    v_mfma_f32_32x32x16_bf16 v[240:255], v[64:67], v[208:211], v[240:255]
    v_mul_f32_dpp v168, v15, v168 row_newbcast:8 row_mask:0xf bank_mask:0xf
    v_mul_f32_dpp v180, v16, v180 row_newbcast:4 row_mask:0xf bank_mask:0xf
    v_mul_f32_dpp v161, v15, v161 row_newbcast:1 row_mask:0xf bank_mask:0xf
    v_mul_f32 v161, v161, v19
    v_cvt_pk_bf16_f32 v160, v160, v161
    v_cvt_pk_bf16_f32 v119, v126, v127
    v_mfma_f32_32x32x16_bf16 v[240:255], v[68:71], v[212:215], v[240:255]
    v_cvt_pk_bf16_f32 v114, v116, v117
    v_cvt_pk_bf16_f32 v117, v122, v123
    v_cvt_pk_bf16_f32 v122, v132, v133
    v_cvt_pk_bf16_f32 v127, v142, v143
    v_cvt_pk_bf16_f32 v116, v120, v121
    v_mul_f32 v175, v175, v19
    v_mfma_f32_32x32x16_bf16 v[240:255], v[72:75], v[216:219], v[240:255]
    v_mul_f32 v163, v163, v19
    v_mul_f32 v162, v162, v19
    v_cvt_pk_bf16_f32 v161, v162, v163
    v_cvt_pk_bf16_f32 v121, v130, v131
    v_mul_f32 v165, v165, v19
    v_cvt_pk_bf16_f32 v162, v164, v165
    v_mfma_f32_32x32x16_bf16 v[192:207], v[36:39], v[236:239], v[192:207]
    v_mul_f32 v168, v168, v19
    v_mul_f32 v171, v171, v19
    v_cvt_pk_bf16_f32 v165, v170, v171
    v_mul_f32_dpp v167, v15, v167 row_newbcast:7 row_mask:0xf bank_mask:0xf
    v_mul_f32 v167, v167, v19
    v_mul_f32 v174, v174, v19
    v_mfma_f32_32x32x16_bf16 v[240:255], v[76:79], v[220:223], v[240:255]
    v_cvt_pk_bf16_f32 v163, v166, v167
    v_cvt_pk_bf16_f32 v166, v172, v173
    v_cvt_pk_bf16_f32 v167, v174, v175
    v_mul_f32_dpp v190, v16, v190 row_newbcast:14 row_mask:0xf bank_mask:0xf
    v_mul_f32 v190, v190, v19
    v_cvt_pk_bf16_f32 v175, v190, v191
    v_mfma_f32_32x32x16_bf16 v[192:207], v[40:43], v[208:211], v[192:207]
    ds_write_b128 v6, v[96:99] offset:64
    v_mfma_f32_32x32x16_bf16 v[192:207], v[44:47], v[212:215], v[192:207]
    v_mul_f32_dpp v179, v16, v179 row_newbcast:3 row_mask:0xf bank_mask:0xf
    v_cvt_pk_bf16_f32 v123, v134, v135
    v_mul_f32 v179, v179, v19
    v_cvt_pk_bf16_f32 v126, v140, v141
    v_mul_f32_dpp v246, v16, v246 row_newbcast:6 row_mask:0xf bank_mask:0xf
    v_mul_f32_dpp v250, v16, v250 row_newbcast:10 row_mask:0xf bank_mask:0xf
    v_mfma_f32_32x32x16_bf16 v[192:207], v[48:51], v[216:219], v[192:207]
    v_mul_f32 v185, v185, v19
    v_cvt_pk_bf16_f32 v172, v184, v185
    v_mul_f32 v180, v180, v19
    v_mul_f32_dpp v254, v16, v254 row_newbcast:14 row_mask:0xf bank_mask:0xf
    v_mul_f32 v189, v189, v19
    v_mfma_f32_32x32x16_bf16 v[192:207], v[52:55], v[220:223], v[192:207]
    s_sub_u32 s66, 0, s66
    v_mul_f32_dpp v248, v16, v248 row_newbcast:8 row_mask:0xf bank_mask:0xf
    v_cvt_pk_bf16_f32 v102, v108, v109
    v_mul_f32 v186, v186, v19
    v_mul_f32 v187, v187, v19
    v_mul_f32_dpp v242, v16, v242 row_newbcast:2 row_mask:0xf bank_mask:0xf
    v_cvt_pk_bf16_f32 v173, v186, v187
    v_mfma_f32_4x4x4_16b_bf16 v[132:135], v[22:23], a[34:35], 0
    v_cvt_pk_bf16_f32 v120, v128, v129
    v_mfma_f32_4x4x4_16b_bf16 v[128:131], v[22:23], a[32:33], 0
    v_cvt_pk_bf16_f32 v103, v110, v111
    v_mfma_f32_4x4x4_16b_bf16 v[96:99], v[22:23], a[40:41], 0
    v_mfma_f32_4x4x4_16b_bf16 v[108:111], v[22:23], a[46:47], 0
    v_cvt_pk_bf16_f32 v124, v136, v137
    v_mfma_f32_4x4x4_16b_bf16 v[136:139], v[22:23], a[36:37], 0
    v_mul_f32_dpp v197, v15, v197 row_newbcast:5 row_mask:0xf bank_mask:0xf
    v_mfma_f32_4x4x4_16b_bf16 v[140:143], v[22:23], a[38:39], 0
    v_mfma_f32_4x4x4_16b_bf16 v[80:83], v[22:23], a[16:17], 0
    v_mul_f32_dpp v241, v16, v241 row_newbcast:1 row_mask:0xf bank_mask:0xf
    v_cvt_pk_bf16_f32 v171, v182, v183
    v_mfma_f32_32x32x16_bf16 v[128:143], v[88:91], v[152:155], v[128:143]
    ds_write_b128 v7, v[100:103] offset:64
    v_mfma_f32_32x32x16_bf16 v[128:143], v[92:95], v[156:159], v[128:143]
    v_mul_f32_dpp v249, v16, v249 row_newbcast:9 row_mask:0xf bank_mask:0xf
    v_mul_f32_dpp v196, v15, v196 row_newbcast:4 row_mask:0xf bank_mask:0xf
    v_mul_f32_dpp v202, v15, v202 row_newbcast:10 row_mask:0xf bank_mask:0xf
    v_mul_f32_dpp v252, v16, v252 row_newbcast:12 row_mask:0xf bank_mask:0xf
    v_mul_f32_dpp v193, v15, v193 row_newbcast:1 row_mask:0xf bank_mask:0xf
    v_cvt_pk_bf16_f32 v170, v180, v181
    v_mfma_f32_32x32x16_bf16 v[208:223], v[32:35], a[184:187], 0
    s_add_u32 s45, s40, 73728
    v_mul_f32_dpp v255, v16, v255 row_newbcast:15 row_mask:0xf bank_mask:0xf
    v_mul_f32_dpp v245, v16, v245 row_newbcast:5 row_mask:0xf bank_mask:0xf
    v_mul_f32_dpp v206, v15, v206 row_newbcast:14 row_mask:0xf bank_mask:0xf
    v_mul_f32_dpp v240, v16, v240 row_newbcast:0 row_mask:0xf bank_mask:0xf
    v_mul_f32_dpp v251, v16, v251 row_newbcast:11 row_mask:0xf bank_mask:0xf
    v_mul_f32_dpp v198, v15, v198 row_newbcast:6 row_mask:0xf bank_mask:0xf
    v_mfma_f32_32x32x16_bf16 v[208:223], v[36:39], a[188:191], v[208:223]
    v_mul_f32_dpp v203, v15, v203 row_newbcast:11 row_mask:0xf bank_mask:0xf
    v_mul_f32_dpp v243, v16, v243 row_newbcast:3 row_mask:0xf bank_mask:0xf
    v_cvt_pk_bf16_f32 v128, v128, v129
    v_cvt_pk_bf16_f32 v129, v130, v131
    v_cvt_pk_bf16_f32 v131, v134, v135
    v_cvt_pk_bf16_f32 v134, v140, v141
    v_mfma_f32_32x32x16_bf16 v[208:223], v[40:43], a[192:195], v[208:223]
    v_mul_f32_dpp v204, v15, v204 row_newbcast:12 row_mask:0xf bank_mask:0xf
    v_cvt_pk_bf16_f32 v130, v132, v133
    v_cvt_pk_bf16_f32 v132, v136, v137
    v_cvt_pk_bf16_f32 v164, v168, v169
    v_mul_f32_dpp v201, v15, v201 row_newbcast:9 row_mask:0xf bank_mask:0xf
    v_cvt_pk_bf16_f32 v168, v176, v177
    v_mfma_f32_32x32x16_bf16 v[208:223], v[44:47], a[196:199], v[208:223]
    v_mul_f32_dpp v192, v15, v192 row_newbcast:0 row_mask:0xf bank_mask:0xf
    v_mul_f32_dpp v194, v15, v194 row_newbcast:2 row_mask:0xf bank_mask:0xf
    v_mul_f32_dpp v199, v15, v199 row_newbcast:7 row_mask:0xf bank_mask:0xf
    v_max3_f32 v17, v192, v193, v194
    v_mul_f32_dpp v195, v15, v195 row_newbcast:3 row_mask:0xf bank_mask:0xf
    v_mul_f32_dpp v247, v16, v247 row_newbcast:7 row_mask:0xf bank_mask:0xf
    v_mfma_f32_32x32x16_bf16 v[208:223], v[48:51], a[200:203], v[208:223]
    v_mul_f32_dpp v207, v15, v207 row_newbcast:15 row_mask:0xf bank_mask:0xf
    v_max3_f32 v17, v17, v195, v196
    v_max3_f32 v17, v17, v197, v198
    v_mul_f32_dpp v200, v15, v200 row_newbcast:8 row_mask:0xf bank_mask:0xf
    v_max3_f32 v17, v17, v199, v200
    v_max3_f32 v17, v17, v201, v202
    v_mfma_f32_32x32x16_bf16 v[224:239], v[56:59], a[184:187], 0
    v_cvt_pk_bf16_f32 v174, v188, v189
    v_max3_f32 v17, v17, v203, v204
    v_mul_f32_dpp v205, v15, v205 row_newbcast:13 row_mask:0xf bank_mask:0xf
    v_mul_f32_dpp v244, v16, v244 row_newbcast:4 row_mask:0xf bank_mask:0xf
    v_max3_f32 v17, v17, v205, v206
    v_max3_f32 v17, v17, v207, v240
    v_mfma_f32_32x32x16_bf16 v[208:223], v[52:55], a[204:207], v[208:223]
    v_max3_f32 v17, v17, v241, v242
    v_max3_f32 v17, v17, v243, v244
    v_max3_f32 v17, v17, v245, v246
    v_max3_f32 v17, v17, v247, v248
    v_max3_f32 v17, v17, v249, v250
    v_mfma_f32_32x32x16_bf16 v[224:239], v[60:63], a[188:191], v[224:239]
    v_mul_f32_dpp v253, v16, v253 row_newbcast:13 row_mask:0xf bank_mask:0xf
    v_max3_f32 v17, v17, v251, v252
    v_max3_f32 v17, v17, v253, v254
    v_max_f32 v20, v17, v255
    v_max_f32 v17, v17, v255
    v_cvt_pk_bf16_f32 v208, v208, v209
    v_mfma_f32_32x32x16_bf16 v[224:239], v[64:67], a[192:195], v[224:239]
    ds_write_b128 v6, v[128:131] offset:6208
    v_cvt_pk_bf16_f32 v209, v210, v211
    v_mfma_f32_32x32x16_bf16 v[224:239], v[68:71], a[196:199], v[224:239]
    v_permlane32_swap_b32 v17, v20
    v_max_f32 v17, v17, v20
    v_mul_f32 v17, v17, v14
    v_fma_f32 v195, v195, v14, -v17
    v_exp_f32 v195, v195
    v_mfma_f32_4x4x4_16b_bf16 v[104:107], v[22:23], a[44:45], 0
    v_mfma_f32_4x4x4_16b_bf16 v[92:95], v[22:23], a[22:23], 0
    v_fma_f32 v193, v193, v14, -v17
    v_mfma_f32_4x4x4_16b_bf16 v[88:91], v[22:23], a[20:21], 0
    v_fma_f32 v198, v198, v14, -v17
    v_mfma_f32_4x4x4_16b_bf16 v[84:87], v[22:23], a[18:19], 0
    v_fma_f32 v205, v205, v14, -v17
    v_mfma_f32_4x4x4_16b_bf16 v[100:103], v[22:23], a[42:43], 0
    v_cvt_pk_bf16_f32 v211, v214, v215
    v_cvt_pk_bf16_f32 v215, v222, v223
    v_mfma_f32_32x32x16_bf16 v[224:239], v[72:75], a[200:203], v[224:239]
    v_fma_f32 v196, v196, v14, -v17
    v_exp_f32 v196, v196
    v_exp_f32 v198, v198
    v_mul_f32 v178, v178, v19
    v_mfma_f32_32x32x16_bf16 v[224:239], v[76:79], a[204:207], v[224:239]
    v_fma_f32 v194, v194, v14, -v17
    v_fma_f32 v192, v192, v14, -v17
    v_exp_f32 v194, v194
    v_exp_f32 v192, v192
    v_mfma_f32_32x32x16_bf16 v[80:95], v[112:115], v[144:147], v[80:95]
    v_cvt_pk_bf16_f32 v210, v212, v213
    v_cvt_pk_bf16_f32 v213, v218, v219
    v_exp_f32 v193, v193
    v_cvt_pk_bf16_f32 v212, v216, v217
    v_add_f32 v19, v192, v193
    v_mfma_f32_32x32x16_bf16 v[80:95], v[116:119], v[148:151], v[80:95]
    v_fma_f32 v197, v197, v14, -v17
    v_exp_f32 v197, v197
    v_cvt_pk_bf16_f32 v169, v178, v179
    v_cvt_pk_bf16_f32 v216, v224, v225
    v_cvt_pk_bf16_f32 v135, v142, v143
    v_mfma_f32_32x32x16_bf16 v[176:191], v[56:59], a[208:211], 0
    v_add_f32 v19, v19, v194
    v_add_f32 v19, v19, v195
    v_add_f32_e64 v19, v19, v196
    v_cvt_pk_bf16_f32 v223, v238, v239
    v_cvt_pk_bf16_f32 v218, v228, v229
    v_mul_f32_dpp v195, v15, v195 row_newbcast:3 row_mask:0xf bank_mask:0xf
    v_mfma_f32_32x32x16_bf16 v[176:191], v[60:63], a[212:215], v[176:191]
    v_cvt_pk_bf16_f32 v80, v80, v81
    v_cvt_pk_bf16_f32 v81, v82, v83
    v_cvt_pk_bf16_f32 v133, v138, v139
    v_cvt_pk_bf16_f32 v83, v86, v87
    v_cvt_pk_bf16_f32 v219, v230, v231
    v_cvt_pk_bf16_f32 v87, v94, v95
    v_mfma_f32_32x32x16_bf16 v[176:191], v[64:67], a[216:219], v[176:191]
    v_fma_f32 v202, v202, v14, -v17
    v_cvt_pk_bf16_f32 v214, v220, v221
    v_cvt_pk_bf16_f32 v221, v234, v235
    v_cvt_pk_bf16_f32 v217, v226, v227
    v_cvt_pk_bf16_f32 v222, v236, v237
    v_cvt_pk_bf16_f32 v220, v232, v233
    v_mfma_f32_32x32x16_bf16 v[224:239], v[32:35], a[208:211], 0
    v_fma_f32 v199, v199, v14, -v17
    v_exp_f32_e64 v199, v199
    v_add_f32 v19, v19, v197
    v_add_f32 v19, v19, v198
    v_add_f32 v19, v19, v199
    v_mfma_f32_32x32x16_bf16 v[224:239], v[36:39], a[212:215], v[224:239]
    v_cvt_pk_bf16_f32 v82, v84, v85
    v_cvt_pk_bf16_f32 v86, v92, v93
    v_fma_f32 v201, v201, v14, -v17
    v_cvt_pk_bf16_f32 v84, v88, v89
    v_exp_f32 v201, v201
    v_mfma_f32_32x32x16_bf16 v[224:239], v[40:43], a[216:219], v[224:239]
    ds_write_b128 v6, v[80:83] offset:128
    v_mul_f32_dpp v197, v15, v197 row_newbcast:5 row_mask:0xf bank_mask:0xf
    v_mfma_f32_32x32x16_bf16 v[224:239], v[44:47], a[220:223], v[224:239]
    v_fma_f32 v200, v200, v14, -v17
    v_exp_f32 v200, v200
    v_fma_f32 v204, v204, v14, -v17
    v_exp_f32 v204, v204
    v_mfma_f32_32x32x16_bf16 v[224:239], v[48:51], a[224:227], v[224:239]
    v_add_f32 v19, v19, v200
    v_mul_f32_dpp v200, v15, v200 row_newbcast:8 row_mask:0xf bank_mask:0xf
    v_add_f32 v19, v19, v201
    v_mul_f32_dpp v199, v15, v199 row_newbcast:7 row_mask:0xf bank_mask:0xf
    v_exp_f32 v205, v205
    v_mfma_f32_32x32x16_bf16 v[224:239], v[52:55], a[228:231], v[224:239]
    v_fma_f32 v203, v203, v14, -v17
    v_exp_f32 v203, v203
    v_exp_f32 v202, v202
    v_mul_f32_dpp v198, v15, v198 row_newbcast:6 row_mask:0xf bank_mask:0xf
    v_mfma_f32_32x32x16_bf16 v[176:191], v[68:71], a[220:223], v[176:191]
    v_cvt_pk_bf16_f32 v85, v90, v91
    v_add_f32 v19, v19, v202
    v_add_f32 v19, v19, v203
    v_mul_f32_dpp v193, v15, v193 row_newbcast:1 row_mask:0xf bank_mask:0xf
    v_cvt_pk_bf16_f32 v224, v224, v225
    v_mfma_f32_32x32x16_bf16 v[176:191], v[72:75], a[224:227], v[176:191]
    v_cvt_pk_bf16_f32 v225, v226, v227
    v_cvt_pk_bf16_f32 v226, v228, v229
    v_add_f32 v19, v19, v204
    v_cvt_pk_bf16_f32 v228, v232, v233
    v_cvt_pk_bf16_f32 v227, v230, v231
    v_cvt_pk_bf16_f32 v231, v238, v239
    v_mfma_f32_32x32x16_bf16 v[176:191], v[76:79], a[228:231], v[176:191]
    ds_write_b128 v7, v[132:135] offset:6208
    v_mul_f32_dpp v201, v15, v201 row_newbcast:9 row_mask:0xf bank_mask:0xf
    v_mfma_f32_32x32x16_bf16 v[96:111], v[120:123], v[152:155], v[96:111]
    v_mul_f32_dpp v202, v15, v202 row_newbcast:10 row_mask:0xf bank_mask:0xf
    v_mul_f32_dpp v194, v15, v194 row_newbcast:2 row_mask:0xf bank_mask:0xf
    v_cvt_pk_bf16_f32 v229, v234, v235
    v_cvt_pk_bf16_f32 v230, v236, v237
    v_cvt_pk_bf16_f32 v233, v178, v179
    v_cvt_pk_bf16_f32 v235, v182, v183
    v_mfma_f32_32x32x16_bf16 v[96:111], v[124:127], v[156:159], v[96:111]
    v_cvt_pk_bf16_f32 v237, v186, v187
    v_cvt_pk_bf16_f32 v239, v190, v191
    v_cvt_pk_bf16_f32 v238, v188, v189
    v_cvt_pk_bf16_f32 v232, v176, v177
    v_cvt_pk_bf16_f32 v234, v180, v181
    v_cvt_pk_bf16_f32 v236, v184, v185
    v_mfma_f32_32x32x16_bf16 v[176:191], v[32:35], a[232:235], 0
    ds_write_b128 v7, v[84:87] offset:128
    v_mfma_f32_32x32x16_bf16 v[176:191], v[36:39], a[236:239], v[176:191]
    v_cvt_pk_bf16_f32 v96, v96, v97
    v_cvt_pk_bf16_f32 v97, v98, v99
    v_cvt_pk_bf16_f32 v98, v100, v101
    v_cvt_pk_bf16_f32 v101, v106, v107
    v_cvt_pk_bf16_f32 v99, v102, v103
    v_cvt_pk_bf16_f32 v102, v108, v109
    v_mfma_f32_32x32x16_bf16 v[176:191], v[40:43], a[240:243], v[176:191]
    ds_write_b128 v6, v[96:99] offset:6272
    v_cvt_pk_bf16_f32 v100, v104, v105
    v_mfma_f32_32x32x16_bf16 v[176:191], v[44:47], a[244:247], v[176:191]
    v_cvt_pk_bf16_f32 v103, v110, v111
    v_fma_f32 v206, v206, v14, -v17
    v_exp_f32 v206, v206
    v_mfma_f32_32x32x16_bf16 v[176:191], v[48:51], a[248:251], v[176:191]
    ds_write_b128 v7, v[100:103] offset:6272
    v_add_u32 v7, s65, v7
    v_mfma_f32_32x32x16_bf16 v[176:191], v[52:55], a[252:255], v[176:191]
    s_mov_b32 s40, s41
    v_add_f32 v19, v19, v205
    v_mul_f32_dpp v205, v15, v205 row_newbcast:13 row_mask:0xf bank_mask:0xf
    v_add_f32 v19, v19, v206
    v_add_u32_e64 v6, s65, v6
    v_mul_f32_dpp v203, v15, v203 row_newbcast:11 row_mask:0xf bank_mask:0xf
    s_mov_b32 s41, s38
    v_mul_f32_dpp v204, v15, v204 row_newbcast:12 row_mask:0xf bank_mask:0xf
    v_mul_f32_dpp v192, v15, v192 row_newbcast:0 row_mask:0xf bank_mask:0xf
    v_mul_f32_dpp v196, v15, v196 row_newbcast:4 row_mask:0xf bank_mask:0xf
    s_sub_u32 s65, 0, s65
    s_nop 0
    v_cvt_pk_bf16_f32 v26, v180, v181
    v_cvt_pk_bf16_f32 v31, v190, v191
    v_cvt_pk_bf16_f32 v28, v184, v185
    v_cvt_pk_bf16_f32 v29, v186, v187
    v_cvt_pk_bf16_f32 v24, v176, v177
    v_cvt_pk_bf16_f32 v27, v182, v183
    v_cvt_pk_bf16_f32 v30, v188, v189
    v_cvt_pk_bf16_f32 v25, v178, v179
    s_waitcnt vmcnt(0) lgkmcnt(0)
    s_barrier
L_loop:
    v_mfma_f32_32x32x16_bf16 v[176:191], v[56:59], a[232:235], 0
    s_add_u32 s36, s36, 256
    ds_read_b128 a[4:7], v7 offset:0
    ds_read_b128 a[0:3], v6 offset:0
    v_fma_f32 v250, v250, v14, -v17
    v_fma_f32 v242, v242, v14, -v17
    v_fma_f32 v241, v241, v14, -v17
    v_mfma_f32_32x32x16_bf16 v[176:191], v[60:63], a[236:239], v[176:191]
    ds_read_b128 a[32:35], v6 offset:6208
    ds_read_b128 a[28:31], v7 offset:6144
    v_fma_f32 v244, v244, v14, -v17
    v_fma_f32 v253, v253, v14, -v17
    v_fma_f32 v247, v247, v14, -v17
    v_mfma_f32_32x32x16_bf16 v[176:191], v[64:67], a[240:243], v[176:191]
    v_and_b32 v139, s62, v45
    v_fma_f32 v240, v240, v14, -v17
    v_exp_f32 v240, v240
    v_exp_f32 v247, v247
    v_mfma_f32_32x32x16_bf16 v[176:191], v[68:71], a[244:247], v[176:191]
    ds_read_b128 a[8:11], v6 offset:64
    v_exp_f32 v241, v241
    v_fma_f32 v252, v252, v14, -v17
    v_exp_f32 v250, v250
    v_mfma_f32_32x32x16_bf16 v[176:191], v[72:75], a[248:251], v[176:191]
    ds_read_b128 a[24:27], v6 offset:6144
    v_exp_f32 v252, v252
    v_exp_f32 v253, v253
    v_lshlrev_b32 v128, 16, v40
    v_mfma_f32_32x32x16_bf16 v[176:191], v[76:79], a[252:255], v[176:191]
    s_waitcnt lgkmcnt(4)
    ds_read_b128 a[12:15], v7 offset:64
    v_fma_f32 v207, v207, v14, -v17
    v_exp_f32 v244, v244
    v_exp_f32 v207, v207
    v_mfma_f32_16x16x32_bf16 v[152:155], a[48:51], a[0:3], 0
    v_fma_f32 v251, v251, v14, -v17
    v_and_b32 v131, s62, v41
    v_mfma_f32_16x16x32_bf16 v[152:155], a[48:51], a[4:7], v[152:155]
    v_exp_f32 v251, v251
    v_mfma_f32_32x32x16_bf16 v[80:95], a[72:75], a[0:3], 0
    s_mul_i32 s42, s36, 43691
    ds_read_b128 a[36:39], v7 offset:6208
    v_exp_f32 v242, v242
    v_fma_f32 v249, v249, v14, -v17
    v_exp_f32 v249, v249
    v_mfma_f32_32x32x16_bf16 v[80:95], a[76:79], a[4:7], v[80:95]
    s_waitcnt lgkmcnt(3)
    v_add_f32 v19, v19, v207
    v_add_f32 v19, v19, v240
    v_lshlrev_b32 v134, 16, v43
    v_fma_f32 v248, v248, v14, -v17
    v_exp_f32 v248, v248
    v_mfma_f32_16x16x32_bf16 v[152:155], a[48:51], a[8:11], v[152:155]
    s_waitcnt lgkmcnt(2)
    ds_read_b128 a[40:43], v6 offset:6272
    v_fma_f32 v245, v245, v14, -v17
    v_mfma_f32_32x32x16_bf16 v[96:111], a[72:75], a[24:27], 0
    s_waitcnt lgkmcnt(2)
    v_fma_f32 v246, v246, v14, -v17
    v_exp_f32 v246, v246
    v_lshlrev_b32 v142, 16, v47
    v_exp_f32 v245, v245
    v_mfma_f32_16x16x32_bf16 v[152:155], a[48:51], a[12:15], v[152:155]
    ds_read_b128 a[16:19], v6 offset:128
    v_add_f32 v19, v19, v241
    v_mul_f32_dpp v241, v16, v241 row_newbcast:1 row_mask:0xf bank_mask:0xf
    v_mfma_f32_4x4x4_16b_bf16 v[144:147], a[0:1], a[0:1], 0
    v_add_f32 v19, v19, v242
    v_mfma_f32_4x4x4_16b_bf16 v[148:151], a[24:25], a[24:25], 0
    v_lshlrev_b32 v112, 16, v32
    v_mfma_f32_4x4x4_16b_bf16 v[144:147], a[2:3], a[2:3], v[144:147]
    v_fma_f32 v243, v243, v14, -v17
    v_mfma_f32_4x4x4_16b_bf16 v[148:151], a[26:27], a[26:27], v[148:151]
    v_lshlrev_b32_e64 v138, 16, v45
    v_mfma_f32_4x4x4_16b_bf16 v[144:147], a[4:5], a[4:5], v[144:147]
    v_fma_f32 v255, v255, v14, -v17
    v_mfma_f32_4x4x4_16b_bf16 v[148:151], a[28:29], a[28:29], v[148:151]
    v_mul_f32_dpp v207, v15, v207 row_newbcast:15 row_mask:0xf bank_mask:0xf
    v_mfma_f32_4x4x4_16b_bf16 v[144:147], a[6:7], a[6:7], v[144:147]
    v_and_b32 v133, s62, v42
    v_mfma_f32_4x4x4_16b_bf16 v[148:151], a[30:31], a[30:31], v[148:151]
    v_mul_f32_dpp v242, v16, v242 row_newbcast:2 row_mask:0xf bank_mask:0xf
    v_mfma_f32_4x4x4_16b_bf16 v[144:147], a[8:9], a[8:9], v[144:147]
    v_and_b32 v113, s62, v32
    v_mfma_f32_4x4x4_16b_bf16 v[148:151], a[32:33], a[32:33], v[148:151]
    v_and_b32 v137, s62, v44
    v_mfma_f32_4x4x4_16b_bf16 v[144:147], a[10:11], a[10:11], v[144:147]
    v_and_b32 v141, s62, v46
    v_mfma_f32_4x4x4_16b_bf16 v[148:151], a[34:35], a[34:35], v[148:151]
    v_lshlrev_b32 v136, 16, v44
    v_mfma_f32_4x4x4_16b_bf16 v[144:147], a[12:13], a[12:13], v[144:147]
    v_exp_f32 v243, v243
    v_mfma_f32_32x32x16_bf16 v[80:95], a[80:83], a[8:11], v[80:95]
    ds_read_b128 a[20:23], v7 offset:128
    v_add_f32 v19, v19, v243
    v_add_f32 v19, v19, v244
    v_and_b32 v125, s62, v38
    v_add_f32 v19, v19, v245
    v_mul_f32_dpp v243, v16, v243 row_newbcast:3 row_mask:0xf bank_mask:0xf
    v_mfma_f32_32x32x16_bf16 v[80:95], a[84:87], a[12:15], v[80:95]
    s_waitcnt lgkmcnt(1)
    v_mul_f32_dpp v245, v16, v245 row_newbcast:5 row_mask:0xf bank_mask:0xf
    v_add_f32 v19, v19, v246
    v_add_f32 v19, v19, v247
    v_add_f32 v19, v19, v248
    v_add_f32 v19, v19, v249
    v_add_f32 v19, v19, v250
    v_mfma_f32_32x32x16_bf16 v[96:111], a[76:79], a[28:31], v[96:111]
    s_lshr_b32 s42, s42, 21
    v_add_f32 v19, v19, v251
    v_add_f32 v19, v19, v252
    v_lshlrev_b32 v140, 16, v46
    v_fma_f32 v254, v254, v14, -v17
    v_exp_f32 v254, v254
    v_mfma_f32_32x32x16_bf16 v[96:111], a[80:83], a[32:35], v[96:111]
    s_mul_i32 s43, s42, 48
    v_add_f32 v19, v19, v253
    v_exp_f32 v255, v255
    v_add_f32 v19, v19, v254
    v_add_f32 v19, v19, v255
    v_mov_b32 v20, v19
    v_mfma_f32_32x32x16_bf16 v[80:95], a[88:91], a[16:19], v[80:95]
    s_sub_u32 s43, s36, s43
    v_permlane32_swap_b32 v19, v20
    v_add_f32 v19, v19, v20
    v_rcp_f32 v19, v19
    v_mul_f32_dpp v253, v16, v253 row_newbcast:13 row_mask:0xf bank_mask:0xf
    v_mfma_f32_16x16x32_bf16 v[152:155], a[48:51], a[16:19], v[152:155]
    s_waitcnt lgkmcnt(0)
    v_and_b32 v129, s62, v40
    v_lshlrev_b32 v130, 16, v41
    v_mfma_f32_16x16x32_bf16 v[152:155], a[48:51], a[20:23], v[152:155]
    v_mul_f32_dpp v251, v16, v251 row_newbcast:11 row_mask:0xf bank_mask:0xf
    v_mul_f32_dpp v252, v16, v252 row_newbcast:12 row_mask:0xf bank_mask:0xf
    v_mfma_f32_16x16x32_bf16 v[152:155], a[52:55], a[24:27], v[152:155]
    v_lshlrev_b32 v132, 16, v42
    v_mul_f32 v202, v202, v19
    v_mfma_f32_16x16x32_bf16 v[152:155], a[52:55], a[28:31], v[152:155]
    v_mul_f32 v251, v251, v19
    v_mul_f32 v205, v205, v19
    v_mfma_f32_16x16x32_bf16 v[152:155], a[52:55], a[32:35], v[152:155]
    v_and_b32 v135, s62, v43
    v_lshlrev_b32 v114, 16, v33
    v_mfma_f32_16x16x32_bf16 v[152:155], a[52:55], a[36:39], v[152:155]
    ds_read_b128 a[44:47], v7 offset:6272
    v_and_b32 v127, s62, v39
    v_mfma_f32_32x32x16_bf16 v[96:111], a[84:87], a[36:39], v[96:111]
    v_and_b32 v143, s62, v47
    v_mul_f32 v252, v252, v19
    v_and_b32 v117, s62, v34
    v_mul_f32 v192, v192, v19
    v_mul_f32 v253, v253, v19
    v_and_b32 v123, s62, v37
    v_mfma_f32_32x32x16_bf16 v[128:143], v[224:227], v[160:163], v[128:143]
    v_mul_f32_dpp v240, v16, v240 row_newbcast:0 row_mask:0xf bank_mask:0xf
    v_lshlrev_b32 v124, 16, v38
    v_lshlrev_b32 v118, 16, v35
    v_lshlrev_b32 v122, 16, v37
    v_mul_f32_dpp v246, v16, v246 row_newbcast:6 row_mask:0xf bank_mask:0xf
    v_mul_f32 v199, v199, v19
    v_mfma_f32_32x32x16_bf16 v[80:95], a[92:95], a[20:23], v[80:95]
    v_mul_f32_dpp v248, v16, v248 row_newbcast:8 row_mask:0xf bank_mask:0xf
    v_mul_f32 v248, v248, v19
    v_lshlrev_b32 v116, 16, v34
    v_lshlrev_b32 v120, 16, v36
    v_mul_f32_dpp v250, v16, v250 row_newbcast:10 row_mask:0xf bank_mask:0xf
    v_mul_f32 v201, v201, v19
    v_mfma_f32_32x32x16_bf16 v[128:143], v[228:231], v[164:167], v[128:143]
    v_and_b32 v115, s62, v33
    v_mul_f32_dpp v254, v16, v254 row_newbcast:14 row_mask:0xf bank_mask:0xf
    v_mul_f32_dpp v247, v16, v247 row_newbcast:7 row_mask:0xf bank_mask:0xf
    v_mul_f32 v247, v247, v19
    v_mul_f32_dpp v206, v15, v206 row_newbcast:14 row_mask:0xf bank_mask:0xf
    v_mul_f32 v254, v254, v19
    v_mfma_f32_32x32x16_bf16 v[96:111], a[88:91], a[40:43], v[96:111]
    s_waitcnt lgkmcnt(0)
    v_mul_f32_dpp v249, v16, v249 row_newbcast:9 row_mask:0xf bank_mask:0xf
    v_mul_f32 v250, v250, v19
    v_mul_f32 v198, v198, v19
    v_mul_f32 v207, v207, v19
    v_mul_f32 v249, v249, v19
    v_mul_f32 v245, v245, v19
    v_mfma_f32_32x32x16_bf16 v[96:111], a[92:95], a[44:47], v[96:111]
    v_mul_f32 v193, v193, v19
    v_lshlrev_b32 v126, 16, v39
    v_mul_f32 v195, v195, v19
    v_cvt_pk_bf16_f32 v192, v192, v193
    v_mul_f32 v242, v242, v19
    v_mul_f32 v194, v194, v19
    v_mfma_f32_32x32x16_bf16 v[128:143], v[232:235], v[168:171], v[128:143]
    v_mul_f32 v206, v206, v19
    v_cvt_pk_bf16_f32 v193, v194, v195
    v_cvt_pk_bf16_f32 v195, v198, v199
    v_cvt_pk_bf16_f32 v199, v206, v207
    v_cvt_pk_bf16_f32 v206, v252, v253
    v_and_b32 v253, s62, v54
    v_mul_f32 v197, v197, v19
    v_mfma_f32_4x4x4_16b_bf16 v[148:151], a[36:37], a[36:37], v[148:151]
    v_mul_f32 v203, v203, v19
    v_mfma_f32_4x4x4_16b_bf16 v[144:147], a[14:15], a[14:15], v[144:147]
    v_mul_f32 v204, v204, v19
    v_mfma_f32_4x4x4_16b_bf16 v[148:151], a[38:39], a[38:39], v[148:151]
    v_mul_f32 v240, v240, v19
    v_mfma_f32_4x4x4_16b_bf16 v[144:147], a[16:17], a[16:17], v[144:147]
    v_lshlrev_b32 v252, 16, v54
    v_mfma_f32_4x4x4_16b_bf16 v[148:151], a[40:41], a[40:41], v[148:151]
    v_cvt_pk_bf16_f32 v198, v204, v205
    v_mfma_f32_4x4x4_16b_bf16 v[144:147], a[18:19], a[18:19], v[144:147]
    v_and_b32 v119, s62, v35
    v_mfma_f32_4x4x4_16b_bf16 v[148:151], a[42:43], a[42:43], v[148:151]
    v_mul_f32_dpp v255, v16, v255 row_newbcast:15 row_mask:0xf bank_mask:0xf
    v_mfma_f32_4x4x4_16b_bf16 v[144:147], a[20:21], a[20:21], v[144:147]
    v_and_b32 v121, s62, v36
    v_mfma_f32_4x4x4_16b_bf16 v[148:151], a[44:45], a[44:45], v[148:151]
    v_cvt_pk_bf16_f32 v205, v250, v251
    v_mfma_f32_4x4x4_16b_bf16 v[144:147], a[22:23], a[22:23], v[144:147]
    v_cvt_pk_bf16_f32 v204, v248, v249
    v_mfma_f32_4x4x4_16b_bf16 v[148:151], a[46:47], a[46:47], v[148:151]
    v_mul_f32 v200, v200, v19
    v_and_b32 v249, s62, v52
    v_mfma_f32_32x32x16_bf16 v[112:127], v[208:211], v[160:163], v[112:127]
    v_mul_f32 v241, v241, v19
    v_mul_f32 v196, v196, v19
    v_cvt_pk_bf16_f32 v194, v196, v197
    v_cvt_pk_bf16_f32 v196, v200, v201
    v_cvt_pk_bf16_f32 v200, v240, v241
    v_lshlrev_b32 v240, 16, v48
    v_mfma_f32_32x32x16_bf16 v[112:127], v[212:215], v[164:167], v[112:127]
    v_lshlrev_b32 v250, 16, v53
    v_mul_f32 v243, v243, v19
    v_cvt_pk_bf16_f32 v197, v202, v203
    v_mul_f32 v246, v246, v19
    v_cvt_pk_bf16_f32 v203, v246, v247
    v_and_b32 v247, s62, v51
    v_mfma_f32_16x16x32_bf16 v[152:155], a[52:55], a[40:43], v[152:155]
    v_cvt_pk_bf16_f32 v201, v242, v243
    v_lshlrev_b32 v242, 16, v49
    v_mfma_f32_32x32x16_bf16 v[128:143], v[236:239], v[172:175], v[128:143]
    v_mul_f32 v255, v255, v19
    v_mul_f32_dpp v244, v16, v244 row_newbcast:4 row_mask:0xf bank_mask:0xf
    v_mul_f32 v244, v244, v19
    v_cvt_pk_bf16_f32 v207, v254, v255
    v_lshlrev_b32 v246, 16, v51
    v_and_b32 v251, s62, v53
    v_mfma_f32_32x32x16_bf16 v[112:127], v[216:219], v[168:171], v[112:127]
    v_lshlrev_b32 v254, 16, v55
    v_and_b32 v243, s62, v49
    v_cvt_pk_bf16_f32 v202, v244, v245
    v_and_b32 v241, s62, v48
    v_lshlrev_b32 v244, 16, v50
    v_and_b32 v255, s62, v55
    v_mfma_f32_32x32x16_bf16 v[112:127], v[220:223], v[172:175], v[112:127]
    v_cvt_pk_bf16_f32 v176, v176, v177
    v_lshlrev_b32 v248, 16, v52
    v_and_b32 v245, s62, v50
    v_cvt_pk_bf16_f32 v177, v178, v179
    v_cvt_pk_bf16_f32 v179, v182, v183
    v_cvt_pk_bf16_f32 v182, v188, v189
    v_mfma_f32_32x32x16_bf16 v[240:255], v[24:27], v[160:163], v[240:255]
    ds_read_b128 v[52:55], v9 offset:128
    v_and_b32 v161, s62, v56
    v_lshlrev_b32 v160, 16, v56
    v_cvt_pk_bf16_f32 v178, v180, v181
    v_cvt_pk_bf16_f32 v181, v186, v187
    v_cvt_pk_bf16_f32 v183, v190, v191
    v_mfma_f32_32x32x16_bf16 v[240:255], v[28:31], v[164:167], v[240:255]
    s_mul_i32 s42, s42, 589824
    ds_read_b128 v[40:43], v8 offset:64
    v_and_b32 v165, s62, v58
    v_and_b32 v167, s62, v59
    v_lshlrev_b32 v162, 16, v57
    v_lshlrev_b32 v164, 16, v58
    v_and_b32 v163, s62, v57
    v_mfma_f32_32x32x16_bf16 v[240:255], v[176:179], v[168:171], v[240:255]
    v_lshlrev_b32 v170, 16, v61
    v_lshlrev_b32 v168, 16, v60
    v_lshlrev_b32 v166, 16, v59
    v_cvt_pk_bf16_f32 v180, v184, v185
    v_and_b32_e64 v169, s62, v60
    v_and_b32_e64 v171, s62, v61
    v_mfma_f32_32x32x16_bf16 v[240:255], v[180:183], v[172:175], v[240:255]
    v_and_b32_e64 v175, s62, v63
    v_lshlrev_b32_e64 v172, 16, v62
    v_lshlrev_b32_e64 v174, 16, v63
    v_and_b32_e64 v173, s62, v62
    v_cvt_pk_bf16_f32 v128, v128, v129
    s_nop 0
    v_mfma_f32_32x32x16_bf16 v[160:175], v[208:211], v[192:195], v[160:175]
    ds_read_b128 v[36:39], v9 offset:0
    v_cvt_pk_bf16_f32 v129, v130, v131
    v_cvt_pk_bf16_f32 v131, v134, v135
    v_cvt_pk_bf16_f32 v135, v142, v143
    v_cvt_pk_bf16_f32 v80, v80, v81
    v_and_b32_e64 v209, s62, v64
    v_mfma_f32_32x32x16_bf16 v[160:175], v[212:215], v[196:199], v[160:175]
    ds_read_b128 v[32:35], v8 offset:0
    ds_read_b128 v[44:47], v9 offset:64
    v_lshlrev_b32 v210, 16, v65
    v_lshlrev_b32 v212, 16, v66
    v_lshlrev_b32 v214, 16, v67
    v_mfma_f32_32x32x16_bf16 v[160:175], v[216:219], v[200:203], v[160:175]
    v_and_b32 v219, s62, v69
    v_and_b32 v217, s62, v68
    v_lshlrev_b32 v218, 16, v69
    v_and_b32 v211, s62, v65
    v_lshlrev_b32 v208, 16, v64
    v_and_b32 v215, s62, v67
    v_mfma_f32_32x32x16_bf16 v[160:175], v[220:223], v[204:207], v[160:175]
    v_lshlrev_b32 v222, 16, v71
    v_lshlrev_b32 v216, 16, v68
    v_and_b32 v223, s62, v71
    v_lshlrev_b32 v220, 16, v70
    v_and_b32 v213, s62, v66
    v_and_b32 v221, s62, v70
    v_mfma_f32_16x16x32_bf16 v[152:155], a[52:55], a[44:47], v[152:155]
    v_cvt_pk_bf16_f32 v112, v112, v113
    v_cvt_pk_bf16_f32 v113, v114, v115
    v_mfma_f32_32x32x16_bf16 v[208:223], v[224:227], v[192:195], v[208:223]
    ds_read_b128 a[56:59], v11 offset:0
    v_cvt_pk_bf16_f32 v115, v118, v119
    v_cvt_pk_bf16_f32 v118, v124, v125
    v_cvt_pk_bf16_f32 v119, v126, v127
    v_and_b32 v227, s62, v73
    v_lshlrev_b32 v224, 16, v72
    v_mfma_f32_32x32x16_bf16 v[208:223], v[228:231], v[196:199], v[208:223]
    ds_read_b128 v[48:51], v8 offset:128
    v_cvt_pk_bf16_f32 v130, v132, v133
    v_lshlrev_b32 v230, 16, v75
    v_lshlrev_b32 v226, 16, v73
    v_lshlrev_b32 v228, 16, v74
    v_and_b32 v229, s62, v74
    v_mfma_f32_32x32x16_bf16 v[208:223], v[232:235], v[200:203], v[208:223]
    v_lshlrev_b32 v234, 16, v77
    v_and_b32 v235, s62, v77
    v_lshlrev_b32 v232, 16, v76
    v_and_b32 v225, s62, v72
    v_and_b32 v233, s62, v76
    v_and_b32 v231, s62, v75
    v_mfma_f32_32x32x16_bf16 v[208:223], v[236:239], v[204:207], v[208:223]
    v_and_b32 v237, s62, v78
    v_lshlrev_b32 v236, 16, v78
    v_lshlrev_b32 v238, 16, v79
    v_and_b32 v239, s62, v79
    v_cvt_pk_bf16_f32 v114, v116, v117
    v_cvt_pk_bf16_f32 v116, v120, v121
    v_mfma_f32_32x32x16_bf16 v[224:239], v[24:27], v[192:195], v[224:239]
    s_mul_i32 s43, s43, 1536
    ds_write_b128 v10, v[112:115] offset:0
    s_add_u32 s38, s42, s43
    v_mfma_f32_32x32x16_bf16 v[224:239], v[28:31], v[196:199], v[224:239]
    s_cmp_lt_u32 s36, 2304
    v_cndmask_b32_e64 v148, v148, v149, s[56:57]
    v_cndmask_b32_e64 v148, v148, v150, s[58:59]
    v_cndmask_b32_e64 v144, v144, v145, s[56:57]
    v_cndmask_b32_e64 v148, v148, v151, s[60:61]
    v_cndmask_b32_e64 v144, v144, v146, s[58:59]
    v_cndmask_b32_e64 v144, v144, v147, s[60:61]
    v_mfma_f32_32x32x16_bf16 v[224:239], v[176:179], v[200:203], v[224:239]
    s_cselect_b32 s38, s38, 0x80000000
    v_cvt_pk_bf16_f32 v240, v240, v241
    v_cvt_pk_bf16_f32 v241, v242, v243
    v_cvt_pk_bf16_f32 v242, v244, v245
    s_add_u32 s39, s38, 73728
    v_cvt_pk_bf16_f32 v96, v96, v97
    s_add_u32 m0, s35, 0
    v_mfma_f32_32x32x16_bf16 v[224:239], v[180:183], v[204:207], v[224:239]
    s_waitcnt lgkmcnt(1)
    ds_write_b128 v10, v[128:131] offset:64
    v_cvt_pk_bf16_f32 v117, v122, v123
    v_mfma_f32_32x32x16_bf16 v[192:207], a[160:163], v[32:35], 0
    buffer_load_dwordx4 v1, s[16:19], s38 offen offset:1024 sc0 sc1 nt lds
    v_cvt_pk_bf16_f32 v132, v136, v137
    v_cvt_pk_bf16_f32 v243, v246, v247
    v_mfma_f32_32x32x16_bf16 v[176:191], a[136:139], v[32:35], 0
    ds_write_b128 v21, v[116:119] offset:0
    v_cvt_pk_bf16_f32 v134, v140, v141
    v_mfma_f32_32x32x16_bf16 v[192:207], a[164:167], v[36:39], v[192:207]
    v_cvt_pk_bf16_f32 v208, v208, v209
    v_cvt_pk_bf16_f32 v209, v210, v211
    v_cvt_pk_bf16_f32 v160, v160, v161
    v_cvt_pk_bf16_f32 v81, v82, v83
    v_cvt_pk_bf16_f32 v82, v84, v85
    v_cvt_pk_bf16_f32 v84, v88, v89
    v_mfma_f32_32x32x16_bf16 v[176:191], a[140:143], v[36:39], v[176:191]
    ds_write_b128 v10, v[240:243] offset:128
    v_mfma_f32_32x32x16_bf16 v[176:191], a[144:147], v[40:43], v[176:191]
    v_fma_f32 v152, -v152, v152, s64
    v_permlane32_swap_b32 v144, v148
    v_cvt_pk_bf16_f32 v245, v250, v251
    v_add_f32 v144, v144, v148
    v_fma_f32 v144, v144, s67, v152
    v_mfma_f32_32x32x16_bf16 v[192:207], a[168:171], v[40:43], v[192:207]
    buffer_load_dwordx4 v2, s[16:19], s38 offen offset:2048 sc0 sc1 nt lds
    v_cvt_pk_bf16_f32 v133, v138, v139
    v_cvt_pk_bf16_f32 v97, v98, v99
    v_mfma_f32_32x32x16_bf16 v[192:207], a[172:175], v[44:47], v[192:207]
    ds_read_b128 a[64:67], v11 offset:2048
    ds_read_b128 v[56:59], v8 offset:6144
    v_cvt_pk_bf16_f32 v246, v252, v253
    v_cvt_pk_bf16_f32 v244, v248, v249
    v_mfma_f32_32x32x16_bf16 v[192:207], a[176:179], v[48:51], v[192:207]
    ds_write_b128 v21, v[132:135] offset:64
    v_cvt_pk_bf16_f32 v247, v254, v255
    v_mfma_f32_32x32x16_bf16 v[176:191], a[148:151], v[44:47], v[176:191]
    v_cvt_pk_bf16_f32 v83, v86, v87
    v_cvt_pk_bf16_f32 v86, v92, v93
    v_cvt_pk_bf16_f32 v98, v100, v101
    v_cvt_pk_bf16_f32 v101, v106, v107
    v_cvt_pk_bf16_f32 v87, v94, v95
    v_cvt_pk_bf16_f32 v100, v104, v105
    v_mfma_f32_32x32x16_bf16 v[176:191], a[152:155], v[48:51], v[176:191]
    ds_write_b128 v21, v[244:247] offset:128
    v_mfma_f32_32x32x16_bf16 v[192:207], a[180:183], v[52:55], v[192:207]
    buffer_load_dwordx4 v0, s[16:19], s38 offen offset:0 sc0 sc1 nt lds
    v_cvt_pk_bf16_f32 v99, v102, v103
    v_cvt_pk_bf16_f32 v103, v110, v111
    v_mfma_f32_32x32x16_bf16 v[176:191], a[156:159], v[52:55], v[176:191]
    ds_read_b128 v[120:123], v18 offset:3072
    ds_read_b128 v[136:139], v18 offset:4096
    v_cvt_pk_bf16_f32 v161, v162, v163
    v_max_f32 v144, s64, v144
    v_rsq_f32 v156, v144
    v_mfma_f32_4x4x4_16b_bf16 v[144:147], a[0:1], v[80:81], 0
    v_cvt_pk_bf16_f32 v85, v90, v91
    v_mfma_f32_4x4x4_16b_bf16 v[240:243], v[32:33], v[32:33], 0
    v_mfma_f32_4x4x4_16b_bf16 v[148:151], a[24:25], v[96:97], 0
    ds_read_b128 v[248:251], v18 offset:5120
    v_mfma_f32_4x4x4_16b_bf16 v[240:243], v[34:35], v[34:35], v[240:243]
    v_mfma_f32_4x4x4_16b_bf16 v[148:151], a[26:27], v[98:99], v[148:151]
    v_cvt_pk_bf16_f32 v102, v108, v109
    v_mfma_f32_4x4x4_16b_bf16 v[240:243], v[36:37], v[36:37], v[240:243]
    v_mfma_f32_4x4x4_16b_bf16 v[144:147], a[2:3], v[82:83], v[144:147]
    ds_read_b128 v[64:67], v8 offset:6208
    v_mfma_f32_4x4x4_16b_bf16 v[148:151], a[28:29], v[100:101], v[148:151]
    s_waitcnt lgkmcnt(6)
    v_mfma_f32_4x4x4_16b_bf16 v[240:243], v[38:39], v[38:39], v[240:243]
    ds_read_b128 a[60:63], v11 offset:1024
    v_mfma_f32_4x4x4_16b_bf16 v[148:151], a[30:31], v[102:103], v[148:151]
    v_cvt_pk_bf16_f32 v210, v212, v213
    v_mfma_f32_4x4x4_16b_bf16 v[144:147], a[4:5], v[84:85], v[144:147]
    v_cvt_pk_bf16_f32 v213, v218, v219
    v_mfma_f32_4x4x4_16b_bf16 v[244:247], v[56:57], v[56:57], 0
    s_add_u32 m0, s35, 3072
    v_mfma_f32_4x4x4_16b_bf16 v[144:147], a[6:7], v[86:87], v[144:147]
    ds_read_b128 v[72:75], v8 offset:6272
    v_cvt_pk_bf16_f32 v218, v180, v181
    v_mfma_f32_32x32x16_bf16 v[96:111], a[64:67], a[24:27], 0
    s_waitcnt lgkmcnt(5)
    buffer_store_dwordx4 v[120:123], v3, s[20:23], s44 offen offset:0 sc1
    v_mfma_f32_32x32x16_bf16 v[80:95], a[64:67], a[0:3], 0
    ds_read_b128 a[64:67], v11 offset:6144
    v_cvt_pk_bf16_f32 v224, v224, v225
    v_cvt_pk_bf16_f32 v225, v226, v227
    v_cvt_pk_bf16_f32 v227, v230, v231
    v_mfma_f32_32x32x16_bf16 v[112:127], a[96:99], a[0:3], 0
    v_cvt_pk_bf16_f32 v226, v228, v229
    v_cvt_pk_bf16_f32 v229, v234, v235
    v_cvt_pk_bf16_f32 v163, v166, v167
    v_cvt_pk_bf16_f32 v166, v172, v173
    v_cvt_pk_bf16_f32 v167, v174, v175
    v_mfma_f32_32x32x16_bf16 v[112:127], a[100:103], a[4:7], v[112:127]
    ds_write_b128 v10, v[224:227] offset:3200
    v_mfma_f32_32x32x16_bf16 v[112:127], a[104:107], a[8:11], v[112:127]
    v_cvt_pk_bf16_f32 v162, v164, v165
    v_cvt_pk_bf16_f32 v165, v170, v171
    s_waitcnt lgkmcnt(6)
    ds_read_b128 v[68:71], v9 offset:6208
    v_cvt_pk_bf16_f32 v164, v168, v169
    v_mfma_f32_32x32x16_bf16 v[112:127], a[108:111], a[12:15], v[112:127]
    buffer_store_dwordx4 v[136:139], v4, s[20:23], s44 offen offset:1024 sc1
    v_mfma_f32_32x32x16_bf16 v[112:127], a[56:59], a[16:19], v[112:127]
    ds_read_b128 v[24:27], v18 offset:0
    v_cvt_pk_bf16_f32 v219, v182, v183
    s_waitcnt lgkmcnt(5)
    ds_read_b128 a[68:71], v11 offset:3072
    v_mfma_f32_32x32x16_bf16 v[112:127], a[60:63], a[20:23], v[112:127]
    v_cvt_pk_bf16_f32 v212, v216, v217
    v_cvt_pk_bf16_f32 v211, v214, v215
    v_cvt_pk_bf16_f32 v216, v176, v177
    v_cvt_pk_bf16_f32 v217, v178, v179
    v_cvt_pk_bf16_f32 v214, v220, v221
    v_cvt_pk_bf16_f32 v220, v184, v185
    v_mfma_f32_32x32x16_bf16 v[128:143], a[96:99], a[24:27], 0
    ds_read_b128 v[60:63], v9 offset:6144
    v_mfma_f32_32x32x16_bf16 v[128:143], a[100:103], a[28:31], v[128:143]
    ds_write_b128 v21, v[164:167] offset:3072
    v_mfma_f32_32x32x16_bf16 v[128:143], a[104:107], a[32:35], v[128:143]
    buffer_store_dwordx4 v[248:251], v5, s[20:23], s44 offen offset:2048 sc1
    v_mfma_f32_32x32x16_bf16 v[128:143], a[108:111], a[36:39], v[128:143]
    v_cvt_pk_bf16_f32 v227, v198, v199
    v_cvt_pk_bf16_f32 v112, v112, v113
    v_cvt_pk_bf16_f32 v113, v114, v115
    v_cvt_pk_bf16_f32 v115, v118, v119
    v_cvt_pk_bf16_f32 v119, v126, v127
    v_mfma_f32_32x32x16_bf16 v[128:143], a[56:59], a[40:43], v[128:143]
    ds_read_b128 a[56:59], v11 offset:4096
    v_cvt_pk_bf16_f32 v215, v222, v223
    v_cvt_pk_bf16_f32 v114, v116, v117
    v_cvt_pk_bf16_f32 v116, v120, v121
    v_cvt_pk_bf16_f32 v222, v188, v189
    v_add_u32 v8, s66, v8
    v_mfma_f32_32x32x16_bf16 v[128:143], a[60:63], a[44:47], v[128:143]
    s_waitcnt lgkmcnt(3)
    ds_read_b128 a[60:63], v11 offset:5120
    v_mfma_f32_32x32x16_bf16 v[80:95], a[68:71], a[4:7], v[80:95]
    ds_write_b128 v10, v[160:163] offset:3072
    v_mfma_f32_32x32x16_bf16 v[160:175], a[112:115], v[32:35], 0
    buffer_load_dwordx4 v5, s[16:19], s38 offen offset:2048 sc0 sc1 nt lds
    v_cvt_pk_bf16_f32 v230, v236, v237
    v_mfma_f32_32x32x16_bf16 v[96:111], a[68:71], a[28:31], v[96:111]
    ds_read_b128 a[68:71], v11 offset:7168
    ds_read_b128 v[28:31], v18 offset:1024
    v_cvt_pk_bf16_f32 v228, v232, v233
    s_waitcnt lgkmcnt(4)
    v_mfma_f32_32x32x16_bf16 v[80:95], a[56:59], a[8:11], v[80:95]
    s_waitcnt lgkmcnt(3)
    v_mfma_f32_32x32x16_bf16 v[80:95], a[60:63], a[12:15], v[80:95]
    v_cvt_pk_bf16_f32 v118, v124, v125
    v_cvt_pk_bf16_f32 v231, v238, v239
    v_cvt_pk_bf16_f32 v128, v128, v129
    v_cvt_pk_bf16_f32 v129, v130, v131
    v_cvt_pk_bf16_f32 v130, v132, v133
    v_cvt_pk_bf16_f32 v133, v138, v139
    v_mfma_f32_32x32x16_bf16 v[80:95], a[64:67], a[16:19], v[80:95]
    ds_write_b128 v10, v[208:211] offset:3136
    v_mfma_f32_32x32x16_bf16 v[160:175], a[116:119], v[36:39], v[160:175]
    buffer_load_dwordx4 v3, s[16:19], s38 offen offset:0 sc0 sc1 nt lds
    s_waitcnt lgkmcnt(2)
    v_mfma_f32_32x32x16_bf16 v[80:95], a[68:71], a[20:23], v[80:95]
    ds_write_b128 v21, v[212:215] offset:3136
    v_mfma_f32_32x32x16_bf16 v[96:111], a[56:59], a[32:35], v[96:111]
    ds_read_b128 a[56:59], v11 offset:8192
    v_mfma_f32_32x32x16_bf16 v[96:111], a[60:63], a[36:39], v[96:111]
    ds_read_b128 a[60:63], v11 offset:9216
    v_cvt_pk_bf16_f32 v80, v80, v81
    v_cvt_pk_bf16_f32 v81, v82, v83
    v_cvt_pk_bf16_f32 v82, v84, v85
    v_cvt_pk_bf16_f32 v85, v90, v91
    v_mfma_f32_16x16x32_bf16 v[248:251], a[48:51], v[32:35], 0
    v_mfma_f32_32x32x16_bf16 v[96:111], a[64:67], a[40:43], v[96:111]
    buffer_load_dwordx4 v4, s[16:19], s38 offen offset:1024 sc0 sc1 nt lds
    s_add_u32 m0, s35, 6144
    v_mfma_f32_32x32x16_bf16 v[96:111], a[68:71], a[44:47], v[96:111]
    ds_read_b128 a[68:71], v11 offset:11264
    v_cvt_pk_bf16_f32 v83, v86, v87
    v_cvt_pk_bf16_f32 v87, v94, v95
    v_cvt_pk_bf16_f32 v86, v92, v93
    v_cvt_pk_bf16_f32 v117, v122, v123
    v_cvt_pk_bf16_f32 v224, v192, v193
    v_mfma_f32_32x32x16_bf16 v[160:175], a[120:123], v[40:43], v[160:175]
    ds_write_b128 v21, v[228:231] offset:3200
    v_cvt_pk_bf16_f32 v228, v200, v201
    v_mfma_f32_32x32x16_bf16 v[160:175], a[124:127], v[44:47], v[160:175]
    v_cvt_pk_bf16_f32 v231, v206, v207
    v_cvt_pk_bf16_f32 v96, v96, v97
    v_cvt_pk_bf16_f32 v97, v98, v99
    v_cvt_pk_bf16_f32 v98, v100, v101
    v_cvt_pk_bf16_f32 v101, v106, v107
    v_cvt_pk_bf16_f32 v84, v88, v89
    v_mfma_f32_32x32x16_bf16 v[160:175], a[128:131], v[48:51], v[160:175]
    s_waitcnt lgkmcnt(6)
    v_cvt_pk_bf16_f32 v131, v134, v135
    v_cvt_pk_bf16_f32 v134, v140, v141
    v_cvt_pk_bf16_f32 v225, v194, v195
    v_cvt_pk_bf16_f32 v135, v142, v143
    v_cvt_pk_bf16_f32 v99, v102, v103
    v_cvt_pk_bf16_f32 v100, v104, v105
    v_mfma_f32_32x32x16_bf16 v[160:175], a[132:135], v[52:55], v[160:175]
    buffer_store_dwordx4 v[28:31], v1, s[20:23], s44 offen offset:1024 sc1
    ds_read_b128 v[76:79], v9 offset:6272
    v_mfma_f32_4x4x4_16b_bf16 v[240:243], v[40:41], v[40:41], v[240:243]
    v_cvt_pk_bf16_f32 v132, v136, v137
    v_mfma_f32_4x4x4_16b_bf16 v[144:147], a[8:9], v[112:113], v[144:147]
    v_mfma_f32_4x4x4_16b_bf16 v[148:151], a[32:33], v[128:129], v[148:151]
    v_cvt_pk_bf16_f32 v230, v204, v205
    v_mfma_f32_4x4x4_16b_bf16 v[240:243], v[42:43], v[42:43], v[240:243]
    v_mfma_f32_4x4x4_16b_bf16 v[244:247], v[58:59], v[58:59], v[244:247]
    v_mfma_f32_4x4x4_16b_bf16 v[148:151], a[34:35], v[130:131], v[148:151]
    v_mfma_f32_4x4x4_16b_bf16 v[240:243], v[44:45], v[44:45], v[240:243]
    v_mfma_f32_4x4x4_16b_bf16 v[244:247], v[60:61], v[60:61], v[244:247]
    v_cvt_pk_bf16_f32 v208, v160, v161
    v_mfma_f32_4x4x4_16b_bf16 v[144:147], a[10:11], v[114:115], v[144:147]
    v_cvt_pk_bf16_f32 v215, v174, v175
    v_mfma_f32_4x4x4_16b_bf16 v[244:247], v[62:63], v[62:63], v[244:247]
    v_cvt_pk_bf16_f32 v221, v186, v187
    v_mfma_f32_4x4x4_16b_bf16 v[240:243], v[46:47], v[46:47], v[240:243]
    v_cvt_pk_bf16_f32 v211, v166, v167
    v_mfma_f32_4x4x4_16b_bf16 v[144:147], a[12:13], v[116:117], v[144:147]
    v_cvt_pk_bf16_f32 v213, v170, v171
    v_mfma_f32_4x4x4_16b_bf16 v[240:243], v[48:49], v[48:49], v[240:243]
    v_cvt_pk_bf16_f32 v214, v172, v173
    v_mfma_f32_4x4x4_16b_bf16 v[144:147], a[14:15], v[118:119], v[144:147]
    v_cvt_pk_bf16_f32 v210, v164, v165
    v_mfma_f32_4x4x4_16b_bf16 v[244:247], v[64:65], v[64:65], v[244:247]
    v_mfma_f32_4x4x4_16b_bf16 v[144:147], a[16:17], v[80:81], v[144:147]
    v_cvt_pk_bf16_f32 v229, v202, v203
    v_mfma_f32_4x4x4_16b_bf16 v[244:247], v[66:67], v[66:67], v[244:247]
    v_mfma_f32_4x4x4_16b_bf16 v[144:147], a[18:19], v[82:83], v[144:147]
    v_cvt_pk_bf16_f32 v226, v196, v197
    v_mfma_f32_4x4x4_16b_bf16 v[240:243], v[50:51], v[50:51], v[240:243]
    v_cvt_pk_bf16_f32 v212, v168, v169
    v_mfma_f32_4x4x4_16b_bf16 v[148:151], a[36:37], v[132:133], v[148:151]
    v_add_u32 v9, s66, v9
    v_mfma_f32_4x4x4_16b_bf16 v[240:243], v[52:53], v[52:53], v[240:243]
    v_mfma_f32_4x4x4_16b_bf16 v[148:151], a[38:39], v[134:135], v[148:151]
    ds_read_b128 a[64:67], v11 offset:10240
    v_mfma_f32_4x4x4_16b_bf16 v[244:247], v[68:69], v[68:69], v[244:247]
    ds_read_b128 v[28:31], v18 offset:3072
    v_mfma_f32_4x4x4_16b_bf16 v[240:243], v[54:55], v[54:55], v[240:243]
    v_mfma_f32_4x4x4_16b_bf16 v[244:247], v[70:71], v[70:71], v[244:247]
    v_mfma_f32_4x4x4_16b_bf16 v[144:147], a[20:21], v[84:85], v[144:147]
    v_mfma_f32_4x4x4_16b_bf16 v[244:247], v[72:73], v[72:73], v[244:247]
    v_cvt_pk_bf16_f32 v103, v110, v111
    v_mfma_f32_4x4x4_16b_bf16 v[148:151], a[40:41], v[96:97], v[148:151]
    v_cvt_pk_bf16_f32 v223, v190, v191
    v_mfma_f32_4x4x4_16b_bf16 v[244:247], v[74:75], v[74:75], v[244:247]
    s_waitcnt lgkmcnt(2)
    v_mfma_f32_4x4x4_16b_bf16 v[148:151], a[42:43], v[98:99], v[148:151]
    v_cndmask_b32_e64 v240, v240, v241, s[56:57]
    v_mfma_f32_4x4x4_16b_bf16 v[244:247], v[76:77], v[76:77], v[244:247]
    v_cndmask_b32_e64 v240, v240, v242, s[58:59]
    v_mfma_f32_4x4x4_16b_bf16 v[148:151], a[44:45], v[100:101], v[148:151]
    v_cvt_pk_bf16_f32 v102, v108, v109
    v_mfma_f32_4x4x4_16b_bf16 v[144:147], a[22:23], v[86:87], v[144:147]
    v_cvt_pk_bf16_f32 v209, v162, v163
    v_mfma_f32_4x4x4_16b_bf16 v[148:151], a[46:47], v[102:103], v[148:151]
    v_mfma_f32_4x4x4_16b_bf16 v[244:247], v[78:79], v[78:79], v[244:247]
    v_cndmask_b32_e64 v240, v240, v243, s[60:61]
    v_mfma_f32_32x32x16_bf16 v[112:127], a[0:3], a[56:59], 0
    buffer_load_dwordx4 v0, s[16:19], s39 offen offset:0 sc0 sc1 nt lds
    v_permlane32_swap_b32 v146, v150
    v_mfma_f32_16x16x32_bf16 v[248:251], a[48:51], v[36:39], v[248:251]
    v_permlane32_swap_b32 v144, v148
    v_mfma_f32_16x16x32_bf16 v[248:251], a[48:51], v[40:43], v[248:251]
    v_add_f32 v146, v146, v150
    v_add_f32 v144, v144, v148
    v_mfma_f32_16x16x32_bf16 v[248:251], a[48:51], v[44:47], v[248:251]
    s_nop 0
    v_mul_f32_dpp v144, v156, v144 quad_perm:[0,0,0,0] row_mask:0xf bank_mask:0xf
    v_mul_f32_dpp v146, v156, v146 quad_perm:[2,2,2,2] row_mask:0xf bank_mask:0xf
    v_mfma_f32_16x16x32_bf16 v[248:251], a[48:51], v[48:51], v[248:251]
    v_permlane32_swap_b32 v147, v151
    v_mfma_f32_32x32x16_bf16 v[112:127], a[4:7], a[60:63], v[112:127]
    v_permlane32_swap_b32 v145, v149
    v_add_f32 v145, v145, v149
    v_add_f32 v147, v147, v151
    v_cndmask_b32_e64 v244, v244, v245, s[56:57]
    v_cndmask_b32_e64 v244, v244, v246, s[58:59]
    v_mfma_f32_16x16x32_bf16 v[248:251], a[48:51], v[52:55], v[248:251]
    v_mul_f32_dpp v145, v156, v145 quad_perm:[1,1,1,1] row_mask:0xf bank_mask:0xf
    v_max3_f32 v154, v144, v145, v146
    v_mfma_f32_16x16x32_bf16 v[248:251], a[52:55], v[56:59], v[248:251]
    v_cndmask_b32_e64 v244, v244, v247, s[60:61]
    v_mfma_f32_32x32x16_bf16 v[160:175], v[32:35], v[208:211], 0
    buffer_load_dwordx4 v2, s[16:19], s39 offen offset:2048 sc0 sc1 nt lds
    v_permlane32_swap_b32 v240, v244
    v_mfma_f32_16x16x32_bf16 v[248:251], a[52:55], v[60:63], v[248:251]
    v_mul_f32_dpp v147, v156, v147 quad_perm:[3,3,3,3] row_mask:0xf bank_mask:0xf
    v_max_f32 v154, v154, v147
    v_mfma_f32_16x16x32_bf16 v[248:251], a[52:55], v[64:67], v[248:251]
    v_mul_f32 v155, v154, v156
    v_fma_f32 v145, v145, v156, -v155
    v_mfma_f32_16x16x32_bf16 v[248:251], a[52:55], v[68:71], v[248:251]
    v_exp_f32 v145, v145
    v_mfma_f32_32x32x16_bf16 v[176:191], v[56:59], v[208:211], 0
    s_waitcnt lgkmcnt(1)
    v_fma_f32 v144, v144, v156, -v155
    v_exp_f32 v144, v144
    v_fma_f32 v146, v146, v156, -v155
    v_exp_f32 v146, v146
    v_mfma_f32_32x32x16_bf16 v[112:127], a[8:11], a[64:67], v[112:127]
    v_fma_f32 v147, v147, v156, -v155
    v_exp_f32 v147, v147
    v_add_f32 v157, v144, v145
    v_add_f32 v154, v146, v147
    v_mul_f32_dpp v144, v156, v144 quad_perm:[0,0,0,0] row_mask:0xf bank_mask:0xf
    v_mfma_f32_16x16x32_bf16 v[248:251], a[52:55], v[72:75], v[248:251]
    v_add_f32 v157, v157, v154
    v_mul_f32_dpp v145, v156, v145 quad_perm:[1,1,1,1] row_mask:0xf bank_mask:0xf
    v_mfma_f32_16x16x32_bf16 v[248:251], a[52:55], v[76:79], v[248:251]
    v_rcp_f32 v157, v157
    v_mfma_f32_32x32x16_bf16 v[160:175], v[36:39], v[212:215], v[160:175]
    v_mul_f32_dpp v146, v156, v146 quad_perm:[2,2,2,2] row_mask:0xf bank_mask:0xf
    v_mul_f32 v146, v146, v157
    v_mul_f32_e64 v145, v145, v157
    v_mul_f32_e64 v144, v144, v157
    v_cvt_pk_bf16_f32 v152, v144, v145
    v_cvt_pk_bf16_f32 v158, v144, v145
    v_mfma_f32_32x32x16_bf16 v[160:175], v[40:43], v[216:219], v[160:175]
    buffer_store_dwordx4 v[24:27], v0, s[20:23], s44 offen offset:0 sc1
    v_mfma_f32_32x32x16_bf16 v[160:175], v[44:47], v[220:223], v[160:175]
    v_fma_f32 v248, -v248, v248, s64
    v_add_f32_e64 v240, v240, v244
    v_fma_f32 v240, v240, s67, v248
    v_max_f32_e64 v240, s64, v240
    v_rsq_f32_e64 v252, v240
    v_mfma_f32_32x32x16_bf16 v[160:175], v[48:51], v[224:227], v[160:175]
    ds_bpermute_b32 v16, v12, v252 offset:128
    ds_bpermute_b32 v15, v12, v252 offset:0
    v_mul_f32_dpp v147, v156, v147 quad_perm:[3,3,3,3] row_mask:0xf bank_mask:0xf
    v_mul_f32_e64 v147, v147, v157
    v_mfma_f32_32x32x16_bf16 v[160:175], v[52:55], v[228:231], v[160:175]
    v_cvt_pk_bf16_f32 v153, v146, v147
    v_cvt_pk_bf16_f32 v159, v146, v147
    v_permlane32_swap_b32 v152, v158
    v_cndmask_b32_e64 v150, 0, v152, s[54:55]
    v_mov_b32_e64 v14, v252
    v_mfma_f32_32x32x16_bf16 v[176:191], v[60:63], v[212:215], v[176:191]
    v_permlane32_swap_b32 v153, v159
    v_cndmask_b32_e64 v146, 0, v152, s[50:51]
    v_cndmask_b32_e64 v149, 0, v153, s[52:53]
    v_cndmask_b32_e64 v151, 0, v153, s[54:55]
    v_cndmask_b32_e64 v147, 0, v153, s[50:51]
    v_mfma_f32_32x32x16_bf16 v[176:191], v[64:67], v[216:219], v[176:191]
    buffer_load_dwordx4 v1, s[16:19], s39 offen offset:1024 sc0 sc1 nt lds
    s_add_u32 m0, s35, 9216
    s_add_u32 s35, s35, s66
    v_mfma_f32_32x32x16_bf16 v[176:191], v[68:71], v[220:223], v[176:191]
    s_waitcnt lgkmcnt(0)
    v_mul_f32_dpp v174, v15, v174 row_newbcast:14 row_mask:0xf bank_mask:0xf
    v_cndmask_b32_e64 v144, 0, v152, s[48:49]
    v_cndmask_b32_e64 v148, 0, v152, s[52:53]
    v_cndmask_b32_e64 v152, 0, v158, s[48:49]
    v_mul_f32_dpp v175, v15, v175 row_newbcast:15 row_mask:0xf bank_mask:0xf
    v_mul_f32_dpp v168, v15, v168 row_newbcast:8 row_mask:0xf bank_mask:0xf
    v_mfma_f32_32x32x16_bf16 v[176:191], v[72:75], v[224:227], v[176:191]
    v_cndmask_b32_e64 v154, 0, v158, s[50:51]
    v_mul_f32_dpp v171, v15, v171 row_newbcast:11 row_mask:0xf bank_mask:0xf
    v_mov_b32 v13, v252
    v_mul_f32_dpp v162, v15, v162 row_newbcast:2 row_mask:0xf bank_mask:0xf
    v_cndmask_b32_e64 v156, 0, v158, s[52:53]
    v_cndmask_b32_e64 v158, 0, v158, s[54:55]
    v_mfma_f32_32x32x16_bf16 v[176:191], v[76:79], v[228:231], v[176:191]
    v_cndmask_b32_e64 v145, 0, v153, s[48:49]
    v_mul_f32_dpp v173, v15, v173 row_newbcast:13 row_mask:0xf bank_mask:0xf
    v_cndmask_b32_e64 v153, 0, v159, s[48:49]
    v_cndmask_b32_e64 v157, 0, v159, s[52:53]
    v_mul_f32_dpp v170, v15, v170 row_newbcast:10 row_mask:0xf bank_mask:0xf
    v_mul_f32_dpp v164, v15, v164 row_newbcast:4 row_mask:0xf bank_mask:0xf
    v_mfma_f32_32x32x16_bf16 v[192:207], a[112:115], v[56:59], 0
    v_cndmask_b32_e64 v155, 0, v159, s[50:51]
    v_cndmask_b32_e64 v159, 0, v159, s[54:55]
    v_mul_f32_dpp v169, v15, v169 row_newbcast:9 row_mask:0xf bank_mask:0xf
    v_mul_f32_dpp v165, v15, v165 row_newbcast:5 row_mask:0xf bank_mask:0xf
    v_mul_f32_dpp v160, v15, v160 row_newbcast:0 row_mask:0xf bank_mask:0xf
    v_mul_f32_dpp v177, v16, v177 row_newbcast:1 row_mask:0xf bank_mask:0xf
    v_mfma_f32_32x32x16_bf16 v[192:207], a[116:119], v[60:63], v[192:207]
    ds_read_b128 v[24:27], v18 offset:2048
    v_mul_f32_dpp v190, v16, v190 row_newbcast:14 row_mask:0xf bank_mask:0xf
    v_mul_f32_dpp v189, v16, v189 row_newbcast:13 row_mask:0xf bank_mask:0xf
    v_permlane32_swap_b32 v13, v14
    v_mul_f32_dpp v181, v16, v181 row_newbcast:5 row_mask:0xf bank_mask:0xf
    v_mfma_f32_32x32x16_bf16 v[192:207], a[120:123], v[64:67], v[192:207]
    v_mul_f32_dpp v172, v15, v172 row_newbcast:12 row_mask:0xf bank_mask:0xf
    v_mul_f32_dpp v185, v16, v185 row_newbcast:9 row_mask:0xf bank_mask:0xf
    v_mul_f32_dpp v161, v15, v161 row_newbcast:1 row_mask:0xf bank_mask:0xf
    v_max3_f32 v17, v160, v161, v162
    v_mul_f32_dpp v163, v15, v163 row_newbcast:3 row_mask:0xf bank_mask:0xf
    v_max3_f32 v17, v17, v163, v164
    v_mfma_f32_32x32x16_bf16 v[192:207], a[124:127], v[68:71], v[192:207]
    v_mul_f32_dpp v184, v16, v184 row_newbcast:8 row_mask:0xf bank_mask:0xf
    v_mul_f32_dpp v187, v16, v187 row_newbcast:11 row_mask:0xf bank_mask:0xf
    v_mul_f32_dpp v166, v15, v166 row_newbcast:6 row_mask:0xf bank_mask:0xf
    v_mul_f32_dpp v176, v16, v176 row_newbcast:0 row_mask:0xf bank_mask:0xf
    v_mul_f32_dpp v191, v16, v191 row_newbcast:15 row_mask:0xf bank_mask:0xf
    v_mul_f32_dpp v182, v16, v182 row_newbcast:6 row_mask:0xf bank_mask:0xf
    v_mfma_f32_32x32x16_bf16 v[192:207], a[128:131], v[72:75], v[192:207]
    v_mul_f32_dpp v180, v16, v180 row_newbcast:4 row_mask:0xf bank_mask:0xf
    v_mul_f32_dpp v167, v15, v167 row_newbcast:7 row_mask:0xf bank_mask:0xf
    v_max3_f32 v17, v17, v165, v166
    v_max3_f32 v17, v17, v167, v168
    v_max3_f32 v17, v17, v169, v170
    v_mul_f32_dpp v186, v16, v186 row_newbcast:10 row_mask:0xf bank_mask:0xf
    v_mfma_f32_32x32x16_bf16 v[128:143], a[24:27], a[56:59], 0
    ds_read_b128 a[56:59], v11 offset:12288
    v_max3_f32 v17, v17, v171, v172
    v_max3_f32 v17, v17, v173, v174
    v_mul_f32_dpp v178, v16, v178 row_newbcast:2 row_mask:0xf bank_mask:0xf
    v_max3_f32 v17, v17, v175, v176
    v_max3_f32 v17, v17, v177, v178
    v_mfma_f32_32x32x16_bf16 v[128:143], a[28:31], a[60:63], v[128:143]
    ds_read_b128 a[60:63], v11 offset:13312
    v_mul_f32_dpp v179, v16, v179 row_newbcast:3 row_mask:0xf bank_mask:0xf
    v_max3_f32 v17, v17, v179, v180
    v_max3_f32 v17, v17, v181, v182
    v_mul_f32_dpp v183, v16, v183 row_newbcast:7 row_mask:0xf bank_mask:0xf
    v_max3_f32 v17, v17, v183, v184
    v_mfma_f32_32x32x16_bf16 v[192:207], a[132:135], v[76:79], v[192:207]
    v_mul_f32_dpp v188, v16, v188 row_newbcast:12 row_mask:0xf bank_mask:0xf
    v_max3_f32 v17, v17, v185, v186
    v_max3_f32 v17, v17, v187, v188
    v_max3_f32 v17, v17, v189, v190
    v_max_f32 v20, v17, v191
    v_max_f32_e64 v17, v17, v191
    v_mfma_f32_32x32x16_bf16 v[128:143], a[32:35], a[64:67], v[128:143]
    ds_read_b128 a[64:67], v11 offset:14336
    v_permlane32_swap_b32 v17, v20
    v_max_f32 v17, v17, v20
    v_mul_f32 v17, v17, v13
    v_fma_f32 v173, v173, v13, -v17
    v_mfma_f32_32x32x16_bf16 v[112:127], a[12:15], a[68:71], v[112:127]
    v_fma_f32 v179, v179, v13, -v17
    v_fma_f32 v167, v167, v13, -v17
    v_fma_f32 v161, v161, v13, -v17
    v_exp_f32 v161, v161
    v_fma_f32 v191, v191, v13, -v17
    v_mfma_f32_32x32x16_bf16 v[240:255], a[136:139], v[56:59], 0
    buffer_load_dwordx4 v4, s[16:19], s39 offen offset:1024 sc0 sc1 nt lds
    v_exp_f32 v179, v179
    v_fma_f32 v176, v176, v13, -v17
    v_mfma_f32_32x32x16_bf16 v[128:143], a[36:39], a[68:71], v[128:143]
    s_waitcnt lgkmcnt(2)
    ds_read_b128 a[68:71], v11 offset:15360
    v_cvt_pk_bf16_f32 v237, v202, v203
    v_fma_f32 v166, v166, v13, -v17
    v_exp_f32 v166, v166
    v_fma_f32 v168, v168, v13, -v17
    v_mfma_f32_32x32x16_bf16 v[112:127], a[16:19], a[56:59], v[112:127]
    s_waitcnt lgkmcnt(2)
    v_fma_f32 v182, v182, v13, -v17
    v_fma_f32 v163, v163, v13, -v17
    v_exp_f32 v163, v163
    v_fma_f32 v180, v180, v13, -v17
    v_fma_f32 v171, v171, v13, -v17
    v_mfma_f32_32x32x16_bf16 v[112:127], a[20:23], a[60:63], v[112:127]
    v_cvt_pk_bf16_f32 v238, v204, v205
    v_fma_f32 v178, v178, v13, -v17
    v_exp_f32 v191, v191
    v_exp_f32 v178, v178
    v_mfma_f32_32x32x16_bf16 v[128:143], a[40:43], a[56:59], v[128:143]
    ds_read_b128 a[56:59], v11 offset:16384
    v_fma_f32 v172, v172, v13, -v17
    v_exp_f32 v182, v182
    v_cvt_pk_bf16_f32 v236, v200, v201
    v_fma_f32 v175, v175, v13, -v17
    v_mfma_f32_32x32x16_bf16 v[240:255], a[140:143], v[60:63], v[240:255]
    buffer_load_dwordx4 v3, s[16:19], s39 offen offset:0 sc0 sc1 nt lds
    v_fma_f32 v162, v162, v13, -v17
    v_exp_f32 v162, v162
    v_mfma_f32_32x32x16_bf16 v[128:143], a[44:47], a[60:63], v[128:143]
    s_waitcnt lgkmcnt(2)
    ds_read_b128 a[60:63], v11 offset:17408
    v_exp_f32 v175, v175
    v_fma_f32 v186, v186, v13, -v17
    v_exp_f32 v186, v186
    v_mfma_f32_32x32x16_bf16 v[96:111], a[24:27], a[64:67], 0
    s_waitcnt lgkmcnt(2)
    v_cvt_pk_bf16_f32 v112, v112, v113
    v_cvt_pk_bf16_f32 v113, v114, v115
    v_cvt_pk_bf16_f32 v233, v194, v195
    v_exp_f32 v168, v168
    v_cvt_pk_bf16_f32 v114, v116, v117
    v_mfma_f32_32x32x16_bf16 v[96:111], a[28:31], a[68:71], v[96:111]
    v_fma_f32 v160, v160, v13, -v17
    v_cvt_pk_bf16_f32 v115, v118, v119
    v_cvt_pk_bf16_f32 v118, v124, v125
    v_cvt_pk_bf16_f32 v119, v126, v127
    v_exp_f32 v172, v172
    v_mfma_f32_32x32x16_bf16 v[80:95], a[0:3], a[64:67], 0
    ds_read_b128 a[64:67], v11 offset:18432
    v_fma_f32 v169, v169, v13, -v17
    v_cvt_pk_bf16_f32 v127, v142, v143
    v_cvt_pk_bf16_f32 v116, v120, v121
    v_exp_f32 v169, v169
    v_mfma_f32_32x32x16_bf16 v[80:95], a[4:7], a[68:71], v[80:95]
    s_waitcnt lgkmcnt(2)
    buffer_load_dwordx4 v5, s[16:19], s39 offen offset:2048 sc0 sc1 nt lds
    ds_read_b128 a[68:71], v11 offset:19456
    v_cvt_pk_bf16_f32 v232, v192, v193
    v_fma_f32 v188, v188, v13, -v17
    v_mfma_f32_32x32x16_bf16 v[80:95], a[8:11], a[56:59], v[80:95]
    v_cvt_pk_bf16_f32 v120, v128, v129
    v_exp_f32 v160, v160
    v_fma_f32 v164, v164, v13, -v17
    v_exp_f32 v164, v164
    v_mfma_f32_32x32x16_bf16 v[240:255], a[144:147], v[64:67], v[240:255]
    s_waitcnt lgkmcnt(2)
    v_fma_f32 v190, v190, v13, -v17
    v_exp_f32 v171, v171
    v_exp_f32 v190, v190
    v_add_f32 v19, v160, v161
    v_mfma_f32_32x32x16_bf16 v[80:95], a[12:15], a[60:63], v[80:95]
    v_fma_f32 v165, v165, v13, -v17
    v_exp_f32 v165, v165
    v_add_f32 v19, v19, v162
    v_add_f32 v19, v19, v163
    v_add_f32 v19, v19, v164
    v_mfma_f32_32x32x16_bf16 v[240:255], a[148:151], v[68:71], v[240:255]
    v_exp_f32 v167, v167
    v_add_f32 v19, v19, v165
    v_add_f32 v19, v19, v166
    v_mul_f32_dpp v163, v15, v163 row_newbcast:3 row_mask:0xf bank_mask:0xf
    v_fma_f32 v185, v185, v13, -v17
    v_mfma_f32_32x32x16_bf16 v[96:111], a[32:35], a[56:59], v[96:111]
    v_fma_f32 v184, v184, v13, -v17
    v_exp_f32 v184, v184
    v_cvt_pk_bf16_f32 v117, v122, v123
    v_cvt_pk_bf16_f32 v125, v138, v139
    v_cvt_pk_bf16_f32 v122, v132, v133
    v_mfma_f32_32x32x16_bf16 v[96:111], a[36:39], a[60:63], v[96:111]
    s_waitcnt lgkmcnt(1)
    ds_read_b128 a[60:63], v11 offset:21504
    buffer_store_dwordx4 v[24:27], v2, s[20:23], s44 offen offset:2048 sc1
    v_mfma_f32_32x32x16_bf16 v[96:111], a[40:43], a[64:67], v[96:111]
    s_nop 0
    ds_read_b128 v[24:27], v18 offset:4096
    v_add_f32 v19, v19, v167
    v_add_f32 v19, v19, v168
    v_add_f32 v19, v19, v169
    v_fma_f32 v187, v187, v13, -v17
    v_mul_f32_dpp v160, v15, v160 row_newbcast:0 row_mask:0xf bank_mask:0xf
    v_mfma_f32_32x32x16_bf16 v[80:95], a[16:19], a[64:67], v[80:95]
    s_waitcnt lgkmcnt(2)
    ds_read_b128 a[64:67], v11 offset:22528
    v_fma_f32 v170, v170, v13, -v17
    v_exp_f32 v170, v170
    v_exp_f32 v180, v180
    v_mfma_f32_32x32x16_bf16 v[80:95], a[20:23], a[68:71], v[80:95]
    v_exp_f32 v173, v173
    v_fma_f32 v174, v174, v13, -v17
    v_cvt_pk_bf16_f32 v239, v206, v207
    v_exp_f32 v174, v174
    v_mfma_f32_32x32x16_bf16 v[240:255], a[152:155], v[72:75], v[240:255]
    v_add_f32 v19, v19, v170
    v_add_f32 v19, v19, v171
    v_add_f32 v19, v19, v172
    v_add_f32 v19, v19, v173
    v_add_f32 v19, v19, v174
    v_add_f32 v19, v19, v175
    v_mfma_f32_32x32x16_bf16 v[96:111], a[44:47], a[68:71], v[96:111]
    ds_read_b128 a[68:71], v11 offset:23552
    v_cvt_pk_bf16_f32 v80, v80, v81
    v_cvt_pk_bf16_f32 v81, v82, v83
    v_cvt_pk_bf16_f32 v126, v140, v141
    v_cvt_pk_bf16_f32 v234, v196, v197
    v_cvt_pk_bf16_f32 v235, v198, v199
    v_mfma_f32_32x32x16_bf16 v[192:207], a[160:163], v[56:59], 0
    buffer_store_dwordx4 v[28:31], v0, s[20:23], s45 offen offset:0 sc1
    v_fma_f32 v177, v177, v13, -v17
    v_mfma_f32_32x32x16_bf16 v[192:207], a[164:167], v[60:63], v[192:207]
    v_fma_f32 v181, v181, v13, -v17
    v_exp_f32 v181, v181
    v_mul_f32_dpp v170, v15, v170 row_newbcast:10 row_mask:0xf bank_mask:0xf
    v_exp_f32 v176, v176
    v_mfma_f32_32x32x16_bf16 v[192:207], a[168:171], v[64:67], v[192:207]
    v_cvt_pk_bf16_f32 v82, v84, v85
    v_mul_f32_dpp v172, v15, v172 row_newbcast:12 row_mask:0xf bank_mask:0xf
    v_cvt_pk_bf16_f32 v85, v90, v91
    v_exp_f32 v188, v188
    v_cvt_pk_bf16_f32 v84, v88, v89
    v_mfma_f32_32x32x16_bf16 v[192:207], a[172:175], v[68:71], v[192:207]
    v_fma_f32 v183, v183, v13, -v17
    v_exp_f32 v183, v183
    v_exp_f32 v187, v187
    v_fma_f32 v189, v189, v13, -v17
    v_mfma_f32_32x32x16_bf16 v[192:207], a[176:179], v[72:75], v[192:207]
    v_mul_f32_dpp v161, v15, v161 row_newbcast:1 row_mask:0xf bank_mask:0xf
    v_add_f32 v19, v19, v176
    v_exp_f32 v189, v189
    v_exp_f32 v177, v177
    v_mfma_f32_32x32x16_bf16 v[192:207], a[180:183], v[76:79], v[192:207]
    ds_read_b128 a[56:59], v11 offset:20480
    v_add_f32 v19, v19, v177
    v_add_f32 v19, v19, v178
    v_add_f32 v19, v19, v179
    v_add_f32 v19, v19, v180
    v_cvt_pk_bf16_f32 v83, v86, v87
    v_mfma_f32_32x32x16_bf16 v[240:255], a[156:159], v[76:79], v[240:255]
    v_cvt_pk_bf16_f32 v86, v92, v93
    v_cvt_pk_bf16_f32 v93, v106, v107
    v_cvt_pk_bf16_f32 v87, v94, v95
    v_cvt_pk_bf16_f32 v94, v108, v109
    v_cvt_pk_bf16_f32 v89, v98, v99
    v_cvt_pk_bf16_f32 v91, v102, v103
    v_cvt_pk_bf16_f32 v88, v96, v97
    v_mfma_f32_4x4x4_16b_bf16 v[96:99], v[22:23], a[24:25], 0
    v_cvt_pk_bf16_f32 v123, v134, v135
    v_mfma_f32_4x4x4_16b_bf16 v[132:135], v[22:23], a[2:3], 0
    v_cvt_pk_bf16_f32 v92, v104, v105
    v_mfma_f32_4x4x4_16b_bf16 v[104:107], v[22:23], a[28:29], 0
    v_cvt_pk_bf16_f32 v95, v110, v111
    v_mfma_f32_4x4x4_16b_bf16 v[108:111], v[22:23], a[30:31], 0
    v_cvt_pk_bf16_f32 v124, v136, v137
    v_mfma_f32_4x4x4_16b_bf16 v[136:139], v[22:23], a[4:5], 0
    v_mul_f32_dpp v167, v15, v167 row_newbcast:7 row_mask:0xf bank_mask:0xf
    v_mfma_f32_4x4x4_16b_bf16 v[140:143], v[22:23], a[6:7], 0
    v_cvt_pk_bf16_f32 v90, v100, v101
    v_mfma_f32_4x4x4_16b_bf16 v[100:103], v[22:23], a[26:27], 0
    v_cvt_pk_bf16_f32 v121, v130, v131
    v_mfma_f32_4x4x4_16b_bf16 v[128:131], v[22:23], a[0:1], 0
    v_cvt_pk_bf16_f32 v221, v202, v203
    v_cvt_pk_bf16_f32 v216, v192, v193
    v_mfma_f32_32x32x16_bf16 v[96:111], v[120:123], v[152:155], v[96:111]
    s_waitcnt lgkmcnt(3)
    ds_read_b128 v[28:31], v18 offset:5120
    buffer_store_dwordx4 v[24:27], v1, s[20:23], s45 offen offset:1024 sc1
    v_mfma_f32_32x32x16_bf16 v[96:111], v[124:127], v[156:159], v[96:111]
    v_add_f32 v19, v19, v181
    v_add_f32 v19, v19, v182
    v_exp_f32 v185, v185
    v_cvt_pk_bf16_f32 v213, v250, v251
    v_cvt_pk_bf16_f32 v208, v240, v241
    v_mfma_f32_32x32x16_bf16 v[128:143], v[112:115], v[144:147], v[128:143]
    v_cvt_pk_bf16_f32 v218, v196, v197
    v_add_f32 v19, v19, v183
    v_mul_f32_dpp v183, v16, v183 row_newbcast:7 row_mask:0xf bank_mask:0xf
    v_cvt_pk_bf16_f32 v210, v244, v245
    v_add_f32 v19, v19, v184
    v_add_f32_e64 v19, v19, v185
    v_mfma_f32_32x32x16_bf16 v[128:143], v[116:119], v[148:151], v[128:143]
    v_cvt_pk_bf16_f32 v217, v194, v195
    v_cvt_pk_bf16_f32 v215, v254, v255
    v_cvt_pk_bf16_f32 v214, v252, v253
    v_cvt_pk_bf16_f32 v211, v246, v247
    v_cvt_pk_bf16_f32 v209, v242, v243
    v_cvt_pk_bf16_f32 v212, v248, v249
    v_mfma_f32_32x32x16_bf16 v[240:255], v[56:59], v[232:235], 0
    ds_read_b128 v[24:27], v18 offset:6144
    v_cvt_pk_bf16_f32 v96, v96, v97
    v_cvt_pk_bf16_f32 v97, v98, v99
    v_cvt_pk_bf16_f32 v99, v102, v103
    v_mul_f32_dpp v174, v15, v174 row_newbcast:14 row_mask:0xf bank_mask:0xf
    v_cvt_pk_bf16_f32 v220, v200, v201
    v_mfma_f32_32x32x16_bf16 v[240:255], v[60:63], v[236:239], v[240:255]
    v_add_f32 v19, v19, v186
    v_mul_f32_dpp v186, v16, v186 row_newbcast:10 row_mask:0xf bank_mask:0xf
    v_cvt_pk_bf16_f32 v219, v198, v199
    v_cvt_pk_bf16_f32 v128, v128, v129
    v_cvt_pk_bf16_f32 v129, v130, v131
    v_cvt_pk_bf16_f32 v131, v134, v135
    v_mfma_f32_32x32x16_bf16 v[240:255], v[64:67], v[208:211], v[240:255]
    v_mul_f32_dpp v173, v15, v173 row_newbcast:13 row_mask:0xf bank_mask:0xf
    v_add_f32 v19, v19, v187
    v_add_f32 v19, v19, v188
    v_add_f32 v19, v19, v189
    v_cvt_pk_bf16_f32 v98, v100, v101
    v_cvt_pk_bf16_f32 v103, v110, v111
    v_mfma_f32_32x32x16_bf16 v[240:255], v[68:71], v[212:215], v[240:255]
    v_mul_f32_dpp v179, v16, v179 row_newbcast:3 row_mask:0xf bank_mask:0xf
    v_cvt_pk_bf16_f32 v222, v204, v205
    v_cvt_pk_bf16_f32 v130, v132, v133
    v_mul_f32_dpp v181, v16, v181 row_newbcast:5 row_mask:0xf bank_mask:0xf
    v_cvt_pk_bf16_f32 v133, v138, v139
    v_cvt_pk_bf16_f32 v223, v206, v207
    v_mfma_f32_32x32x16_bf16 v[240:255], v[72:75], v[216:219], v[240:255]
    ds_write_b128 v6, v[96:99] offset:6144
    v_add_f32_e64 v19, v19, v190
    v_mfma_f32_32x32x16_bf16 v[240:255], v[76:79], v[220:223], v[240:255]
    v_mul_f32_dpp v165, v15, v165 row_newbcast:5 row_mask:0xf bank_mask:0xf
    v_cvt_pk_bf16_f32 v102, v108, v109
    v_cvt_pk_bf16_f32 v100, v104, v105
    v_mul_f32_dpp v189, v16, v189 row_newbcast:13 row_mask:0xf bank_mask:0xf
    v_cvt_pk_bf16_f32 v135, v142, v143
    v_mul_f32_dpp v162, v15, v162 row_newbcast:2 row_mask:0xf bank_mask:0xf
    v_mfma_f32_32x32x16_bf16 v[192:207], v[32:35], v[232:235], 0
    s_waitcnt lgkmcnt(2)
    v_add_f32 v19, v19, v191
    v_mul_f32_dpp v175, v15, v175 row_newbcast:15 row_mask:0xf bank_mask:0xf
    v_mul_f32_dpp v164, v15, v164 row_newbcast:4 row_mask:0xf bank_mask:0xf
    v_mov_b32 v20, v19
    v_mul_f32_dpp v176, v16, v176 row_newbcast:0 row_mask:0xf bank_mask:0xf
    v_mul_f32_dpp v191, v16, v191 row_newbcast:15 row_mask:0xf bank_mask:0xf
    v_mfma_f32_32x32x16_bf16 v[192:207], v[36:39], v[236:239], v[192:207]
    buffer_store_dwordx4 v[28:31], v2, s[20:23], s45 offen offset:2048 sc1
    v_mul_f32_dpp v180, v16, v180 row_newbcast:4 row_mask:0xf bank_mask:0xf
    v_mfma_f32_32x32x16_bf16 v[192:207], v[40:43], v[208:211], v[192:207]
    v_permlane32_swap_b32 v19, v20
    v_add_f32 v19, v19, v20
    v_rcp_f32 v19, v19
    v_mul_f32_dpp v166, v15, v166 row_newbcast:6 row_mask:0xf bank_mask:0xf
    v_mfma_f32_32x32x16_bf16 v[192:207], v[44:47], v[212:215], v[192:207]
    v_cvt_pk_bf16_f32 v101, v106, v107
    v_mul_f32_dpp v250, v16, v250 row_newbcast:10 row_mask:0xf bank_mask:0xf
    v_mul_f32_dpp v248, v16, v248 row_newbcast:8 row_mask:0xf bank_mask:0xf
    v_mul_f32_dpp v188, v16, v188 row_newbcast:12 row_mask:0xf bank_mask:0xf
    v_mul_f32 v188, v188, v19
    v_mul_f32_dpp v251, v16, v251 row_newbcast:11 row_mask:0xf bank_mask:0xf
    v_mfma_f32_32x32x16_bf16 v[192:207], v[48:51], v[216:219], v[192:207]
    s_waitcnt lgkmcnt(1)
    ds_write_b128 v7, v[100:103] offset:6144
    v_mul_f32_dpp v177, v16, v177 row_newbcast:1 row_mask:0xf bank_mask:0xf
    v_mul_f32 v177, v177, v19
    v_mfma_f32_4x4x4_16b_bf16 v[104:107], v[22:23], a[12:13], 0
    v_mul_f32_dpp v178, v16, v178 row_newbcast:2 row_mask:0xf bank_mask:0xf
    v_mfma_f32_4x4x4_16b_bf16 v[108:111], v[22:23], a[14:15], 0
    v_mul_f32 v165, v165, v19
    v_mfma_f32_4x4x4_16b_bf16 v[100:103], v[22:23], a[10:11], 0
    v_mul_f32 v162, v162, v19
    v_mfma_f32_4x4x4_16b_bf16 v[96:99], v[22:23], a[8:9], 0
    v_mul_f32 v176, v176, v19
    v_mul_f32 v173, v173, v19
    v_mfma_f32_32x32x16_bf16 v[192:207], v[52:55], v[220:223], v[192:207]
    buffer_store_dwordx4 v[24:27], v3, s[20:23], s45 offen offset:0 sc1
    v_mul_f32_dpp v244, v16, v244 row_newbcast:4 row_mask:0xf bank_mask:0xf
    v_mfma_f32_32x32x16_bf16 v[208:223], v[32:35], a[184:187], 0
    v_mul_f32 v179, v179, v19
    v_mul_f32_dpp v243, v16, v243 row_newbcast:3 row_mask:0xf bank_mask:0xf
    v_mul_f32_dpp v190, v16, v190 row_newbcast:14 row_mask:0xf bank_mask:0xf
    v_mul_f32 v190, v190, v19
    v_mul_f32_dpp v171, v15, v171 row_newbcast:11 row_mask:0xf bank_mask:0xf
    v_mul_f32 v171, v171, v19
    v_mfma_f32_32x32x16_bf16 v[208:223], v[36:39], a[188:191], v[208:223]
    v_mul_f32 v191, v191, v19
    v_mul_f32 v180, v180, v19
    v_mul_f32_dpp v184, v16, v184 row_newbcast:8 row_mask:0xf bank_mask:0xf
    v_mul_f32 v161, v161, v19
    v_mul_f32 v189, v189, v19
    v_mul_f32_dpp v182, v16, v182 row_newbcast:6 row_mask:0xf bank_mask:0xf
    v_mfma_f32_32x32x16_bf16 v[96:111], v[80:83], v[144:147], v[96:111]
    ds_write_b128 v6, v[128:131] offset:0
    v_mul_f32 v163, v163, v19
    v_mfma_f32_32x32x16_bf16 v[96:111], v[84:87], v[148:151], v[96:111]
    v_mul_f32 v170, v170, v19
    v_mul_f32_dpp v192, v15, v192 row_newbcast:0 row_mask:0xf bank_mask:0xf
    v_mul_f32_dpp v194, v15, v194 row_newbcast:2 row_mask:0xf bank_mask:0xf
    v_cvt_pk_bf16_f32 v132, v136, v137
    v_mul_f32_dpp v240, v16, v240 row_newbcast:0 row_mask:0xf bank_mask:0xf
    v_cvt_pk_bf16_f32 v134, v140, v141
    v_mfma_f32_32x32x16_bf16 v[224:239], v[56:59], a[184:187], 0
    v_mul_f32_dpp v197, v15, v197 row_newbcast:5 row_mask:0xf bank_mask:0xf
    v_mul_f32 v182, v182, v19
    v_mul_f32_dpp v254, v16, v254 row_newbcast:14 row_mask:0xf bank_mask:0xf
    v_mul_f32 v164, v164, v19
    v_mul_f32_dpp v249, v16, v249 row_newbcast:9 row_mask:0xf bank_mask:0xf
    v_mul_f32_dpp v204, v15, v204 row_newbcast:12 row_mask:0xf bank_mask:0xf
    v_mfma_f32_32x32x16_bf16 v[208:223], v[40:43], a[192:195], v[208:223]
    v_mul_f32_dpp v253, v16, v253 row_newbcast:13 row_mask:0xf bank_mask:0xf
    v_mul_f32_dpp v185, v16, v185 row_newbcast:9 row_mask:0xf bank_mask:0xf
    v_mul_f32_dpp v168, v15, v168 row_newbcast:8 row_mask:0xf bank_mask:0xf
    v_mul_f32_e64 v168, v168, v19
    v_mul_f32_dpp v252, v16, v252 row_newbcast:12 row_mask:0xf bank_mask:0xf
    v_mul_f32_dpp v202, v15, v202 row_newbcast:10 row_mask:0xf bank_mask:0xf
    v_mfma_f32_32x32x16_bf16 v[224:239], v[60:63], a[188:191], v[224:239]
    ds_write_b128 v7, v[132:135] offset:0
    v_mul_f32_dpp v207, v15, v207 row_newbcast:15 row_mask:0xf bank_mask:0xf
    v_mfma_f32_32x32x16_bf16 v[224:239], v[64:67], a[192:195], v[224:239]
    v_mul_f32_dpp v246, v16, v246 row_newbcast:6 row_mask:0xf bank_mask:0xf
    v_cvt_pk_bf16_f32 v96, v96, v97
    v_cvt_pk_bf16_f32 v97, v98, v99
    v_mul_f32_dpp v193, v15, v193 row_newbcast:1 row_mask:0xf bank_mask:0xf
    v_mul_f32_dpp v198, v15, v198 row_newbcast:6 row_mask:0xf bank_mask:0xf
    v_mul_f32_dpp v245, v16, v245 row_newbcast:5 row_mask:0xf bank_mask:0xf
    v_mfma_f32_32x32x16_bf16 v[208:223], v[44:47], a[196:199], v[208:223]
    v_mul_f32_dpp v255, v16, v255 row_newbcast:15 row_mask:0xf bank_mask:0xf
    v_mul_f32_dpp v247, v16, v247 row_newbcast:7 row_mask:0xf bank_mask:0xf
    v_mul_f32_dpp v206, v15, v206 row_newbcast:14 row_mask:0xf bank_mask:0xf
    v_cvt_pk_bf16_f32 v99, v102, v103
    v_mul_f32 v166, v166, v19
    v_cvt_pk_bf16_f32 v98, v100, v101
    v_mfma_f32_32x32x16_bf16 v[208:223], v[48:51], a[200:203], v[208:223]
    ds_write_b128 v6, v[96:99] offset:64
    v_cvt_pk_bf16_f32 v103, v110, v111
    v_mfma_f32_32x32x16_bf16 v[208:223], v[52:55], a[204:207], v[208:223]
    v_max3_f32 v17, v192, v193, v194
    v_mul_f32 v160, v160, v19
    v_cvt_pk_bf16_f32 v160, v160, v161
    v_mul_f32_dpp v200, v15, v200 row_newbcast:8 row_mask:0xf bank_mask:0xf
    v_mul_f32_dpp v241, v16, v241 row_newbcast:1 row_mask:0xf bank_mask:0xf
    v_mul_f32_dpp v196, v15, v196 row_newbcast:4 row_mask:0xf bank_mask:0xf
    v_mfma_f32_32x32x16_bf16 v[112:127], a[0:3], a[56:59], 0
    v_mul_f32_dpp v205, v15, v205 row_newbcast:13 row_mask:0xf bank_mask:0xf
    v_cvt_pk_bf16_f32 v161, v162, v163
    v_mul_f32_dpp v187, v16, v187 row_newbcast:11 row_mask:0xf bank_mask:0xf
    v_mul_f32_dpp v195, v15, v195 row_newbcast:3 row_mask:0xf bank_mask:0xf
    v_mul_f32 v187, v187, v19
    v_mul_f32_e64 v167, v167, v19
    v_mfma_f32_32x32x16_bf16 v[112:127], a[4:7], a[60:63], v[112:127]
    v_cvt_pk_bf16_f32 v208, v208, v209
    v_cvt_pk_bf16_f32 v209, v210, v211
    v_cvt_pk_bf16_f32 v210, v212, v213
    v_mul_f32_dpp v242, v16, v242 row_newbcast:2 row_mask:0xf bank_mask:0xf
    v_cvt_pk_bf16_f32 v212, v216, v217
    v_cvt_pk_bf16_f32 v211, v214, v215
    v_mfma_f32_32x32x16_bf16 v[224:239], v[68:71], a[196:199], v[224:239]
    s_sub_u32 s66, 0, s66
    v_mul_f32_dpp v203, v15, v203 row_newbcast:11 row_mask:0xf bank_mask:0xf
    v_cvt_pk_bf16_f32 v213, v218, v219
    v_max3_f32 v17, v17, v195, v196
    v_max3_f32 v17, v17, v197, v198
    v_mul_f32_dpp v199, v15, v199 row_newbcast:7 row_mask:0xf bank_mask:0xf
    v_max3_f32 v17, v17, v199, v200
    v_mfma_f32_32x32x16_bf16 v[224:239], v[72:75], a[200:203], v[224:239]
    v_mul_f32_dpp v201, v15, v201 row_newbcast:9 row_mask:0xf bank_mask:0xf
    v_max3_f32 v17, v17, v201, v202
    v_max3_f32 v17, v17, v203, v204
    v_mul_f32 v172, v172, v19
    v_max3_f32 v17, v17, v205, v206
    v_max3_f32 v17, v17, v207, v240
    v_mfma_f32_32x32x16_bf16 v[224:239], v[76:79], a[204:207], v[224:239]
    v_mul_f32 v175, v175, v19
    v_max3_f32 v17, v17, v241, v242
    v_max3_f32 v17, v17, v243, v244
    v_max3_f32 v17, v17, v245, v246
    v_max3_f32 v17, v17, v247, v248
    v_max3_f32 v17, v17, v249, v250
    v_mfma_f32_32x32x16_bf16 v[128:143], a[24:27], a[56:59], 0
    ds_read_b128 a[56:59], v11 offset:24576
    v_max3_f32 v17, v17, v251, v252
    v_max3_f32 v17, v17, v253, v254
    v_max_f32 v20, v17, v255
    v_mul_f32 v185, v185, v19
    v_max_f32 v17, v17, v255
    v_mfma_f32_32x32x16_bf16 v[128:143], a[28:31], a[60:63], v[128:143]
    ds_read_b128 a[60:63], v11 offset:25600
    v_permlane32_swap_b32 v17, v20
    v_max_f32 v17, v17, v20
    v_mul_f32 v17, v17, v14
    v_fma_f32 v202, v202, v14, -v17
    v_mfma_f32_32x32x16_bf16 v[112:127], a[8:11], a[64:67], v[112:127]
    v_cvt_pk_bf16_f32 v215, v222, v223
    v_cvt_pk_bf16_f32 v223, v238, v239
    v_cvt_pk_bf16_f32 v222, v236, v237
    v_exp_f32 v202, v202
    v_cvt_pk_bf16_f32 v163, v166, v167
    v_mfma_f32_32x32x16_bf16 v[128:143], a[32:35], a[64:67], v[128:143]
    v_cvt_pk_bf16_f32 v166, v172, v173
    v_mul_f32 v184, v184, v19
    v_fma_f32 v193, v193, v14, -v17
    v_fma_f32 v196, v196, v14, -v17
    v_cvt_pk_bf16_f32 v219, v230, v231
    v_fma_f32 v192, v192, v14, -v17
    v_mfma_f32_32x32x16_bf16 v[128:143], a[36:39], a[68:71], v[128:143]
    ds_read_b128 v[24:27], v18 offset:8192
    v_fma_f32 v194, v194, v14, -v17
    v_exp_f32 v193, v193
    v_exp_f32 v194, v194
    v_mfma_f32_32x32x16_bf16 v[112:127], a[12:15], a[68:71], v[112:127]
    s_waitcnt lgkmcnt(2)
    v_fma_f32 v203, v203, v14, -v17
    v_cvt_pk_bf16_f32 v217, v226, v227
    v_cvt_pk_bf16_f32 v218, v228, v229
    v_exp_f32 v192, v192
    v_cvt_pk_bf16_f32 v162, v164, v165
    v_mfma_f32_32x32x16_bf16 v[112:127], a[16:19], a[56:59], v[112:127]
    s_waitcnt lgkmcnt(1)
    v_fma_f32 v195, v195, v14, -v17
    v_exp_f32 v203, v203
    v_exp_f32 v195, v195
    v_mul_f32 v174, v174, v19
    v_mfma_f32_32x32x16_bf16 v[112:127], a[20:23], a[60:63], v[112:127]
    v_fma_f32 v199, v199, v14, -v17
    v_exp_f32 v199, v199
    v_exp_f32 v196, v196
    v_mul_f32 v178, v178, v19
    v_mfma_f32_32x32x16_bf16 v[128:143], a[40:43], a[56:59], v[128:143]
    v_fma_f32 v201, v201, v14, -v17
    v_exp_f32 v201, v201
    v_fma_f32 v197, v197, v14, -v17
    v_exp_f32_e64 v197, v197
    v_mfma_f32_32x32x16_bf16 v[128:143], a[44:47], a[60:63], v[128:143]
    v_cvt_pk_bf16_f32 v102, v108, v109
    v_cvt_pk_bf16_f32 v214, v220, v221
    v_cvt_pk_bf16_f32 v220, v232, v233
    v_cvt_pk_bf16_f32 v100, v104, v105
    v_cvt_pk_bf16_f32 v221, v234, v235
    v_cvt_pk_bf16_f32 v216, v224, v225
    v_mfma_f32_32x32x16_bf16 v[224:239], v[32:35], a[208:211], 0
    v_cvt_pk_bf16_f32 v112, v112, v113
    v_cvt_pk_bf16_f32 v113, v114, v115
    v_cvt_pk_bf16_f32 v115, v118, v119
    v_cvt_pk_bf16_f32 v118, v124, v125
    v_fma_f32 v198, v198, v14, -v17
    v_mul_f32 v183, v183, v19
    v_mfma_f32_32x32x16_bf16 v[224:239], v[36:39], a[212:215], v[224:239]
    v_cvt_pk_bf16_f32 v114, v116, v117
    v_fma_f32 v206, v206, v14, -v17
    v_exp_f32 v206, v206
    v_fma_f32 v200, v200, v14, -v17
    v_cvt_pk_bf16_f32 v116, v120, v121
    v_mfma_f32_32x32x16_bf16 v[224:239], v[40:43], a[216:219], v[224:239]
    v_cvt_pk_bf16_f32 v167, v174, v175
    v_cvt_pk_bf16_f32 v174, v188, v189
    v_exp_f32 v200, v200
    v_cvt_pk_bf16_f32 v125, v138, v139
    v_cvt_pk_bf16_f32 v120, v128, v129
    v_mfma_f32_32x32x16_bf16 v[224:239], v[44:47], a[220:223], v[224:239]
    ds_read_b128 v[28:31], v18 offset:7168
    v_exp_f32 v198, v198
    v_cvt_pk_bf16_f32 v117, v122, v123
    v_cvt_pk_bf16_f32 v119, v126, v127
    v_cvt_pk_bf16_f32 v122, v132, v133
    v_cvt_pk_bf16_f32 v123, v134, v135
    v_mfma_f32_4x4x4_16b_bf16 v[132:135], v[22:23], a[34:35], 0
    v_cvt_pk_bf16_f32 v101, v106, v107
    v_mfma_f32_4x4x4_16b_bf16 v[108:111], v[22:23], a[46:47], 0
    v_cvt_pk_bf16_f32 v124, v136, v137
    v_mfma_f32_4x4x4_16b_bf16 v[136:139], v[22:23], a[36:37], 0
    v_cvt_pk_bf16_f32 v126, v140, v141
    v_mfma_f32_4x4x4_16b_bf16 v[104:107], v[22:23], a[44:45], 0
    v_cvt_pk_bf16_f32 v127, v142, v143
    v_mfma_f32_4x4x4_16b_bf16 v[140:143], v[22:23], a[38:39], 0
    v_cvt_pk_bf16_f32 v121, v130, v131
    v_mfma_f32_4x4x4_16b_bf16 v[128:131], v[22:23], a[32:33], 0
    v_fma_f32 v204, v204, v14, -v17
    v_mfma_f32_4x4x4_16b_bf16 v[96:99], v[22:23], a[40:41], 0
    v_mul_f32_dpp v169, v15, v169 row_newbcast:9 row_mask:0xf bank_mask:0xf
    v_mul_f32 v169, v169, v19
    v_mfma_f32_32x32x16_bf16 v[128:143], v[88:91], v[152:155], v[128:143]
    ds_write_b128 v7, v[100:103] offset:64
    v_cvt_pk_bf16_f32 v172, v184, v185
    v_mfma_f32_32x32x16_bf16 v[128:143], v[92:95], v[156:159], v[128:143]
    v_mul_f32 v181, v181, v19
    v_mul_f32 v186, v186, v19
    v_add_f32 v19, v192, v193
    v_mul_f32_dpp v193, v15, v193 row_newbcast:1 row_mask:0xf bank_mask:0xf
    v_add_f32 v19, v19, v194
    v_add_f32 v19, v19, v195
    v_add_f32 v19, v19, v196
    v_mfma_f32_4x4x4_16b_bf16 v[88:91], v[22:23], a[20:21], 0
    v_add_f32 v19, v19, v197
    v_mfma_f32_4x4x4_16b_bf16 v[92:95], v[22:23], a[22:23], 0
    v_add_f32_e64 v19, v19, v198
    v_cvt_pk_bf16_f32 v165, v170, v171
    v_mfma_f32_4x4x4_16b_bf16 v[100:103], v[22:23], a[42:43], 0
    v_cvt_pk_bf16_f32 v128, v128, v129
    v_mfma_f32_4x4x4_16b_bf16 v[84:87], v[22:23], a[18:19], 0
    v_cvt_pk_bf16_f32 v129, v130, v131
    v_mfma_f32_4x4x4_16b_bf16 v[80:83], v[22:23], a[16:17], 0
    v_cvt_pk_bf16_f32 v170, v180, v181
    v_add_f32 v19, v19, v199
    v_mfma_f32_32x32x16_bf16 v[224:239], v[48:51], a[224:227], v[224:239]
    v_cvt_pk_bf16_f32 v175, v190, v191
    v_mul_f32_dpp v199, v15, v199 row_newbcast:7 row_mask:0xf bank_mask:0xf
    v_cvt_pk_bf16_f32 v130, v132, v133
    v_cvt_pk_bf16_f32 v132, v136, v137
    v_add_f32 v19, v19, v200
    v_mul_f32_dpp v196, v15, v196 row_newbcast:4 row_mask:0xf bank_mask:0xf
    v_mfma_f32_32x32x16_bf16 v[224:239], v[52:55], a[228:231], v[224:239]
    v_cvt_pk_bf16_f32 v131, v134, v135
    v_cvt_pk_bf16_f32 v134, v140, v141
    v_cvt_pk_bf16_f32 v135, v142, v143
    v_cvt_pk_bf16_f32 v164, v168, v169
    v_exp_f32 v204, v204
    v_mfma_f32_32x32x16_bf16 v[96:111], v[120:123], v[152:155], v[96:111]
    v_cvt_pk_bf16_f32 v133, v138, v139
    v_fma_f32 v205, v205, v14, -v17
    v_cvt_pk_bf16_f32 v168, v176, v177
    v_exp_f32 v205, v205
    v_mul_f32_dpp v200, v15, v200 row_newbcast:8 row_mask:0xf bank_mask:0xf
    v_mfma_f32_32x32x16_bf16 v[96:111], v[124:127], v[156:159], v[96:111]
    v_cvt_pk_bf16_f32 v224, v224, v225
    v_cvt_pk_bf16_f32 v225, v226, v227
    v_cvt_pk_bf16_f32 v226, v228, v229
    v_cvt_pk_bf16_f32 v171, v182, v183
    v_cvt_pk_bf16_f32 v169, v178, v179
    v_cvt_pk_bf16_f32 v173, v186, v187
    v_mfma_f32_32x32x16_bf16 v[176:191], v[56:59], a[208:211], 0
    ds_write_b128 v6, v[128:131] offset:6208
    v_add_f32_e64 v19, v19, v201
    v_mfma_f32_32x32x16_bf16 v[176:191], v[60:63], a[212:215], v[176:191]
    v_cvt_pk_bf16_f32 v228, v232, v233
    v_cvt_pk_bf16_f32 v96, v96, v97
    v_cvt_pk_bf16_f32 v97, v98, v99
    v_cvt_pk_bf16_f32 v99, v102, v103
    v_cvt_pk_bf16_f32 v98, v100, v101
    v_cvt_pk_bf16_f32 v101, v106, v107
    v_mfma_f32_32x32x16_bf16 v[176:191], v[64:67], a[216:219], v[176:191]
    ds_write_b128 v6, v[96:99] offset:6272
    v_cvt_pk_bf16_f32 v100, v104, v105
    v_mfma_f32_32x32x16_bf16 v[176:191], v[68:71], a[220:223], v[176:191]
    v_cvt_pk_bf16_f32 v103, v110, v111
    v_mul_f32_dpp v198, v15, v198 row_newbcast:6 row_mask:0xf bank_mask:0xf
    v_cvt_pk_bf16_f32 v102, v108, v109
    v_cvt_pk_bf16_f32 v229, v234, v235
    v_cvt_pk_bf16_f32 v227, v230, v231
    v_cvt_pk_bf16_f32 v230, v236, v237
    v_mfma_f32_32x32x16_bf16 v[176:191], v[72:75], a[224:227], v[176:191]
    s_waitcnt lgkmcnt(3)
    ds_write_b128 v7, v[100:103] offset:6272
    v_add_f32 v19, v19, v202
    v_mfma_f32_32x32x16_bf16 v[176:191], v[76:79], a[228:231], v[176:191]
    buffer_store_dwordx4 v[28:31], v4, s[20:23], s45 offen offset:1024 sc1
    v_add_f32 v19, v19, v203
    v_mfma_f32_32x32x16_bf16 v[80:95], v[112:115], v[144:147], v[80:95]
    v_add_f32 v19, v19, v204
    v_mul_f32_dpp v204, v15, v204 row_newbcast:12 row_mask:0xf bank_mask:0xf
    v_mul_f32_dpp v202, v15, v202 row_newbcast:10 row_mask:0xf bank_mask:0xf
    v_cvt_pk_bf16_f32 v231, v238, v239
    v_cvt_pk_bf16_f32 v238, v188, v189
    v_cvt_pk_bf16_f32 v239, v190, v191
    v_mfma_f32_32x32x16_bf16 v[80:95], v[116:119], v[148:151], v[80:95]
    v_cvt_pk_bf16_f32 v236, v184, v185
    v_cvt_pk_bf16_f32 v234, v180, v181
    v_cvt_pk_bf16_f32 v232, v176, v177
    v_cvt_pk_bf16_f32 v237, v186, v187
    v_cvt_pk_bf16_f32 v235, v182, v183
    v_cvt_pk_bf16_f32 v233, v178, v179
    v_mfma_f32_32x32x16_bf16 v[176:191], v[32:35], a[232:235], 0
    ds_write_b128 v7, v[132:135] offset:6208
    v_add_f32_e64 v19, v19, v205
    v_mfma_f32_32x32x16_bf16 v[176:191], v[36:39], a[236:239], v[176:191]
    v_cvt_pk_bf16_f32 v80, v80, v81
    v_cvt_pk_bf16_f32 v81, v82, v83
    v_cvt_pk_bf16_f32 v82, v84, v85
    v_cvt_pk_bf16_f32 v84, v88, v89
    v_cvt_pk_bf16_f32 v83, v86, v87
    v_cvt_pk_bf16_f32 v86, v92, v93
    v_mfma_f32_32x32x16_bf16 v[176:191], v[40:43], a[240:243], v[176:191]
    ds_write_b128 v6, v[80:83] offset:128
    v_cvt_pk_bf16_f32 v85, v90, v91
    v_mfma_f32_32x32x16_bf16 v[176:191], v[44:47], a[244:247], v[176:191]
    buffer_store_dwordx4 v[24:27], v5, s[20:23], s45 offen offset:2048 sc1
    v_cvt_pk_bf16_f32 v87, v94, v95
    v_mfma_f32_32x32x16_bf16 v[176:191], v[48:51], a[248:251], v[176:191]
    s_mov_b32 s44, s40
    ds_write_b128 v7, v[84:87] offset:128
    v_add_u32 v7, s65, v7
    v_mfma_f32_32x32x16_bf16 v[176:191], v[52:55], a[252:255], v[176:191]
    s_add_u32 s45, s40, 73728
    s_mov_b32 s40, s41
    s_mov_b32 s41, s38
    v_mul_f32_dpp v194, v15, v194 row_newbcast:2 row_mask:0xf bank_mask:0xf
    v_mul_f32_dpp v195, v15, v195 row_newbcast:3 row_mask:0xf bank_mask:0xf
    v_add_u32 v6, s65, v6
    s_sub_u32 s65, 0, s65
    v_mul_f32_dpp v201, v15, v201 row_newbcast:9 row_mask:0xf bank_mask:0xf
    v_mul_f32_dpp v203, v15, v203 row_newbcast:11 row_mask:0xf bank_mask:0xf
    v_mul_f32_dpp v197, v15, v197 row_newbcast:5 row_mask:0xf bank_mask:0xf
    v_mul_f32_dpp v205, v15, v205 row_newbcast:13 row_mask:0xf bank_mask:0xf
    v_add_f32_e64 v19, v19, v206
    v_cvt_pk_bf16_f32 v31, v190, v191
    v_cvt_pk_bf16_f32 v26, v180, v181
    v_cvt_pk_bf16_f32 v25, v178, v179
    v_cvt_pk_bf16_f32 v27, v182, v183
    v_cvt_pk_bf16_f32 v24, v176, v177
    v_cvt_pk_bf16_f32 v30, v188, v189
    v_mul_f32_dpp v192, v15, v192 row_newbcast:0 row_mask:0xf bank_mask:0xf
    v_cvt_pk_bf16_f32 v28, v184, v185
    v_cvt_pk_bf16_f32 v29, v186, v187
    s_cmp_lt_u32 s36, 2304
    s_waitcnt vmcnt(7) lgkmcnt(0)
    s_barrier
    s_cbranch_scc1 L_loop
    v_mfma_f32_4x4x4_16b_bf16 v[132:135], v[22:23], v[42:43], 0
    v_fma_f32 v248, v248, v14, -v17
    v_mfma_f32_4x4x4_16b_bf16 v[140:143], v[22:23], v[46:47], 0
    v_fma_f32 v207, v207, v14, -v17
    v_mfma_f32_4x4x4_16b_bf16 v[116:119], v[22:23], v[34:35], 0
    v_mfma_f32_4x4x4_16b_bf16 v[112:115], v[22:23], v[32:33], 0
    ds_read_b128 v[32:35], v8 offset:0
    v_mfma_f32_4x4x4_16b_bf16 v[136:139], v[22:23], v[44:45], 0
    ds_read_b128 v[44:47], v9 offset:64
    v_mfma_f32_4x4x4_16b_bf16 v[120:123], v[22:23], v[36:37], 0
    v_fma_f32 v242, v242, v14, -v17
    v_mfma_f32_4x4x4_16b_bf16 v[128:131], v[22:23], v[40:41], 0
    v_fma_f32 v247, v247, v14, -v17
    v_mfma_f32_4x4x4_16b_bf16 v[124:127], v[22:23], v[38:39], 0
    v_exp_f32 v247, v247
    v_mfma_f32_32x32x16_bf16 v[176:191], v[56:59], a[232:235], 0
    v_fma_f32 v251, v251, v14, -v17
    v_exp_f32 v242, v242
    v_exp_f32 v207, v207
    v_fma_f32 v250, v250, v14, -v17
    v_mfma_f32_32x32x16_bf16 v[128:143], v[224:227], v[160:163], v[128:143]
    ds_read_b128 v[36:39], v9 offset:0
    v_exp_f32 v250, v250
    v_exp_f32 v251, v251
    v_add_f32 v19, v19, v207
    v_mfma_f32_32x32x16_bf16 v[176:191], v[60:63], a[236:239], v[176:191]
    ds_read_b128 v[40:43], v8 offset:64
    v_fma_f32 v240, v240, v14, -v17
    v_exp_f32 v240, v240
    v_mul_f32_dpp v206, v15, v206 row_newbcast:14 row_mask:0xf bank_mask:0xf
    v_fma_f32 v249, v249, v14, -v17
    v_mfma_f32_32x32x16_bf16 v[128:143], v[228:231], v[164:167], v[128:143]
    s_waitcnt lgkmcnt(3)
    v_fma_f32 v241, v241, v14, -v17
    v_fma_f32 v246, v246, v14, -v17
    v_exp_f32 v246, v246
    v_exp_f32 v241, v241
    v_mfma_f32_32x32x16_bf16 v[80:95], v[32:35], a[184:187], 0
    v_fma_f32 v245, v245, v14, -v17
    v_exp_f32 v245, v245
    v_add_f32 v19, v19, v240
    v_add_f32 v19, v19, v241
    v_add_f32 v19, v19, v242
    v_mfma_f32_32x32x16_bf16 v[176:191], v[64:67], a[240:243], v[176:191]
    v_fma_f32 v254, v254, v14, -v17
    v_exp_f32 v254, v254
    v_fma_f32 v253, v253, v14, -v17
    v_exp_f32 v248, v248
    v_mfma_f32_32x32x16_bf16 v[96:111], v[32:35], a[208:211], 0
    v_fma_f32 v243, v243, v14, -v17
    v_exp_f32 v243, v243
    v_mul_f32_dpp v207, v15, v207 row_newbcast:15 row_mask:0xf bank_mask:0xf
    v_exp_f32 v253, v253
    v_mfma_f32_32x32x16_bf16 v[176:191], v[68:71], a[244:247], v[176:191]
    s_waitcnt lgkmcnt(1)
    v_fma_f32 v244, v244, v14, -v17
    v_exp_f32 v244, v244
    v_exp_f32 v249, v249
    v_fma_f32 v255, v255, v14, -v17
    v_mfma_f32_32x32x16_bf16 v[96:111], v[36:39], a[212:215], v[96:111]
    v_add_f32 v19, v19, v243
    v_add_f32 v19, v19, v244
    v_mul_f32_dpp v240, v16, v240 row_newbcast:0 row_mask:0xf bank_mask:0xf
    v_mul_f32_dpp v244, v16, v244 row_newbcast:4 row_mask:0xf bank_mask:0xf
    v_add_f32 v19, v19, v245
    v_add_f32 v19, v19, v246
    v_mfma_f32_32x32x16_bf16 v[112:127], v[208:211], v[160:163], v[112:127]
    v_add_f32 v19, v19, v247
    v_mul_f32_dpp v246, v16, v246 row_newbcast:6 row_mask:0xf bank_mask:0xf
    v_add_f32 v19, v19, v248
    v_mul_f32_dpp v245, v16, v245 row_newbcast:5 row_mask:0xf bank_mask:0xf
    v_add_f32 v19, v19, v249
    v_add_f32 v19, v19, v250
    v_mfma_f32_32x32x16_bf16 v[144:159], v[32:35], a[232:235], 0
    v_fma_f32 v252, v252, v14, -v17
    v_exp_f32 v252, v252
    v_exp_f32 v255, v255
    v_add_f32 v19, v19, v251
    v_mfma_f32_32x32x16_bf16 v[112:127], v[212:215], v[164:167], v[112:127]
    v_add_f32 v19, v19, v252
    v_add_f32 v19, v19, v253
    v_add_f32 v19, v19, v254
    v_add_f32 v19, v19, v255
    v_mov_b32 v20, v19
    v_mul_f32_dpp v255, v16, v255 row_newbcast:15 row_mask:0xf bank_mask:0xf
    v_mfma_f32_32x32x16_bf16 v[176:191], v[72:75], a[248:251], v[176:191]
    v_mul_f32_dpp v253, v16, v253 row_newbcast:13 row_mask:0xf bank_mask:0xf
    v_permlane32_swap_b32 v19, v20
    v_add_f32 v19, v19, v20
    v_rcp_f32 v19, v19
    v_mfma_f32_32x32x16_bf16 v[128:143], v[232:235], v[168:171], v[128:143]
    v_mul_f32 v240, v240, v19
    v_mul_f32 v206, v206, v19
    v_mul_f32_dpp v252, v16, v252 row_newbcast:12 row_mask:0xf bank_mask:0xf
    v_mul_f32 v252, v252, v19
    v_mul_f32_dpp v241, v16, v241 row_newbcast:1 row_mask:0xf bank_mask:0xf
    v_mul_f32 v196, v196, v19
    v_mfma_f32_32x32x16_bf16 v[112:127], v[216:219], v[168:171], v[112:127]
    v_mul_f32_dpp v254, v16, v254 row_newbcast:14 row_mask:0xf bank_mask:0xf
    v_mul_f32 v254, v254, v19
    v_mul_f32 v200, v200, v19
    v_mul_f32 v193, v193, v19
    v_mul_f32 v205, v205, v19
    v_mul_f32 v201, v201, v19
    v_mfma_f32_32x32x16_bf16 v[144:159], v[36:39], a[236:239], v[144:159]
    s_waitcnt lgkmcnt(0)
    v_mul_f32 v194, v194, v19
    v_mul_f32 v192, v192, v19
    v_cvt_pk_bf16_f32 v192, v192, v193
    v_mul_f32 v244, v244, v19
    v_mul_f32 v199, v199, v19
    v_mul_f32 v197, v197, v19
    v_mfma_f32_32x32x16_bf16 v[96:111], v[40:43], a[216:219], v[96:111]
    v_mul_f32_dpp v248, v16, v248 row_newbcast:8 row_mask:0xf bank_mask:0xf
    v_mul_f32 v204, v204, v19
    v_mul_f32_dpp v250, v16, v250 row_newbcast:10 row_mask:0xf bank_mask:0xf
    v_mul_f32 v250, v250, v19
    v_mul_f32 v246, v246, v19
    v_mul_f32_dpp v242, v16, v242 row_newbcast:2 row_mask:0xf bank_mask:0xf
    v_mfma_f32_32x32x16_bf16 v[96:111], v[44:47], a[220:223], v[96:111]
    v_mul_f32_dpp v251, v16, v251 row_newbcast:11 row_mask:0xf bank_mask:0xf
    v_mul_f32 v251, v251, v19
    v_mul_f32 v242, v242, v19
    v_mul_f32 v195, v195, v19
    v_cvt_pk_bf16_f32 v193, v194, v195
    v_mul_f32 v202, v202, v19
    v_mfma_f32_32x32x16_bf16 v[80:95], v[36:39], a[188:191], v[80:95]
    v_mul_f32 v241, v241, v19
    v_mul_f32 v248, v248, v19
    v_mul_f32 v203, v203, v19
    v_cvt_pk_bf16_f32 v194, v196, v197
    v_cvt_pk_bf16_f32 v196, v200, v201
    v_cvt_pk_bf16_f32 v197, v202, v203
    v_mfma_f32_32x32x16_bf16 v[128:143], v[236:239], v[172:175], v[128:143]
    v_mul_f32 v198, v198, v19
    v_cvt_pk_bf16_f32 v195, v198, v199
    v_cvt_pk_bf16_f32 v198, v204, v205
    v_mul_f32 v245, v245, v19
    v_mul_f32 v207, v207, v19
    v_cvt_pk_bf16_f32 v199, v206, v207
    v_mfma_f32_32x32x16_bf16 v[112:127], v[220:223], v[172:175], v[112:127]
    v_mul_f32_dpp v243, v16, v243 row_newbcast:3 row_mask:0xf bank_mask:0xf
    v_mul_f32 v243, v243, v19
    v_cvt_pk_bf16_f32 v201, v242, v243
    v_mul_f32_dpp v247, v16, v247 row_newbcast:7 row_mask:0xf bank_mask:0xf
    v_mul_f32 v247, v247, v19
    v_cvt_pk_bf16_f32 v203, v246, v247
    v_mfma_f32_32x32x16_bf16 v[176:191], v[76:79], a[252:255], v[176:191]
    v_mul_f32_dpp v249, v16, v249 row_newbcast:9 row_mask:0xf bank_mask:0xf
    v_mul_f32 v249, v249, v19
    v_cvt_pk_bf16_f32 v204, v248, v249
    v_mul_f32 v255, v255, v19
    v_cvt_pk_bf16_f32 v207, v254, v255
    v_mul_f32 v253, v253, v19
    v_cvt_pk_bf16_f32 v206, v252, v253
    v_mfma_f32_4x4x4_16b_bf16 v[252:255], v[22:23], v[54:55], 0
    v_cvt_pk_bf16_f32 v205, v250, v251
    v_mfma_f32_4x4x4_16b_bf16 v[248:251], v[22:23], v[52:53], 0
    v_cvt_pk_bf16_f32 v202, v244, v245
    v_mfma_f32_4x4x4_16b_bf16 v[244:247], v[22:23], v[50:51], 0
    v_cvt_pk_bf16_f32 v200, v240, v241
    v_mfma_f32_4x4x4_16b_bf16 v[240:243], v[22:23], v[48:49], 0
    v_cvt_pk_bf16_f32 v176, v176, v177
    v_cvt_pk_bf16_f32 v177, v178, v179
    v_cvt_pk_bf16_f32 v178, v180, v181
    v_cvt_pk_bf16_f32 v181, v186, v187
    v_mfma_f32_32x32x16_bf16 v[240:255], v[24:27], v[160:163], v[240:255]
    ds_read_b128 v[48:51], v8 offset:128
    v_cvt_pk_bf16_f32 v128, v128, v129
    v_cvt_pk_bf16_f32 v129, v130, v131
    v_cvt_pk_bf16_f32 v131, v134, v135
    v_cvt_pk_bf16_f32 v112, v112, v113
    v_cvt_pk_bf16_f32 v113, v114, v115
    v_mfma_f32_32x32x16_bf16 v[240:255], v[28:31], v[164:167], v[240:255]
    v_cvt_pk_bf16_f32 v130, v132, v133
    v_cvt_pk_bf16_f32 v179, v182, v183
    v_cvt_pk_bf16_f32 v183, v190, v191
    v_cvt_pk_bf16_f32 v114, v116, v117
    v_cvt_pk_bf16_f32 v115, v118, v119
    v_cvt_pk_bf16_f32 v119, v126, v127
    v_mfma_f32_32x32x16_bf16 v[240:255], v[176:179], v[168:171], v[240:255]
    v_cvt_pk_bf16_f32 v134, v140, v141
    v_cvt_pk_bf16_f32 v180, v184, v185
    v_cvt_pk_bf16_f32 v135, v142, v143
    v_cvt_pk_bf16_f32 v182, v188, v189
    v_cvt_pk_bf16_f32 v118, v124, v125
    v_cvt_pk_bf16_f32 v116, v120, v121
    v_mfma_f32_32x32x16_bf16 v[240:255], v[180:183], v[172:175], v[240:255]
    ds_write_b128 v10, v[128:131] offset:64
    v_mfma_f32_4x4x4_16b_bf16 v[164:167], v[22:23], v[58:59], 0
    v_mfma_f32_4x4x4_16b_bf16 v[172:175], v[22:23], v[62:63], 0
    v_mfma_f32_4x4x4_16b_bf16 v[168:171], v[22:23], v[60:61], 0
    ds_read_b128 v[60:63], v9 offset:6144
    v_mfma_f32_4x4x4_16b_bf16 v[160:163], v[22:23], v[56:57], 0
    s_waitcnt lgkmcnt(2)
    ds_read_b128 v[56:59], v8 offset:6144
    v_mfma_f32_32x32x16_bf16 v[96:111], v[48:51], a[224:227], v[96:111]
    ds_read_b128 v[52:55], v9 offset:128
    v_cvt_pk_bf16_f32 v240, v240, v241
    v_cvt_pk_bf16_f32 v241, v242, v243
    v_cvt_pk_bf16_f32 v243, v246, v247
    v_cvt_pk_bf16_f32 v247, v254, v255
    v_mfma_f32_32x32x16_bf16 v[160:175], v[208:211], v[192:195], v[160:175]
    ds_write_b128 v10, v[112:115] offset:0
    v_cvt_pk_bf16_f32 v117, v122, v123
    v_mfma_f32_32x32x16_bf16 v[160:175], v[212:215], v[196:199], v[160:175]
    v_cvt_pk_bf16_f32 v242, v244, v245
    v_cvt_pk_bf16_f32 v244, v248, v249
    v_mfma_f32_32x32x16_bf16 v[160:175], v[216:219], v[200:203], v[160:175]
    v_mfma_f32_32x32x16_bf16 v[160:175], v[220:223], v[204:207], v[160:175]
    ds_write_b128 v10, v[240:243] offset:128
    v_cvt_pk_bf16_f32 v245, v250, v251
    v_mfma_f32_4x4x4_16b_bf16 v[240:243], v[32:33], v[32:33], 0
    v_mfma_f32_4x4x4_16b_bf16 v[208:211], v[22:23], v[64:65], 0
    v_mfma_f32_4x4x4_16b_bf16 v[216:219], v[22:23], v[68:69], 0
    s_waitcnt lgkmcnt(2)
    v_mfma_f32_4x4x4_16b_bf16 v[220:223], v[22:23], v[70:71], 0
    ds_read_b128 v[68:71], v9 offset:6208
    v_mfma_f32_4x4x4_16b_bf16 v[212:215], v[22:23], v[66:67], 0
    ds_read_b128 v[64:67], v8 offset:6208
    v_mfma_f32_4x4x4_16b_bf16 v[240:243], v[34:35], v[34:35], v[240:243]
    v_cvt_pk_bf16_f32 v133, v138, v139
    v_mfma_f32_32x32x16_bf16 v[96:111], v[52:55], a[228:231], v[96:111]
    ds_write_b128 v21, v[116:119] offset:0
    v_cvt_pk_bf16_f32 v132, v136, v137
    v_mfma_f32_32x32x16_bf16 v[208:223], v[224:227], v[192:195], v[208:223]
    v_mfma_f32_32x32x16_bf16 v[208:223], v[228:231], v[196:199], v[208:223]
    ds_write_b128 v21, v[132:135] offset:64
    v_mfma_f32_32x32x16_bf16 v[208:223], v[232:235], v[200:203], v[208:223]
    v_cvt_pk_bf16_f32 v246, v252, v253
    v_cvt_pk_bf16_f32 v160, v160, v161
    v_cvt_pk_bf16_f32 v161, v162, v163
    v_cvt_pk_bf16_f32 v163, v166, v167
    v_cvt_pk_bf16_f32 v162, v164, v165
    v_cvt_pk_bf16_f32 v164, v168, v169
    v_mfma_f32_32x32x16_bf16 v[208:223], v[236:239], v[204:207], v[208:223]
    ds_write_b128 v21, v[244:247] offset:128
    v_cvt_pk_bf16_f32 v166, v172, v173
    v_mfma_f32_4x4x4_16b_bf16 v[244:247], v[56:57], v[56:57], 0
    v_cvt_pk_bf16_f32 v165, v170, v171
    v_mfma_f32_4x4x4_16b_bf16 v[240:243], v[36:37], v[36:37], v[240:243]
    v_mfma_f32_4x4x4_16b_bf16 v[244:247], v[58:59], v[58:59], v[244:247]
    v_mfma_f32_4x4x4_16b_bf16 v[240:243], v[38:39], v[38:39], v[240:243]
    v_mfma_f32_4x4x4_16b_bf16 v[244:247], v[60:61], v[60:61], v[244:247]
    v_cvt_pk_bf16_f32 v96, v96, v97
    v_mfma_f32_4x4x4_16b_bf16 v[232:235], v[22:23], v[76:77], 0
    s_waitcnt lgkmcnt(3)
    v_mfma_f32_4x4x4_16b_bf16 v[244:247], v[62:63], v[62:63], v[244:247]
    ds_read_b128 v[248:251], v18 offset:5120
    v_mfma_f32_4x4x4_16b_bf16 v[240:243], v[40:41], v[40:41], v[240:243]
    v_mfma_f32_4x4x4_16b_bf16 v[244:247], v[64:65], v[64:65], v[244:247]
    ds_read_b128 v[120:123], v18 offset:3072
    v_mfma_f32_4x4x4_16b_bf16 v[240:243], v[42:43], v[42:43], v[240:243]
    v_mfma_f32_4x4x4_16b_bf16 v[224:227], v[22:23], v[72:73], 0
    v_mfma_f32_4x4x4_16b_bf16 v[236:239], v[22:23], v[78:79], 0
    ds_read_b128 v[76:79], v9 offset:6272
    v_mfma_f32_4x4x4_16b_bf16 v[228:231], v[22:23], v[74:75], 0
    v_mfma_f32_4x4x4_16b_bf16 v[244:247], v[66:67], v[66:67], v[244:247]
    ds_read_b128 v[72:75], v8 offset:6272
    v_mfma_f32_4x4x4_16b_bf16 v[240:243], v[44:45], v[44:45], v[240:243]
    v_mfma_f32_4x4x4_16b_bf16 v[244:247], v[68:69], v[68:69], v[244:247]
    ds_read_b128 v[136:139], v18 offset:4096
    v_mfma_f32_4x4x4_16b_bf16 v[240:243], v[46:47], v[46:47], v[240:243]
    v_mfma_f32_4x4x4_16b_bf16 v[244:247], v[70:71], v[70:71], v[244:247]
    v_cvt_pk_bf16_f32 v97, v98, v99
    v_mfma_f32_32x32x16_bf16 v[224:239], v[24:27], v[192:195], v[224:239]
    ds_read_b128 v[24:27], v18 offset:0
    v_cvt_pk_bf16_f32 v99, v102, v103
    v_cvt_pk_bf16_f32 v103, v110, v111
    v_cvt_pk_bf16_f32 v102, v108, v109
    v_mfma_f32_32x32x16_bf16 v[224:239], v[28:31], v[196:199], v[224:239]
    ds_read_b128 v[28:31], v18 offset:1024
    v_cvt_pk_bf16_f32 v208, v208, v209
    v_cvt_pk_bf16_f32 v209, v210, v211
    v_cvt_pk_bf16_f32 v210, v212, v213
    v_cvt_pk_bf16_f32 v213, v218, v219
    v_cvt_pk_bf16_f32 v212, v216, v217
    v_mfma_f32_32x32x16_bf16 v[224:239], v[176:179], v[200:203], v[224:239]
    v_cvt_pk_bf16_f32 v167, v174, v175
    v_cvt_pk_bf16_f32 v211, v214, v215
    v_add_u32 v9, s66, v9
    v_mfma_f32_32x32x16_bf16 v[224:239], v[180:183], v[204:207], v[224:239]
    s_waitcnt lgkmcnt(5)
    v_mfma_f32_32x32x16_bf16 v[192:207], a[160:163], v[32:35], 0
    buffer_store_dwordx4 v[120:123], v3, s[20:23], s44 offen offset:0 sc1
    s_waitcnt lgkmcnt(3)
    v_mfma_f32_4x4x4_16b_bf16 v[240:243], v[48:49], v[48:49], v[240:243]
    v_mfma_f32_4x4x4_16b_bf16 v[244:247], v[72:73], v[72:73], v[244:247]
    v_mfma_f32_4x4x4_16b_bf16 v[240:243], v[50:51], v[50:51], v[240:243]
    v_mfma_f32_4x4x4_16b_bf16 v[244:247], v[74:75], v[74:75], v[244:247]
    v_cvt_pk_bf16_f32 v224, v224, v225
    v_mfma_f32_4x4x4_16b_bf16 v[240:243], v[52:53], v[52:53], v[240:243]
    v_mfma_f32_4x4x4_16b_bf16 v[244:247], v[76:77], v[76:77], v[244:247]
    v_mfma_f32_4x4x4_16b_bf16 v[240:243], v[54:55], v[54:55], v[240:243]
    s_waitcnt lgkmcnt(2)
    v_mfma_f32_4x4x4_16b_bf16 v[244:247], v[78:79], v[78:79], v[244:247]
    v_cvt_pk_bf16_f32 v214, v220, v221
    v_cvt_pk_bf16_f32 v225, v226, v227
    v_mfma_f32_32x32x16_bf16 v[192:207], a[164:167], v[36:39], v[192:207]
    buffer_store_dwordx4 v[136:139], v4, s[20:23], s44 offen offset:1024 sc1
    v_mfma_f32_32x32x16_bf16 v[192:207], a[168:171], v[40:43], v[192:207]
    ds_write_b128 v21, v[164:167] offset:3072
    v_cndmask_b32_e64 v244, v244, v245, s[56:57]
    v_mfma_f32_32x32x16_bf16 v[192:207], a[172:175], v[44:47], v[192:207]
    v_cvt_pk_bf16_f32 v227, v230, v231
    v_cvt_pk_bf16_f32 v230, v236, v237
    v_cndmask_b32_e64 v240, v240, v241, s[56:57]
    v_cndmask_b32_e64 v240, v240, v242, s[58:59]
    v_cndmask_b32_e64 v244, v244, v246, s[58:59]
    v_cvt_pk_bf16_f32 v231, v238, v239
    v_mfma_f32_32x32x16_bf16 v[192:207], a[176:179], v[48:51], v[192:207]
    ds_write_b128 v10, v[208:211] offset:3136
    v_cndmask_b32_e64 v244, v244, v247, s[60:61]
    v_mfma_f32_32x32x16_bf16 v[192:207], a[180:183], v[52:55], v[192:207]
    s_waitcnt lgkmcnt(3)
    v_cndmask_b32_e64 v240, v240, v243, s[60:61]
    s_nop 1
    v_permlane32_swap_b32 v240, v244
    v_add_f32 v240, v240, v244
    v_mfma_f32_32x32x16_bf16 v[176:191], a[136:139], v[32:35], 0
    buffer_store_dwordx4 v[24:27], v0, s[20:23], s44 offen offset:0 sc1
    v_mfma_f32_32x32x16_bf16 v[176:191], a[140:143], v[36:39], v[176:191]
    v_cvt_pk_bf16_f32 v215, v222, v223
    ds_read_b128 v[24:27], v18 offset:2048
    v_mfma_f32_32x32x16_bf16 v[176:191], a[144:147], v[40:43], v[176:191]
    s_waitcnt lgkmcnt(3)
    v_mfma_f32_32x32x16_bf16 v[176:191], a[148:151], v[44:47], v[176:191]
    buffer_store_dwordx4 v[28:31], v1, s[20:23], s44 offen offset:1024 sc1
    v_mfma_f32_32x32x16_bf16 v[176:191], a[152:155], v[48:51], v[176:191]
    ds_write_b128 v10, v[160:163] offset:3072
    v_mfma_f32_32x32x16_bf16 v[176:191], a[156:159], v[52:55], v[176:191]
    v_cvt_pk_bf16_f32 v226, v228, v229
    v_cvt_pk_bf16_f32 v228, v232, v233
    v_add_u32 v8, s66, v8
    v_mfma_f32_32x32x16_bf16 v[160:175], a[112:115], v[32:35], 0
    s_waitcnt lgkmcnt(1)
    buffer_store_dwordx4 v[24:27], v2, s[20:23], s44 offen offset:2048 sc1
    v_mfma_f32_32x32x16_bf16 v[160:175], a[116:119], v[36:39], v[160:175]
    ds_write_b128 v10, v[224:227] offset:3200
    v_cvt_pk_bf16_f32 v227, v198, v199
    v_mfma_f32_32x32x16_bf16 v[160:175], a[120:123], v[40:43], v[160:175]
    v_cvt_pk_bf16_f32 v223, v190, v191
    v_cvt_pk_bf16_f32 v222, v188, v189
    v_cvt_pk_bf16_f32 v229, v234, v235
    v_cvt_pk_bf16_f32 v217, v178, v179
    v_cvt_pk_bf16_f32 v224, v192, v193
    v_cvt_pk_bf16_f32 v218, v180, v181
    v_mfma_f32_32x32x16_bf16 v[160:175], a[124:127], v[44:47], v[160:175]
    ds_write_b128 v21, v[212:215] offset:3136
    v_cvt_pk_bf16_f32 v216, v176, v177
    v_mfma_f32_32x32x16_bf16 v[160:175], a[128:131], v[48:51], v[160:175]
    buffer_store_dwordx4 v[248:251], v5, s[20:23], s44 offen offset:2048 sc1
    v_mfma_f32_32x32x16_bf16 v[160:175], a[132:135], v[52:55], v[160:175]
    ds_write_b128 v21, v[228:231] offset:3200
    v_cvt_pk_bf16_f32 v229, v202, v203
    v_mfma_f32_16x16x32_bf16 v[248:251], a[48:51], v[32:35], 0
    v_mfma_f32_16x16x32_bf16 v[248:251], a[48:51], v[36:39], v[248:251]
    v_cvt_pk_bf16_f32 v220, v184, v185
    v_mfma_f32_16x16x32_bf16 v[248:251], a[48:51], v[40:43], v[248:251]
    v_cvt_pk_bf16_f32 v211, v166, v167
    v_cvt_pk_bf16_f32 v215, v174, v175
    v_mfma_f32_16x16x32_bf16 v[248:251], a[48:51], v[44:47], v[248:251]
    ds_read_b128 v[24:27], v18 offset:4096
    v_cvt_pk_bf16_f32 v210, v164, v165
    v_mfma_f32_16x16x32_bf16 v[248:251], a[48:51], v[48:51], v[248:251]
    v_cvt_pk_bf16_f32 v219, v182, v183
    v_cvt_pk_bf16_f32 v212, v168, v169
    v_mfma_f32_16x16x32_bf16 v[248:251], a[48:51], v[52:55], v[248:251]
    ds_read_b128 v[28:31], v18 offset:3072
    v_cvt_pk_bf16_f32 v208, v160, v161
    v_mfma_f32_16x16x32_bf16 v[248:251], a[52:55], v[56:59], v[248:251]
    v_cvt_pk_bf16_f32 v209, v162, v163
    v_mfma_f32_16x16x32_bf16 v[248:251], a[52:55], v[60:63], v[248:251]
    v_cvt_pk_bf16_f32 v230, v204, v205
    v_mfma_f32_16x16x32_bf16 v[248:251], a[52:55], v[64:67], v[248:251]
    v_mfma_f32_16x16x32_bf16 v[248:251], a[52:55], v[68:71], v[248:251]
    v_mfma_f32_16x16x32_bf16 v[248:251], a[52:55], v[72:75], v[248:251]
    v_cvt_pk_bf16_f32 v225, v194, v195
    v_cvt_pk_bf16_f32 v226, v196, v197
    v_mfma_f32_16x16x32_bf16 v[248:251], a[52:55], v[76:79], v[248:251]
    v_cvt_pk_bf16_f32 v214, v172, v173
    v_cvt_pk_bf16_f32 v213, v170, v171
    v_mfma_f32_32x32x16_bf16 v[160:175], v[32:35], v[208:211], 0
    s_waitcnt lgkmcnt(1)
    buffer_store_dwordx4 v[24:27], v1, s[20:23], s45 offen offset:1024 sc1
    v_mfma_f32_32x32x16_bf16 v[160:175], v[36:39], v[212:215], v[160:175]
    s_nop 0
    ds_read_b128 v[24:27], v18 offset:6144
    v_fma_f32 v248, -v248, v248, s64
    v_fma_f32 v240, v240, s67, v248
    v_max_f32 v240, s64, v240
    v_rsq_f32 v252, v240
    v_mfma_f32_32x32x16_bf16 v[160:175], v[40:43], v[216:219], v[160:175]
    v_cvt_pk_bf16_f32 v228, v200, v201
    v_cvt_pk_bf16_f32 v231, v206, v207
    v_cvt_pk_bf16_f32 v221, v186, v187
    v_mov_b32 v14, v252
    s_nop 0
    s_waitcnt lgkmcnt(1)
    v_mfma_f32_32x32x16_bf16 v[160:175], v[44:47], v[220:223], v[160:175]
    buffer_store_dwordx4 v[28:31], v0, s[20:23], s45 offen offset:0 sc1
    v_mfma_f32_32x32x16_bf16 v[160:175], v[48:51], v[224:227], v[160:175]
    ds_bpermute_b32 v15, v12, v252 offset:0
    ds_read_b128 v[28:31], v18 offset:5120
    v_cvt_pk_bf16_f32 v98, v100, v101
    v_mov_b32_e64 v13, v252
    v_cvt_pk_bf16_f32 v101, v106, v107
    v_mfma_f32_32x32x16_bf16 v[160:175], v[52:55], v[228:231], v[160:175]
    ds_bpermute_b32 v16, v12, v252 offset:128
    v_permlane32_swap_b32 v13, v14
    v_cvt_pk_bf16_f32 v100, v104, v105
    s_waitcnt lgkmcnt(3)
    v_mfma_f32_32x32x16_bf16 v[176:191], v[56:59], v[208:211], 0
    buffer_store_dwordx4 v[24:27], v3, s[20:23], s45 offen offset:0 sc1
    v_mfma_f32_32x32x16_bf16 v[176:191], v[60:63], v[212:215], v[176:191]
    s_nop 0
    ds_read_b128 v[24:27], v18 offset:8192
    s_waitcnt lgkmcnt(3)
    v_mul_f32_dpp v164, v15, v164 row_newbcast:4 row_mask:0xf bank_mask:0xf
    v_mul_f32_dpp v174, v15, v174 row_newbcast:14 row_mask:0xf bank_mask:0xf
    v_mul_f32_dpp v160, v15, v160 row_newbcast:0 row_mask:0xf bank_mask:0xf
    v_mul_f32_dpp v175, v15, v175 row_newbcast:15 row_mask:0xf bank_mask:0xf
    v_mfma_f32_32x32x16_bf16 v[176:191], v[64:67], v[216:219], v[176:191]
    v_mul_f32_dpp v161, v15, v161 row_newbcast:1 row_mask:0xf bank_mask:0xf
    v_mul_f32_dpp v165, v15, v165 row_newbcast:5 row_mask:0xf bank_mask:0xf
    v_mul_f32_dpp v162, v15, v162 row_newbcast:2 row_mask:0xf bank_mask:0xf
    v_max3_f32 v17, v160, v161, v162
    v_mul_f32_dpp v171, v15, v171 row_newbcast:11 row_mask:0xf bank_mask:0xf
    v_mul_f32_dpp v167, v15, v167 row_newbcast:7 row_mask:0xf bank_mask:0xf
    v_mfma_f32_32x32x16_bf16 v[176:191], v[68:71], v[220:223], v[176:191]
    v_mul_f32_dpp v163, v15, v163 row_newbcast:3 row_mask:0xf bank_mask:0xf
    v_max3_f32 v17, v17, v163, v164
    v_mul_f32_dpp v166, v15, v166 row_newbcast:6 row_mask:0xf bank_mask:0xf
    v_max3_f32 v17, v17, v165, v166
    v_mul_f32_dpp v170, v15, v170 row_newbcast:10 row_mask:0xf bank_mask:0xf
    v_mfma_f32_32x32x16_bf16 v[176:191], v[72:75], v[224:227], v[176:191]
    s_waitcnt lgkmcnt(2)
    v_mul_f32_dpp v173, v15, v173 row_newbcast:13 row_mask:0xf bank_mask:0xf
    v_mul_f32_dpp v172, v15, v172 row_newbcast:12 row_mask:0xf bank_mask:0xf
    v_mul_f32_dpp v168, v15, v168 row_newbcast:8 row_mask:0xf bank_mask:0xf
    v_max3_f32 v17, v17, v167, v168
    v_mul_f32_dpp v169, v15, v169 row_newbcast:9 row_mask:0xf bank_mask:0xf
    v_max3_f32 v17, v17, v169, v170
    v_mfma_f32_32x32x16_bf16 v[176:191], v[76:79], v[228:231], v[176:191]
    s_waitcnt lgkmcnt(1)
    buffer_store_dwordx4 v[28:31], v2, s[20:23], s45 offen offset:2048 sc1
    v_mfma_f32_32x32x16_bf16 v[112:127], v[56:59], a[184:187], 0
    s_nop 0
    ds_read_b128 v[28:31], v18 offset:7168
    v_max3_f32 v17, v17, v171, v172
    v_max3_f32 v17, v17, v173, v174
    v_mul_f32_dpp v186, v16, v186 row_newbcast:10 row_mask:0xf bank_mask:0xf
    v_mul_f32_dpp v177, v16, v177 row_newbcast:1 row_mask:0xf bank_mask:0xf
    v_mul_f32_dpp v185, v16, v185 row_newbcast:9 row_mask:0xf bank_mask:0xf
    v_mfma_f32_32x32x16_bf16 v[80:95], v[40:43], a[192:195], v[80:95]
    v_mul_f32_dpp v181, v16, v181 row_newbcast:5 row_mask:0xf bank_mask:0xf
    v_mul_f32_dpp v179, v16, v179 row_newbcast:3 row_mask:0xf bank_mask:0xf
    v_mul_f32_dpp v178, v16, v178 row_newbcast:2 row_mask:0xf bank_mask:0xf
    v_mul_f32_dpp v176, v16, v176 row_newbcast:0 row_mask:0xf bank_mask:0xf
    v_max3_f32 v17, v17, v175, v176
    v_max3_f32 v17, v17, v177, v178
    v_mul_f32_dpp v184, v16, v184 row_newbcast:8 row_mask:0xf bank_mask:0xf
    v_mul_f32_dpp v188, v16, v188 row_newbcast:12 row_mask:0xf bank_mask:0xf
    v_mfma_f32_32x32x16_bf16 v[144:159], v[40:43], a[240:243], v[144:159]
    v_mul_f32_dpp v180, v16, v180 row_newbcast:4 row_mask:0xf bank_mask:0xf
    v_max3_f32 v17, v17, v179, v180
    v_mul_f32_dpp v182, v16, v182 row_newbcast:6 row_mask:0xf bank_mask:0xf
    v_max3_f32 v17, v17, v181, v182
    v_mul_f32_dpp v183, v16, v183 row_newbcast:7 row_mask:0xf bank_mask:0xf
    v_mul_f32_dpp v187, v16, v187 row_newbcast:11 row_mask:0xf bank_mask:0xf
    v_max3_f32 v17, v17, v183, v184
    v_max3_f32 v17, v17, v185, v186
    v_mfma_f32_32x32x16_bf16 v[80:95], v[44:47], a[196:199], v[80:95]
    v_mul_f32_dpp v190, v16, v190 row_newbcast:14 row_mask:0xf bank_mask:0xf
    v_mul_f32_dpp v189, v16, v189 row_newbcast:13 row_mask:0xf bank_mask:0xf
    v_max3_f32 v17, v17, v187, v188
    v_max3_f32 v17, v17, v189, v190
    v_mul_f32_dpp v191, v16, v191 row_newbcast:15 row_mask:0xf bank_mask:0xf
    v_max_f32 v20, v17, v191
    v_max_f32 v17, v17, v191
    v_mfma_f32_32x32x16_bf16 v[240:255], a[136:139], v[56:59], 0
    s_nop 0
    v_permlane32_swap_b32 v17, v20
    v_max_f32 v17, v17, v20
    v_mul_f32 v17, v17, v13
    v_fma_f32 v177, v177, v13, -v17
    v_fma_f32 v186, v186, v13, -v17
    v_mfma_f32_32x32x16_bf16 v[128:143], v[56:59], a[208:211], 0
    v_fma_f32 v167, v167, v13, -v17
    v_fma_f32 v173, v173, v13, -v17
    v_fma_f32 v171, v171, v13, -v17
    v_fma_f32 v182, v182, v13, -v17
    v_exp_f32 v171, v171
    v_mfma_f32_32x32x16_bf16 v[144:159], v[44:47], a[244:247], v[144:159]
    v_fma_f32 v169, v169, v13, -v17
    v_fma_f32 v175, v175, v13, -v17
    v_exp_f32 v175, v175
    v_fma_f32 v168, v168, v13, -v17
    v_exp_f32 v168, v168
    v_mfma_f32_32x32x16_bf16 v[144:159], v[48:51], a[248:251], v[144:159]
    v_exp_f32 v177, v177
    v_fma_f32 v172, v172, v13, -v17
    v_exp_f32 v172, v172
    v_fma_f32 v164, v164, v13, -v17
    v_mfma_f32_32x32x16_bf16 v[192:207], a[112:115], v[56:59], 0
    v_fma_f32 v174, v174, v13, -v17
    v_exp_f32 v164, v164
    v_fma_f32 v165, v165, v13, -v17
    v_exp_f32 v165, v165
    v_mfma_f32_32x32x16_bf16 v[192:207], a[116:119], v[60:63], v[192:207]
    v_fma_f32 v162, v162, v13, -v17
    v_exp_f32 v162, v162
    v_fma_f32 v160, v160, v13, -v17
    v_exp_f32 v160, v160
    v_mfma_f32_32x32x16_bf16 v[128:143], v[60:63], a[212:215], v[128:143]
    v_fma_f32 v191, v191, v13, -v17
    v_exp_f32 v191, v191
    v_fma_f32 v161, v161, v13, -v17
    v_exp_f32 v161, v161
    v_mfma_f32_32x32x16_bf16 v[192:207], a[120:123], v[64:67], v[192:207]
    v_fma_f32 v179, v179, v13, -v17
    v_exp_f32 v179, v179
    v_fma_f32 v189, v189, v13, -v17
    v_fma_f32 v176, v176, v13, -v17
    v_fma_f32 v170, v170, v13, -v17
    v_mfma_f32_32x32x16_bf16 v[112:127], v[60:63], a[188:191], v[112:127]
    v_fma_f32 v190, v190, v13, -v17
    v_fma_f32 v188, v188, v13, -v17
    v_exp_f32 v188, v188
    v_exp_f32 v176, v176
    v_mfma_f32_32x32x16_bf16 v[128:143], v[64:67], a[216:219], v[128:143]
    v_fma_f32 v166, v166, v13, -v17
    v_fma_f32 v180, v180, v13, -v17
    v_exp_f32 v170, v170
    v_exp_f32 v166, v166
    v_mfma_f32_32x32x16_bf16 v[240:255], a[140:143], v[60:63], v[240:255]
    v_fma_f32 v181, v181, v13, -v17
    v_exp_f32 v181, v181
    v_exp_f32 v180, v180
    v_fma_f32 v163, v163, v13, -v17
    v_mfma_f32_32x32x16_bf16 v[240:255], a[144:147], v[64:67], v[240:255]
    v_exp_f32 v182, v182
    v_exp_f32 v163, v163
    v_fma_f32 v183, v183, v13, -v17
    v_fma_f32 v185, v185, v13, -v17
    v_mfma_f32_32x32x16_bf16 v[192:207], a[124:127], v[68:71], v[192:207]
    v_exp_f32 v183, v183
    v_exp_f32 v169, v169
    v_exp_f32 v167, v167
    v_mfma_f32_32x32x16_bf16 v[112:127], v[64:67], a[192:195], v[112:127]
    v_add_f32 v19, v160, v161
    v_mul_f32_dpp v161, v15, v161 row_newbcast:1 row_mask:0xf bank_mask:0xf
    v_add_f32 v19, v19, v162
    v_add_f32 v19, v19, v163
    v_exp_f32 v174, v174
    v_add_f32 v19, v19, v164
    v_add_f32 v19, v19, v165
    v_add_f32 v19, v19, v166
    v_mfma_f32_32x32x16_bf16 v[192:207], a[128:131], v[72:75], v[192:207]
    v_add_f32 v19, v19, v167
    v_add_f32 v19, v19, v168
    v_add_f32 v19, v19, v169
    v_exp_f32 v190, v190
    v_exp_f32 v173, v173
    v_mfma_f32_32x32x16_bf16 v[144:159], v[52:55], a[252:255], v[144:159]
    v_add_f32 v19, v19, v170
    v_add_f32 v19, v19, v171
    v_exp_f32 v189, v189
    v_exp_f32 v186, v186
    v_mfma_f32_32x32x16_bf16 v[192:207], a[132:135], v[76:79], v[192:207]
    v_add_f32 v19, v19, v172
    v_add_f32 v19, v19, v173
    v_mul_f32_dpp v160, v15, v160 row_newbcast:0 row_mask:0xf bank_mask:0xf
    v_add_f32 v19, v19, v174
    v_cvt_pk_bf16_f32 v144, v144, v145
    v_cvt_pk_bf16_f32 v145, v146, v147
    v_cvt_pk_bf16_f32 v146, v148, v149
    v_mfma_f32_32x32x16_bf16 v[240:255], a[148:151], v[68:71], v[240:255]
    v_add_f32 v19, v19, v175
    v_add_f32 v19, v19, v176
    v_mul_f32_dpp v175, v15, v175 row_newbcast:15 row_mask:0xf bank_mask:0xf
    v_add_f32 v19, v19, v177
    v_mul_f32_dpp v171, v15, v171 row_newbcast:11 row_mask:0xf bank_mask:0xf
    v_fma_f32 v178, v178, v13, -v17
    v_mfma_f32_32x32x16_bf16 v[128:143], v[68:71], a[220:223], v[128:143]
    s_sub_u32 s66, 0, s66
    v_fma_f32 v187, v187, v13, -v17
    v_exp_f32 v187, v187
    v_exp_f32 v178, v178
    v_mul_f32_dpp v173, v15, v173 row_newbcast:13 row_mask:0xf bank_mask:0xf
    v_mfma_f32_32x32x16_bf16 v[112:127], v[68:71], a[196:199], v[112:127]
    v_add_f32 v19, v19, v178
    v_add_f32 v19, v19, v179
    v_add_f32 v19, v19, v180
    v_mul_f32_dpp v180, v16, v180 row_newbcast:4 row_mask:0xf bank_mask:0xf
    v_add_f32 v19, v19, v181
    v_mul_f32_dpp v181, v16, v181 row_newbcast:5 row_mask:0xf bank_mask:0xf
    v_mfma_f32_32x32x16_bf16 v[240:255], a[152:155], v[72:75], v[240:255]
    v_exp_f32 v185, v185
    v_add_f32 v19, v19, v182
    v_fma_f32 v184, v184, v13, -v17
    v_exp_f32 v184, v184
    v_mfma_f32_32x32x16_bf16 v[240:255], a[156:159], v[76:79], v[240:255]
    v_add_f32 v19, v19, v183
    v_add_f32 v19, v19, v184
    v_add_f32 v19, v19, v185
    v_mul_f32_dpp v185, v16, v185 row_newbcast:9 row_mask:0xf bank_mask:0xf
    v_add_f32 v19, v19, v186
    v_cvt_pk_bf16_f32 v234, v196, v197
    v_mfma_f32_32x32x16_bf16 v[128:143], v[72:75], a[224:227], v[128:143]
    s_waitcnt lgkmcnt(1)
    v_add_f32 v19, v19, v187
    v_add_f32 v19, v19, v188
    v_mul_f32_dpp v166, v15, v166 row_newbcast:6 row_mask:0xf bank_mask:0xf
    v_add_f32 v19, v19, v189
    v_add_f32 v19, v19, v190
    v_add_f32 v19, v19, v191
    v_mfma_f32_32x32x16_bf16 v[112:127], v[72:75], a[200:203], v[112:127]
    buffer_store_dwordx4 v[24:27], v5, s[20:23], s45 offen offset:2048 sc1
    v_mul_f32_dpp v190, v16, v190 row_newbcast:14 row_mask:0xf bank_mask:0xf
    v_mfma_f32_32x32x16_bf16 v[112:127], v[76:79], a[204:207], v[112:127]
    v_mul_f32_dpp v165, v15, v165 row_newbcast:5 row_mask:0xf bank_mask:0xf
    v_cvt_pk_bf16_f32 v147, v150, v151
    v_cvt_pk_bf16_f32 v237, v202, v203
    v_cvt_pk_bf16_f32 v150, v156, v157
    v_mov_b32 v20, v19
    v_mul_f32_dpp v168, v15, v168 row_newbcast:8 row_mask:0xf bank_mask:0xf
    v_mfma_f32_32x32x16_bf16 v[80:95], v[48:51], a[200:203], v[80:95]
    v_permlane32_swap_b32 v19, v20
    v_mul_f32_dpp v184, v16, v184 row_newbcast:8 row_mask:0xf bank_mask:0xf
    v_add_f32 v19, v19, v20
    v_mul_f32_dpp v164, v15, v164 row_newbcast:4 row_mask:0xf bank_mask:0xf
    v_cvt_pk_bf16_f32 v239, v206, v207
    v_mfma_f32_32x32x16_bf16 v[80:95], v[52:55], a[204:207], v[80:95]
    v_cvt_pk_bf16_f32 v233, v194, v195
    v_cvt_pk_bf16_f32 v235, v198, v199
    v_mul_f32_dpp v186, v16, v186 row_newbcast:10 row_mask:0xf bank_mask:0xf
    v_cvt_pk_bf16_f32 v232, v192, v193
    v_cvt_pk_bf16_f32 v238, v204, v205
    v_cvt_pk_bf16_f32 v236, v200, v201
    v_mfma_f32_32x32x16_bf16 v[192:207], a[160:163], v[56:59], 0
    v_rcp_f32 v19, v19
    v_cvt_pk_bf16_f32 v214, v252, v253
    v_mul_f32 v164, v164, v19
    v_mul_f32_dpp v162, v15, v162 row_newbcast:2 row_mask:0xf bank_mask:0xf
    v_mul_f32_dpp v189, v16, v189 row_newbcast:13 row_mask:0xf bank_mask:0xf
    v_mfma_f32_32x32x16_bf16 v[192:207], a[164:167], v[60:63], v[192:207]
    v_mul_f32_dpp v170, v15, v170 row_newbcast:10 row_mask:0xf bank_mask:0xf
    v_cvt_pk_bf16_f32 v80, v80, v81
    v_mul_f32 v170, v170, v19
    v_cvt_pk_bf16_f32 v81, v82, v83
    v_cvt_pk_bf16_f32 v82, v84, v85
    v_cvt_pk_bf16_f32 v83, v86, v87
    v_mfma_f32_32x32x16_bf16 v[128:143], v[76:79], a[228:231], v[128:143]
    v_mul_f32 v166, v166, v19
    v_mul_f32_dpp v191, v16, v191 row_newbcast:15 row_mask:0xf bank_mask:0xf
    v_mul_f32 v191, v191, v19
    v_mul_f32_dpp v167, v15, v167 row_newbcast:7 row_mask:0xf bank_mask:0xf
    v_mul_f32 v167, v167, v19
    v_cvt_pk_bf16_f32 v149, v154, v155
    v_mfma_f32_32x32x16_bf16 v[192:207], a[168:171], v[64:67], v[192:207]
    v_cvt_pk_bf16_f32 v87, v94, v95
    v_cvt_pk_bf16_f32 v85, v90, v91
    v_mul_f32_dpp v187, v16, v187 row_newbcast:11 row_mask:0xf bank_mask:0xf
    v_mul_f32 v187, v187, v19
    v_mul_f32_dpp v179, v16, v179 row_newbcast:3 row_mask:0xf bank_mask:0xf
    v_mul_f32 v175, v175, v19
    v_mul_f32 v168, v168, v19
    v_mfma_f32_32x32x16_bf16 v[192:207], a[172:175], v[68:71], v[192:207]
    v_cvt_pk_bf16_f32 v151, v158, v159
    v_mul_f32_dpp v169, v15, v169 row_newbcast:9 row_mask:0xf bank_mask:0xf
    v_cvt_pk_bf16_f32 v106, v132, v133
    v_mul_f32 v179, v179, v19
    v_mul_f32 v180, v180, v19
    v_cvt_pk_bf16_f32 v209, v242, v243
    v_mfma_f32_32x32x16_bf16 v[192:207], a[176:179], v[72:75], v[192:207]
    v_cvt_pk_bf16_f32 v212, v248, v249
    v_mul_f32_dpp v174, v15, v174 row_newbcast:14 row_mask:0xf bank_mask:0xf
    v_mul_f32 v174, v174, v19
    v_mul_f32 v161, v161, v19
    v_cvt_pk_bf16_f32 v107, v134, v135
    v_mul_f32 v185, v185, v19
    v_mfma_f32_32x32x16_bf16 v[192:207], a[180:183], v[76:79], v[192:207]
    v_mul_f32 v190, v190, v19
    v_cvt_pk_bf16_f32 v215, v254, v255
    v_cvt_pk_bf16_f32 v211, v246, v247
    v_cvt_pk_bf16_f32 v213, v250, v251
    v_cvt_pk_bf16_f32 v208, v240, v241
    v_cvt_pk_bf16_f32 v210, v244, v245
    v_mfma_f32_32x32x16_bf16 v[240:255], v[56:59], v[232:235], 0
    v_mul_f32 v173, v173, v19
    v_mul_f32_dpp v163, v15, v163 row_newbcast:3 row_mask:0xf bank_mask:0xf
    v_mul_f32 v163, v163, v19
    v_mul_f32 v171, v171, v19
    v_cvt_pk_bf16_f32 v223, v206, v207
    v_cvt_pk_bf16_f32 v218, v196, v197
    v_mfma_f32_32x32x16_bf16 v[240:255], v[60:63], v[236:239], v[240:255]
    s_waitcnt lgkmcnt(0)
    v_cvt_pk_bf16_f32 v217, v194, v195
    v_cvt_pk_bf16_f32 v222, v204, v205
    v_mul_f32 v160, v160, v19
    v_cvt_pk_bf16_f32 v84, v88, v89
    v_cvt_pk_bf16_f32 v148, v152, v153
    v_cvt_pk_bf16_f32 v160, v160, v161
    v_mfma_f32_32x32x16_bf16 v[240:255], v[64:67], v[208:211], v[240:255]
    buffer_store_dwordx4 v[28:31], v4, s[20:23], s45 offen offset:1024 sc1
    v_cvt_pk_bf16_f32 v219, v198, v199
    v_mfma_f32_32x32x16_bf16 v[240:255], v[68:71], v[212:215], v[240:255]
    v_cvt_pk_bf16_f32 v216, v192, v193
    v_cvt_pk_bf16_f32 v221, v202, v203
    v_mul_f32 v165, v165, v19
    v_mul_f32 v162, v162, v19
    v_cvt_pk_bf16_f32 v161, v162, v163
    v_cvt_pk_bf16_f32 v162, v164, v165
    v_mfma_f32_32x32x16_bf16 v[240:255], v[72:75], v[216:219], v[240:255]
    v_cvt_pk_bf16_f32 v220, v200, v201
    v_mul_f32_dpp v172, v15, v172 row_newbcast:12 row_mask:0xf bank_mask:0xf
    v_cvt_pk_bf16_f32 v90, v116, v117
    v_cvt_pk_bf16_f32 v86, v92, v93
    v_cvt_pk_bf16_f32 v93, v122, v123
    v_cvt_pk_bf16_f32 v163, v166, v167
    v_mfma_f32_32x32x16_bf16 v[240:255], v[76:79], v[220:223], v[240:255]
    v_cvt_pk_bf16_f32 v95, v126, v127
    v_mul_f32_dpp v178, v16, v178 row_newbcast:2 row_mask:0xf bank_mask:0xf
    v_mul_f32 v178, v178, v19
    v_cvt_pk_bf16_f32 v111, v142, v143
    v_mul_f32_dpp v183, v16, v183 row_newbcast:7 row_mask:0xf bank_mask:0xf
    v_mul_f32 v183, v183, v19
    v_mfma_f32_32x32x16_bf16 v[192:207], v[32:35], v[232:235], 0
    v_mul_f32_dpp v177, v16, v177 row_newbcast:1 row_mask:0xf bank_mask:0xf
    v_mul_f32 v177, v177, v19
    v_mul_f32_dpp v188, v16, v188 row_newbcast:12 row_mask:0xf bank_mask:0xf
    v_mul_f32 v188, v188, v19
    v_cvt_pk_bf16_f32 v110, v140, v141
    v_mul_f32_dpp v245, v16, v245 row_newbcast:5 row_mask:0xf bank_mask:0xf
    v_mfma_f32_32x32x16_bf16 v[192:207], v[36:39], v[236:239], v[192:207]
    v_cvt_pk_bf16_f32 v167, v174, v175
    v_mul_f32_dpp v176, v16, v176 row_newbcast:0 row_mask:0xf bank_mask:0xf
    v_mul_f32_dpp v182, v16, v182 row_newbcast:6 row_mask:0xf bank_mask:0xf
    v_mul_f32_dpp v246, v16, v246 row_newbcast:6 row_mask:0xf bank_mask:0xf
    v_cvt_pk_bf16_f32 v89, v114, v115
    v_mul_f32_dpp v249, v16, v249 row_newbcast:9 row_mask:0xf bank_mask:0xf
    v_mfma_f32_32x32x16_bf16 v[192:207], v[40:43], v[208:211], v[192:207]
    s_mov_b32 s44, s40
    v_mul_f32 v172, v172, v19
    v_cvt_pk_bf16_f32 v166, v172, v173
    v_mul_f32 v169, v169, v19
    v_cvt_pk_bf16_f32 v164, v168, v169
    v_cvt_pk_bf16_f32 v165, v170, v171
    v_mul_f32_dpp v240, v16, v240 row_newbcast:0 row_mask:0xf bank_mask:0xf
    v_mfma_f32_32x32x16_bf16 v[192:207], v[44:47], v[212:215], v[192:207]
    v_mul_f32 v176, v176, v19
    v_cvt_pk_bf16_f32 v169, v178, v179
    v_mul_f32_e64 v189, v189, v19
    v_mul_f32_dpp v255, v16, v255 row_newbcast:15 row_mask:0xf bank_mask:0xf
    v_mul_f32 v184, v184, v19
    v_mul_f32 v186, v186, v19
    v_mfma_f32_32x32x16_bf16 v[192:207], v[48:51], v[216:219], v[192:207]
    v_cvt_pk_bf16_f32 v91, v118, v119
    v_mul_f32_dpp v247, v16, v247 row_newbcast:7 row_mask:0xf bank_mask:0xf
    v_cvt_pk_bf16_f32 v172, v184, v185
    v_mul_f32_dpp v243, v16, v243 row_newbcast:3 row_mask:0xf bank_mask:0xf
    v_mul_f32_dpp v251, v16, v251 row_newbcast:11 row_mask:0xf bank_mask:0xf
    v_mul_f32_dpp v244, v16, v244 row_newbcast:4 row_mask:0xf bank_mask:0xf
    v_mul_f32_e64 v182, v182, v19
    v_mfma_f32_32x32x16_bf16 v[192:207], v[52:55], v[220:223], v[192:207]
    v_cvt_pk_bf16_f32 v92, v120, v121
    v_cvt_pk_bf16_f32 v174, v188, v189
    v_cvt_pk_bf16_f32 v108, v136, v137
    v_cvt_pk_bf16_f32 v88, v112, v113
    v_cvt_pk_bf16_f32 v94, v124, v125
    v_cvt_pk_bf16_f32 v105, v130, v131
    v_mfma_f32_32x32x16_bf16 v[112:127], v[56:59], a[232:235], 0
    v_mul_f32_dpp v250, v16, v250 row_newbcast:10 row_mask:0xf bank_mask:0xf
    v_mul_f32_e64 v181, v181, v19
    v_cvt_pk_bf16_f32 v170, v180, v181
    v_cvt_pk_bf16_f32 v109, v138, v139
    v_mul_f32_dpp v200, v15, v200 row_newbcast:8 row_mask:0xf bank_mask:0xf
    v_mul_f32_dpp v197, v15, v197 row_newbcast:5 row_mask:0xf bank_mask:0xf
    v_mul_f32_dpp v241, v16, v241 row_newbcast:1 row_mask:0xf bank_mask:0xf
    v_mfma_f32_4x4x4_16b_bf16 v[136:139], v[22:23], v[44:45], 0
    v_mul_f32_dpp v193, v15, v193 row_newbcast:1 row_mask:0xf bank_mask:0xf
    v_mul_f32_dpp v194, v15, v194 row_newbcast:2 row_mask:0xf bank_mask:0xf
    v_mul_f32_dpp v192, v15, v192 row_newbcast:0 row_mask:0xf bank_mask:0xf
    v_mul_f32_dpp v198, v15, v198 row_newbcast:6 row_mask:0xf bank_mask:0xf
    v_max3_f32 v17, v192, v193, v194
    v_mul_f32_dpp v195, v15, v195 row_newbcast:3 row_mask:0xf bank_mask:0xf
    v_mul_f32_dpp v242, v16, v242 row_newbcast:2 row_mask:0xf bank_mask:0xf
    v_mul_f32_dpp v196, v15, v196 row_newbcast:4 row_mask:0xf bank_mask:0xf
    v_max3_f32 v17, v17, v195, v196
    v_max3_f32 v17, v17, v197, v198
    v_mfma_f32_4x4x4_16b_bf16 v[132:135], v[22:23], v[42:43], 0
    v_mul_f32_dpp v199, v15, v199 row_newbcast:7 row_mask:0xf bank_mask:0xf
    v_mul_f32_dpp v202, v15, v202 row_newbcast:10 row_mask:0xf bank_mask:0xf
    v_mfma_f32_32x32x16_bf16 v[112:127], v[60:63], a[236:239], v[112:127]
    v_mul_f32_dpp v204, v15, v204 row_newbcast:12 row_mask:0xf bank_mask:0xf
    v_mul_f32_dpp v253, v16, v253 row_newbcast:13 row_mask:0xf bank_mask:0xf
    v_mul_f32_dpp v203, v15, v203 row_newbcast:11 row_mask:0xf bank_mask:0xf
    v_mul_f32_dpp v205, v15, v205 row_newbcast:13 row_mask:0xf bank_mask:0xf
    v_mul_f32_dpp v206, v15, v206 row_newbcast:14 row_mask:0xf bank_mask:0xf
    v_mul_f32_dpp v201, v15, v201 row_newbcast:9 row_mask:0xf bank_mask:0xf
    v_max3_f32 v17, v17, v199, v200
    v_max3_f32 v17, v17, v201, v202
    v_mul_f32_dpp v252, v16, v252 row_newbcast:12 row_mask:0xf bank_mask:0xf
    v_max3_f32 v17, v17, v203, v204
    v_mul_f32_dpp v248, v16, v248 row_newbcast:8 row_mask:0xf bank_mask:0xf
    v_max3_f32 v17, v17, v205, v206
    v_mul_f32_dpp v207, v15, v207 row_newbcast:15 row_mask:0xf bank_mask:0xf
    v_mfma_f32_32x32x16_bf16 v[112:127], v[64:67], a[240:243], v[112:127]
    v_max3_f32 v17, v17, v207, v240
    v_max3_f32 v17, v17, v241, v242
    v_max3_f32 v17, v17, v243, v244
    v_max3_f32 v17, v17, v245, v246
    v_max3_f32 v17, v17, v247, v248
    v_max3_f32 v17, v17, v249, v250
    v_mul_f32_dpp v254, v16, v254 row_newbcast:14 row_mask:0xf bank_mask:0xf
    v_max3_f32 v17, v17, v251, v252
    v_max3_f32 v17, v17, v253, v254
    v_max_f32 v20, v17, v255
    v_max_f32 v17, v17, v255
    v_cvt_pk_bf16_f32 v175, v190, v191
    v_mfma_f32_4x4x4_16b_bf16 v[188:191], v[22:23], v[38:39], 0
    v_permlane32_swap_b32 v17, v20
    v_max_f32 v17, v17, v20
    v_mul_f32_e64 v17, v17, v14
    v_fma_f32 v204, v204, v14, -v17
    v_fma_f32 v192, v192, v14, -v17
    v_fma_f32 v207, v207, v14, -v17
    v_fma_f32 v199, v199, v14, -v17
    v_fma_f32 v200, v200, v14, -v17
    v_cvt_pk_bf16_f32 v171, v182, v183
    v_mfma_f32_4x4x4_16b_bf16 v[180:183], v[22:23], v[34:35], 0
    v_fma_f32 v196, v196, v14, -v17
    v_exp_f32 v196, v196
    v_fma_f32 v197, v197, v14, -v17
    v_fma_f32 v246, v246, v14, -v17
    v_fma_f32 v241, v241, v14, -v17
    v_cvt_pk_bf16_f32 v173, v186, v187
    v_fma_f32 v254, v254, v14, -v17
    v_fma_f32 v198, v198, v14, -v17
    v_mfma_f32_32x32x16_bf16 v[112:127], v[68:71], a[244:247], v[112:127]
    v_fma_f32 v193, v193, v14, -v17
    v_fma_f32 v203, v203, v14, -v17
    v_fma_f32 v245, v245, v14, -v17
    v_exp_f32 v245, v245
    v_fma_f32 v249, v249, v14, -v17
    v_fma_f32 v252, v252, v14, -v17
    v_fma_f32 v240, v240, v14, -v17
    v_fma_f32 v194, v194, v14, -v17
    v_exp_f32 v194, v194
    v_fma_f32 v195, v195, v14, -v17
    v_exp_f32 v195, v195
    v_cvt_pk_bf16_f32 v104, v128, v129
    v_mfma_f32_4x4x4_16b_bf16 v[128:131], v[22:23], v[40:41], 0
    v_fma_f32 v242, v242, v14, -v17
    v_cvt_pk_bf16_f32 v168, v176, v177
    v_mfma_f32_4x4x4_16b_bf16 v[176:179], v[22:23], v[32:33], 0
    v_exp_f32 v192, v192
    v_exp_f32 v198, v198
    v_mfma_f32_32x32x16_bf16 v[112:127], v[72:75], a[248:251], v[112:127]
    v_fma_f32 v205, v205, v14, -v17
    v_fma_f32 v253, v253, v14, -v17
    v_exp_f32 v193, v193
    v_fma_f32 v202, v202, v14, -v17
    v_exp_f32 v246, v246
    v_mfma_f32_4x4x4_16b_bf16 v[140:143], v[22:23], v[46:47], 0
    v_fma_f32 v243, v243, v14, -v17
    v_exp_f32 v203, v203
    v_exp_f32 v197, v197
    v_exp_f32 v253, v253
    v_mfma_f32_32x32x16_bf16 v[112:127], v[76:79], a[252:255], v[112:127]
    v_fma_f32 v206, v206, v14, -v17
    v_exp_f32 v206, v206
    v_add_f32 v19, v192, v193
    v_mul_f32_dpp v192, v15, v192 row_newbcast:0 row_mask:0xf bank_mask:0xf
    v_fma_f32 v201, v201, v14, -v17
    v_exp_f32 v201, v201
    v_add_f32 v19, v19, v194
    v_exp_f32 v240, v240
    v_mfma_f32_32x32x16_bf16 v[128:143], v[96:99], v[160:163], v[128:143]
    v_fma_f32 v248, v248, v14, -v17
    v_exp_f32 v242, v242
    v_add_f32 v19, v19, v195
    v_add_f32 v19, v19, v196
    v_exp_f32 v207, v207
    v_add_f32 v19, v19, v197
    v_exp_f32 v241, v241
    v_mul_f32_dpp v196, v15, v196 row_newbcast:4 row_mask:0xf bank_mask:0xf
    v_mfma_f32_32x32x16_bf16 v[128:143], v[100:103], v[164:167], v[128:143]
    v_cvt_pk_bf16_f32 v158, v124, v125
    v_exp_f32 v202, v202
    v_add_f32 v19, v19, v198
    v_mul_f32_dpp v198, v15, v198 row_newbcast:6 row_mask:0xf bank_mask:0xf
    v_fma_f32 v251, v251, v14, -v17
    v_mfma_f32_32x32x16_bf16 v[128:143], v[104:107], v[168:171], v[128:143]
    v_exp_f32 v199, v199
    v_mul_f32_dpp v197, v15, v197 row_newbcast:5 row_mask:0xf bank_mask:0xf
    v_exp_f32 v200, v200
    v_exp_f32 v205, v205
    v_cvt_pk_bf16_f32 v157, v122, v123
    v_exp_f32 v204, v204
    v_mfma_f32_4x4x4_16b_bf16 v[184:187], v[22:23], v[36:37], 0
    v_cvt_pk_bf16_f32 v152, v112, v113
    v_cvt_pk_bf16_f32 v154, v116, v117
    v_mfma_f32_32x32x16_bf16 v[128:143], v[108:111], v[172:175], v[128:143]
    v_mul_f32_dpp v194, v15, v194 row_newbcast:2 row_mask:0xf bank_mask:0xf
    v_add_f32 v19, v19, v199
    v_mul_f32_dpp v199, v15, v199 row_newbcast:7 row_mask:0xf bank_mask:0xf
    v_add_f32 v19, v19, v200
    v_mul_f32_dpp v195, v15, v195 row_newbcast:3 row_mask:0xf bank_mask:0xf
    v_add_f32 v19, v19, v201
    v_add_f32 v19, v19, v202
    v_mfma_f32_32x32x16_bf16 v[176:191], v[80:83], v[160:163], v[176:191]
    v_add_f32 v19, v19, v203
    v_mul_f32_dpp v203, v15, v203 row_newbcast:11 row_mask:0xf bank_mask:0xf
    v_add_f32 v19, v19, v204
    v_add_f32 v19, v19, v205
    v_cvt_pk_bf16_f32 v155, v118, v119
    v_add_f32 v19, v19, v206
    v_add_f32 v19, v19, v207
    v_mfma_f32_32x32x16_bf16 v[176:191], v[84:87], v[164:167], v[176:191]
    v_mul_f32_dpp v206, v15, v206 row_newbcast:14 row_mask:0xf bank_mask:0xf
    v_fma_f32 v255, v255, v14, -v17
    v_exp_f32 v255, v255
    v_add_f32 v19, v19, v240
    v_mul_f32_dpp v193, v15, v193 row_newbcast:1 row_mask:0xf bank_mask:0xf
    v_mfma_f32_32x32x16_bf16 v[176:191], v[88:91], v[168:171], v[176:191]
    v_exp_f32 v251, v251
    v_fma_f32 v247, v247, v14, -v17
    v_exp_f32 v243, v243
    v_exp_f32 v247, v247
    v_add_f32 v19, v19, v241
    v_cvt_pk_bf16_f32 v153, v114, v115
    v_cvt_pk_bf16_f32 v128, v128, v129
    v_fma_f32 v244, v244, v14, -v17
    v_exp_f32 v244, v244
    v_cvt_pk_bf16_f32 v129, v130, v131
    v_mfma_f32_4x4x4_16b_bf16 v[112:115], v[22:23], v[48:49], 0
    v_cvt_pk_bf16_f32 v131, v134, v135
    v_cvt_pk_bf16_f32 v134, v140, v141
    v_cvt_pk_bf16_f32 v130, v132, v133
    v_cvt_pk_bf16_f32 v133, v138, v139
    v_fma_f32 v250, v250, v14, -v17
    v_mfma_f32_32x32x16_bf16 v[176:191], v[92:95], v[172:175], v[176:191]
    ds_write_b128 v10, v[128:131] offset:64
    v_mul_f32_dpp v241, v16, v241 row_newbcast:1 row_mask:0xf bank_mask:0xf
    v_mul_f32_dpp v240, v16, v240 row_newbcast:0 row_mask:0xf bank_mask:0xf
    v_cvt_pk_bf16_f32 v135, v142, v143
    v_mfma_f32_4x4x4_16b_bf16 v[116:119], v[22:23], v[50:51], 0
    v_add_f32 v19, v19, v242
    v_cvt_pk_bf16_f32 v132, v136, v137
    v_add_f32 v19, v19, v243
    v_add_f32 v19, v19, v244
    v_add_f32 v19, v19, v245
    v_add_f32_e64 v19, v19, v246
    v_mfma_f32_4x4x4_16b_bf16 v[216:219], v[22:23], v[60:61], 0
    v_cvt_pk_bf16_f32 v159, v126, v127
    v_cvt_pk_bf16_f32 v176, v176, v177
    v_mfma_f32_4x4x4_16b_bf16 v[124:127], v[22:23], v[54:55], 0
    v_cvt_pk_bf16_f32 v177, v178, v179
    v_cvt_pk_bf16_f32 v179, v182, v183
    v_cvt_pk_bf16_f32 v182, v188, v189
    v_mfma_f32_4x4x4_16b_bf16 v[236:239], v[22:23], v[70:71], 0
    v_cvt_pk_bf16_f32 v178, v180, v181
    v_cvt_pk_bf16_f32 v183, v190, v191
    v_cvt_pk_bf16_f32 v181, v186, v187
    v_cvt_pk_bf16_f32 v180, v184, v185
    v_exp_f32 v249, v249
    v_cvt_pk_bf16_f32 v156, v120, v121
    v_mfma_f32_4x4x4_16b_bf16 v[120:123], v[22:23], v[52:53], 0
    v_exp_f32 v248, v248
    v_add_f32 v19, v19, v247
    v_add_f32 v19, v19, v248
    v_exp_f32 v252, v252
    v_mfma_f32_32x32x16_bf16 v[112:127], v[144:147], v[160:163], v[112:127]
    ds_write_b128 v10, v[176:179] offset:0
    v_add_f32 v19, v19, v249
    v_exp_f32 v250, v250
    v_mfma_f32_4x4x4_16b_bf16 v[208:211], v[22:23], v[56:57], 0
    v_exp_f32 v254, v254
    v_mfma_f32_32x32x16_bf16 v[112:127], v[148:151], v[164:167], v[112:127]
    v_mul_f32_dpp v246, v16, v246 row_newbcast:6 row_mask:0xf bank_mask:0xf
    v_add_f32 v19, v19, v250
    v_add_f32 v19, v19, v251
    v_mul_f32_dpp v249, v16, v249 row_newbcast:9 row_mask:0xf bank_mask:0xf
    v_add_f32 v19, v19, v252
    v_add_f32 v19, v19, v253
    v_add_f32 v19, v19, v254
    v_mfma_f32_32x32x16_bf16 v[112:127], v[152:155], v[168:171], v[112:127]
    ds_write_b128 v21, v[132:135] offset:64
    v_mul_f32_dpp v204, v15, v204 row_newbcast:12 row_mask:0xf bank_mask:0xf
    v_add_f32 v19, v19, v255
    v_mov_b32 v20, v19
    v_mul_f32_dpp v253, v16, v253 row_newbcast:13 row_mask:0xf bank_mask:0xf
    v_mfma_f32_32x32x16_bf16 v[112:127], v[156:159], v[172:175], v[112:127]
    ds_write_b128 v21, v[180:183] offset:0
    v_permlane32_swap_b32 v19, v20
    v_add_f32 v19, v19, v20
    v_mfma_f32_4x4x4_16b_bf16 v[220:223], v[22:23], v[62:63], 0
    v_mul_f32_dpp v201, v15, v201 row_newbcast:9 row_mask:0xf bank_mask:0xf
    v_rcp_f32 v19, v19
    v_mfma_f32_4x4x4_16b_bf16 v[228:231], v[22:23], v[66:67], 0
    v_mul_f32 v192, v192, v19
    v_mul_f32 v198, v198, v19
    v_mfma_f32_4x4x4_16b_bf16 v[224:227], v[22:23], v[64:65], 0
    v_mul_f32_dpp v200, v15, v200 row_newbcast:8 row_mask:0xf bank_mask:0xf
    v_mul_f32 v200, v200, v19
    v_mul_f32 v204, v204, v19
    v_cvt_pk_bf16_f32 v112, v112, v113
    v_cvt_pk_bf16_f32 v113, v114, v115
    v_cvt_pk_bf16_f32 v115, v118, v119
    v_mfma_f32_4x4x4_16b_bf16 v[232:235], v[22:23], v[68:69], 0
    v_mul_f32 v196, v196, v19
    v_mul_f32 v195, v195, v19
    v_cvt_pk_bf16_f32 v118, v124, v125
    v_cvt_pk_bf16_f32 v119, v126, v127
    v_mul_f32_dpp v205, v15, v205 row_newbcast:13 row_mask:0xf bank_mask:0xf
    v_mfma_f32_4x4x4_16b_bf16 v[212:215], v[22:23], v[58:59], 0
    v_mul_f32_dpp v202, v15, v202 row_newbcast:10 row_mask:0xf bank_mask:0xf
    v_mul_f32 v202, v202, v19
    v_mul_f32 v206, v206, v19
    v_cvt_pk_bf16_f32 v114, v116, v117
    v_cvt_pk_bf16_f32 v117, v122, v123
    v_mul_f32 v193, v193, v19
    v_cvt_pk_bf16_f32 v192, v192, v193
    v_mul_f32 v203, v203, v19
    v_mul_f32 v194, v194, v19
    v_mul_f32 v197, v197, v19
    v_cvt_pk_bf16_f32 v193, v194, v195
    v_mul_f32 v201, v201, v19
    v_cvt_pk_bf16_f32 v194, v196, v197
    v_cvt_pk_bf16_f32 v196, v200, v201
    v_mul_f32 v240, v240, v19
    v_mul_f32 v199, v199, v19
    v_cvt_pk_bf16_f32 v195, v198, v199
    v_mul_f32 v205, v205, v19
    v_cvt_pk_bf16_f32 v116, v120, v121
    v_mfma_f32_32x32x16_bf16 v[224:239], v[96:99], v[192:195], v[224:239]
    ds_write_b128 v21, v[116:119] offset:128
    v_cvt_pk_bf16_f32 v197, v202, v203
    v_mfma_f32_32x32x16_bf16 v[208:223], v[80:83], v[192:195], v[208:223]
    v_mul_f32_dpp v207, v15, v207 row_newbcast:15 row_mask:0xf bank_mask:0xf
    v_mul_f32 v207, v207, v19
    v_cvt_pk_bf16_f32 v199, v206, v207
    v_cvt_pk_bf16_f32 v198, v204, v205
    v_mul_f32_dpp v252, v16, v252 row_newbcast:12 row_mask:0xf bank_mask:0xf
    v_mul_f32_dpp v247, v16, v247 row_newbcast:7 row_mask:0xf bank_mask:0xf
    v_mul_f32 v247, v247, v19
    v_mfma_f32_32x32x16_bf16 v[208:223], v[84:87], v[196:199], v[208:223]
    ds_write_b128 v10, v[112:115] offset:128
    v_mul_f32 v246, v246, v19
    v_cvt_pk_bf16_f32 v203, v246, v247
    v_mul_f32_dpp v244, v16, v244 row_newbcast:4 row_mask:0xf bank_mask:0xf
    v_mul_f32_dpp v245, v16, v245 row_newbcast:5 row_mask:0xf bank_mask:0xf
    v_mul_f32 v245, v245, v19
    v_mfma_f32_32x32x16_bf16 v[224:239], v[100:103], v[196:199], v[224:239]
    ds_read_b128 v[140:143], v18 offset:1024
    v_mul_f32 v252, v252, v19
    v_mul_f32_dpp v243, v16, v243 row_newbcast:3 row_mask:0xf bank_mask:0xf
    v_mul_f32 v243, v243, v19
    v_mul_f32_dpp v242, v16, v242 row_newbcast:2 row_mask:0xf bank_mask:0xf
    v_mul_f32 v242, v242, v19
    v_cvt_pk_bf16_f32 v201, v242, v243
    v_mul_f32 v241, v241, v19
    v_cvt_pk_bf16_f32 v200, v240, v241
    v_mfma_f32_4x4x4_16b_bf16 v[240:243], v[22:23], v[72:73], 0
    v_mul_f32 v244, v244, v19
    v_cvt_pk_bf16_f32 v202, v244, v245
    v_mfma_f32_4x4x4_16b_bf16 v[244:247], v[22:23], v[74:75], 0
    v_mul_f32_dpp v254, v16, v254 row_newbcast:14 row_mask:0xf bank_mask:0xf
    v_mul_f32 v254, v254, v19
    v_mfma_f32_32x32x16_bf16 v[224:239], v[104:107], v[200:203], v[224:239]
    s_add_u32 s45, s40, 73728
    v_mul_f32_dpp v248, v16, v248 row_newbcast:8 row_mask:0xf bank_mask:0xf
    v_mul_f32 v248, v248, v19
    v_mul_f32 v249, v249, v19
    v_cvt_pk_bf16_f32 v204, v248, v249
    v_mul_f32_dpp v255, v16, v255 row_newbcast:15 row_mask:0xf bank_mask:0xf
    v_mul_f32 v255, v255, v19
    v_cvt_pk_bf16_f32 v207, v254, v255
    v_mfma_f32_32x32x16_bf16 v[208:223], v[88:91], v[200:203], v[208:223]
    ds_read_b128 v[124:127], v18 offset:2048
    v_mul_f32 v253, v253, v19
    v_mul_f32_dpp v251, v16, v251 row_newbcast:11 row_mask:0xf bank_mask:0xf
    v_mul_f32 v251, v251, v19
    v_mul_f32_dpp v250, v16, v250 row_newbcast:10 row_mask:0xf bank_mask:0xf
    v_mul_f32 v250, v250, v19
    v_cvt_pk_bf16_f32 v205, v250, v251
    v_mfma_f32_4x4x4_16b_bf16 v[248:251], v[22:23], v[76:77], 0
    v_cvt_pk_bf16_f32 v206, v252, v253
    v_mfma_f32_4x4x4_16b_bf16 v[252:255], v[22:23], v[78:79], 0
    s_waitcnt lgkmcnt(1)
    ds_read_b128 v[120:123], v18 offset:5120
    v_mfma_f32_32x32x16_bf16 v[224:239], v[108:111], v[204:207], v[224:239]
    buffer_store_dwordx4 v[140:143], v1, s[20:23], s44 offen offset:1024 sc1
    v_mfma_f32_32x32x16_bf16 v[240:255], v[144:147], v[192:195], v[240:255]
    s_mov_b32 s40, s41
    ds_read_b128 v[136:139], v18 offset:4096
    s_mov_b32 s41, s38
    ds_read_b128 v[188:191], v18 offset:0
    v_cvt_pk_bf16_f32 v224, v224, v225
    v_cvt_pk_bf16_f32 v225, v226, v227
    v_cvt_pk_bf16_f32 v227, v230, v231
    v_mfma_f32_32x32x16_bf16 v[208:223], v[92:95], v[204:207], v[208:223]
    ds_read_b128 v[184:187], v18 offset:3072
    v_cvt_pk_bf16_f32 v230, v236, v237
    v_cvt_pk_bf16_f32 v226, v228, v229
    v_cvt_pk_bf16_f32 v228, v232, v233
    v_cvt_pk_bf16_f32 v229, v234, v235
    v_cvt_pk_bf16_f32 v231, v238, v239
    v_mfma_f32_32x32x16_bf16 v[240:255], v[148:151], v[196:199], v[240:255]
    s_waitcnt lgkmcnt(4)
    ds_write_b128 v10, v[224:227] offset:3136
    buffer_store_dwordx4 v[124:127], v2, s[20:23], s44 offen offset:2048 sc1
    v_mfma_f32_32x32x16_bf16 v[240:255], v[152:155], v[200:203], v[240:255]
    ds_write_b128 v21, v[228:231] offset:3136
    v_cvt_pk_bf16_f32 v208, v208, v209
    v_mfma_f32_32x32x16_bf16 v[240:255], v[156:159], v[204:207], v[240:255]
    v_cvt_pk_bf16_f32 v209, v210, v211
    v_cvt_pk_bf16_f32 v210, v212, v213
    v_cvt_pk_bf16_f32 v211, v214, v215
    v_cvt_pk_bf16_f32 v212, v216, v217
    v_cvt_pk_bf16_f32 v213, v218, v219
    v_cvt_pk_bf16_f32 v215, v222, v223
    v_cvt_pk_bf16_f32 v214, v220, v221
    s_waitcnt lgkmcnt(3)
    ds_write_b128 v10, v[208:211] offset:3072
    buffer_store_dwordx4 v[188:191], v0, s[20:23], s44 offen offset:0 sc1
    ds_write_b128 v21, v[212:215] offset:3072
    s_nop 1
    v_cvt_pk_bf16_f32 v240, v240, v241
    v_cvt_pk_bf16_f32 v241, v242, v243
    v_cvt_pk_bf16_f32 v243, v246, v247
    v_cvt_pk_bf16_f32 v242, v244, v245
    ds_write_b128 v10, v[240:243] offset:3200
    buffer_store_dwordx4 v[136:139], v4, s[20:23], s44 offen offset:1024 sc1
    v_cvt_pk_bf16_f32 v247, v254, v255
    v_cvt_pk_bf16_f32 v245, v250, v251
    v_cvt_pk_bf16_f32 v244, v248, v249
    v_cvt_pk_bf16_f32 v246, v252, v253
    ds_write_b128 v21, v[244:247] offset:3200
    buffer_store_dwordx4 v[120:123], v5, s[20:23], s44 offen offset:2048 sc1
    ds_read_b128 v[236:239], v18 offset:6144
    ds_read_b128 v[220:223], v18 offset:4096
    s_waitcnt lgkmcnt(8)
    ds_read_b128 v[252:255], v18 offset:8192
    buffer_store_dwordx4 v[184:187], v3, s[20:23], s44 offen offset:0 sc1
    ds_read_b128 v[248:251], v18 offset:7168
    ds_read_b128 v[216:219], v18 offset:3072
    s_waitcnt lgkmcnt(4)
    buffer_store_dwordx4 v[236:239], v3, s[20:23], s45 offen offset:0 sc1
    ds_read_b128 v[232:235], v18 offset:5120
    s_waitcnt lgkmcnt(2)
    buffer_store_dwordx4 v[248:251], v4, s[20:23], s45 offen offset:1024 sc1
    s_waitcnt lgkmcnt(1)
    buffer_store_dwordx4 v[216:219], v0, s[20:23], s45 offen offset:0 sc1
    buffer_store_dwordx4 v[220:223], v1, s[20:23], s45 offen offset:1024 sc1
    s_waitcnt lgkmcnt(0)
    buffer_store_dwordx4 v[252:255], v5, s[20:23], s45 offen offset:2048 sc1
    buffer_store_dwordx4 v[232:235], v2, s[20:23], s45 offen offset:2048 sc1
L_end:
    s_endpgm
L_codeend:
.section .rodata,"a"
.p2align 6
.amdhsa_kernel standalone__video_video_swin__vision_kernel
  .amdhsa_next_free_vgpr 512
  .amdhsa_next_free_sgpr 102
  .amdhsa_accum_offset 256
  .amdhsa_group_segment_fixed_size 0
  .amdhsa_kernarg_size 64
  .amdhsa_user_sgpr_count 2
  .amdhsa_user_sgpr_kernarg_segment_ptr 1
  .amdhsa_system_sgpr_workgroup_id_x 1
.end_amdhsa_kernel
```
